```python
import torch

def _softmax(x, axis=-1):
    return torch.softmax(x, dim=axis)

def _gelu(x):
    return torch.nn.functional.gelu(x, approximate='tanh')

def _silu(x):
    return torch.nn.functional.silu(x)

def _sigmoid(x):
    return torch.sigmoid(x)

def _layernorm(x, axis=-1, eps=1e-05):
    m = x.mean(dim=axis, keepdim=True)
    v = x.var(dim=axis, keepdim=True, unbiased=False)
    return (x - m) / torch.sqrt(v + eps)

def _scatter_add(tgt, idx, src, axis=0):
    return tgt.clone().index_add_(axis, idx, src)

def _segment_sum(src, seg, n):
    out = torch.zeros((n,) + src.shape[1:], dtype=src.dtype)
    return out.index_add_(0, seg, src)

def _pad(x, pw):
    flat = tuple((v for pair in reversed(pw) for v in pair))
    return torch.nn.functional.pad(x, flat)
kernel_name = 'sequential_preLN__memory_aug_recurrent_mem_tr__mixer_channel_mlp__prompt'

def setup_inputs():

    _w = lambda a: (lambda t: t.to(torch.bfloat16) if t.is_floating_point() else t)(torch.as_tensor(a))

    def _A_setup():
        B, S, Dm = (1, 2048, 448)
        H, Dh = (16, 256)
        M, seg = (8, 32)
        seg = min(seg, S)
        S = S // seg * seg
        return {'x': _w((lambda *s: torch.randn(*s, dtype=torch.bfloat16) * 0.05)(B, S, Dm)), 'mem0': _w((lambda *s: torch.randn(*s, dtype=torch.bfloat16) * 0.2)(B, M, Dm)), 'Wq': _w((lambda *s: torch.randn(*s, dtype=torch.bfloat16) * 1.6)(Dm, H, Dh) * Dm ** (-0.5)), 'Wk': _w((lambda *s: torch.randn(*s, dtype=torch.bfloat16) * 1.6)(Dm, H, Dh) * Dm ** (-0.5)), 'Wv': _w((lambda *s: torch.randn(*s, dtype=torch.bfloat16) * 0.2)(Dm, H, Dh) * Dm ** (-0.5)), 'Wo': _w((lambda *s: torch.randn(*s, dtype=torch.bfloat16) * 0.2)(H, Dh, Dm) * (H * Dh) ** (-0.5)), 'seg_len': seg}
    _A_in = _A_setup()

    def _B_setup():
        B, S, D, F = (1, 2048, 448, 1792)
        return {'x': _w((lambda *s: torch.randn(*s, dtype=torch.bfloat16) * 0.05)(B, S, D)), 'w1': _w((lambda *s: torch.randn(*s, dtype=torch.bfloat16) * 0.8)(D, F) * D ** (-0.5)), 'b1': _w((lambda *s: torch.randn(*s, dtype=torch.bfloat16) * 0.4)(F)), 'w2': _w((lambda *s: torch.randn(*s, dtype=torch.bfloat16) * 0.05)(F, D) * F ** (-0.5)), 'b2': _w((lambda *s: torch.randn(*s, dtype=torch.bfloat16) * 0.05)(D))}
    _B_in = _B_setup()
    return {'A_x': _A_in['x'], 'A_mem0': _A_in['mem0'], 'A_Wq': _A_in['Wq'], 'A_Wk': _A_in['Wk'], 'A_Wv': _A_in['Wv'], 'A_Wo': _A_in['Wo'], 'A_seg_len': _A_in['seg_len'], 'B_x': _B_in['x'], 'B_w1': _B_in['w1'], 'B_b1': _B_in['b1'], 'B_w2': _B_in['w2'], 'B_b2': _B_in['b2']}

def reference(A_x, A_mem0, A_Wq, A_Wk, A_Wv, A_Wo, A_seg_len, B_x, B_w1, B_b1, B_w2, B_b2):

    def _A_ref(x, mem0, Wq, Wk, Wv, Wo, seg_len):
        B, S, Dm = x.shape
        H, Dh = (Wq.shape[1], Wq.shape[2])
        M = mem0.shape[1]
        scale = Dh ** (-0.5)
        n_seg = S // seg_len
        L = M + seg_len
        idx = torch.arange(L)
        mask = (idx[:, None] < M) | (idx[:, None] >= idx[None, :])
        mem = mem0
        outs = []
        for s in range(n_seg):
            xs = x[:, s * seg_len:(s + 1) * seg_len, :].clone()
            h = torch.concatenate([mem, xs], axis=1)
            q = torch.einsum('btd,dhe->bhte', h, Wq)
            k = torch.einsum('btd,dhe->bhte', h, Wk)
            v = torch.einsum('btd,dhe->bhte', h, Wv)
            scores = torch.einsum('bhqe,bhke->bhqk', q, k) * scale
            scores = torch.where(mask[None, None], scores, -1000000000.0)
            p = _softmax(scores, axis=-1)
            o = torch.einsum('bhqk,bhke->bhqe', p, v)
            o = torch.einsum('bhte,hed->btd', o, Wo)
            mem = o[:, :M, :].clone()
            outs.append(o[:, M:, :])
        return torch.concatenate(outs, axis=1)

    def _B_ref(x, w1, b1, w2, b2):
        y = _layernorm(x, axis=-1)
        h = _gelu(torch.einsum('bsd,df->bsf', y, w1) + b1)
        return torch.einsum('bsf,fd->bsd', h, w2) + b2
    x = A_x
    h = x + _A_ref(_layernorm(x, axis=-1), A_mem0, A_Wq, A_Wk, A_Wv, A_Wo, A_seg_len)
    h2 = h + _B_ref(_layernorm(h, axis=-1), B_w1, B_b1, B_w2, B_b2)
    return h2
```

```asm
; @launch grid=(256,1,1) block=(256,1,1) lds=163840
.amdgcn_target "amdgcn-amd-amdhsa--gfx950"
.text
.globl sequential_preLN__memory_aug_recurrent_mem_tr__mixer_channel_mlp__prompt_kernel
.p2align 8
.type sequential_preLN__memory_aug_recurrent_mem_tr__mixer_channel_mlp__prompt_kernel,@function
sequential_preLN__memory_aug_recurrent_mem_tr__mixer_channel_mlp__prompt_kernel:
    s_cmp_ge_u32 s2, 256
    s_cbranch_scc1 Lm_exit
    s_load_dwordx2 s[4:5], s[0:1], 112
    s_load_dwordx2 s[6:7], s[0:1], 104
    s_load_dwordx4 s[76:79], s[0:1], 0
    s_load_dwordx8 s[80:87], s[0:1], 16
    v_lshrrev_b32 v1, 6, v0
    s_getreg_b32 s35, hwreg(HW_REG_XCC_ID)
    v_readfirstlane_b32 s12, v1
    s_and_b32 s35, s35, 7
    s_mov_b32 s15, 400000
    s_waitcnt lgkmcnt(0)
    s_mov_b32 s8, s4
    s_and_b32 s9, s5, 0xffff
    s_mov_b32 s10, 268435456
    s_mov_b32 s11, 0x20000
    s_mov_b32 s40, s6
    s_and_b32 s41, s7, 0xffff
    s_mov_b32 s42, 256
    s_mov_b32 s43, 0x20000
    v_mov_b32 v2, 0
    s_cmp_lg_u32 s12, 0
    s_cbranch_scc1 Lm_warm
    s_mov_b64 exec, 1
    s_mul_i32 s18, s35, 28
    v_mov_b32 v253, 1
    buffer_atomic_add v253, v2, s[40:43], s18 offen sc0 sc1
    s_mov_b64 exec, -1
Lm_warm:
    s_cmp_lg_u32 s12, 1
    s_cbranch_scc1 Lm_nocw
    s_getpc_b64 s[44:45]
    s_lshr_b32 s46, s2, 3
    s_and_b32 s46, s46, 7
    s_lshl_b32 s46, s46, 13
    v_and_b32 v4, 63, v0
    v_lshlrev_b32 v4, 7, v4
    v_add_u32 v4, s46, v4
    v_min_u32 v4, Lm_exit-Lm_nocw, v4
    global_load_dword v252, v4, s[44:45]
Lm_nocw:
    s_cmp_lg_u32 s2, 255
    s_cbranch_scc1 Lm_nozero
    v_mov_b32 v8, 0
    v_mov_b32 v9, 0
    v_mov_b32 v10, 0
    v_mov_b32 v11, 0
    v_lshlrev_b32 v7, 4, v0
    s_mov_b32 s19, 108544000
    buffer_store_dwordx4 v[8:11], v7, s[8:11], s19 offen sc1
    s_add_u32 s19, s19, 4096
    buffer_store_dwordx4 v[8:11], v7, s[8:11], s19 offen sc1
    s_add_u32 s19, s19, 4096
    buffer_store_dwordx4 v[8:11], v7, s[8:11], s19 offen sc1
    s_add_u32 s19, s19, 4096
    buffer_store_dwordx4 v[8:11], v7, s[8:11], s19 offen sc1
    s_add_u32 s19, s19, 4096
    s_waitcnt vmcnt(0)
    s_barrier
    v_mov_b32 v8, 1
    buffer_store_dword v8, v2, s[40:43], 0 offen offset:252 sc1
Lm_nozero:
    s_mov_b32 s3, s2
    v_and_b32 v2, 63, v0
    v_lshrrev_b32 v8, 5, v2
    v_and_b32 v9, 31, v2
    v_mov_b32 v12, 1
    v_mov_b32 v13, 0
    s_cmp_ge_u32 s3, 224
    s_cbranch_scc1 Lp_ln
    s_lshr_b32 s19, s3, 3
    s_mul_i32 s60, s19, 9363
    s_lshr_b32 s60, s60, 16
    s_mul_i32 s18, s60, 7
    s_sub_u32 s61, s19, s18
    s_and_b32 s18, s3, 7
    s_lshl_b32 s18, s18, 2
    s_add_u32 s60, s60, s18
    s_and_b32 s62, s60, 15
    s_cmp_ge_u32 s60, 16
    s_cselect_b32 s44, s84, s80
    s_cselect_b32 s45, s85, s81
    s_cselect_b32 s46, s86, s82
    s_cselect_b32 s47, s87, s83
    s_mov_b32 s18, 1035512379
    s_cselect_b32 s68, 1.0, s18
    s_mov_b32 s69, s68
    s_mov_b32 s48, s44
    s_and_b32 s49, s45, 0xffff
    s_mov_b32 s50, 3670016
    s_mov_b32 s51, 0x20000
    s_mov_b32 s52, s46
    s_and_b32 s53, s47, 0xffff
    s_mov_b32 s54, 3670016
    s_mov_b32 s55, 0x20000
    v_xor_b32 v3, v9, v8
    v_lshlrev_b32 v3, 4, v3
    v_lshl_add_u32 v3, v8, 13, v3
    s_lshl_b32 s63, s12, 13
    s_cmp_ge_u32 s60, 16
    s_cbranch_scc1 Lp_stageWo
    s_lshl_b32 s18, s61, 6
    s_lshl_b32 s19, s12, 4
    s_add_u32 s18, s18, s19
    s_lshl_b32 s18, s18, 13
    s_lshl_b32 s19, s62, 9
    s_add_u32 s18, s18, s19
    v_xor_b32 v4, 0, v3
    s_mov_b32 m0, s63
    s_nop 0
    buffer_load_dwordx4 v4, s[52:55], s18 offen lds
    s_add_u32 s18, s18, 16384
    s_add_u32 s63, s63, 1024
    v_xor_b32 v4, 32, v3
    s_mov_b32 m0, s63
    s_nop 0
    buffer_load_dwordx4 v4, s[52:55], s18 offen lds
    s_add_u32 s18, s18, 16384
    s_add_u32 s63, s63, 1024
    v_xor_b32 v4, 64, v3
    s_mov_b32 m0, s63
    s_nop 0
    buffer_load_dwordx4 v4, s[52:55], s18 offen lds
    s_add_u32 s18, s18, 16384
    s_add_u32 s63, s63, 1024
    v_xor_b32 v4, 96, v3
    s_mov_b32 m0, s63
    s_nop 0
    buffer_load_dwordx4 v4, s[52:55], s18 offen lds
    s_add_u32 s18, s18, 16384
    s_add_u32 s63, s63, 1024
    v_xor_b32 v4, 128, v3
    s_mov_b32 m0, s63
    s_nop 0
    buffer_load_dwordx4 v4, s[52:55], s18 offen lds
    s_add_u32 s18, s18, 16384
    s_add_u32 s63, s63, 1024
    v_xor_b32 v4, 160, v3
    s_mov_b32 m0, s63
    s_nop 0
    buffer_load_dwordx4 v4, s[52:55], s18 offen lds
    s_add_u32 s18, s18, 16384
    s_add_u32 s63, s63, 1024
    v_xor_b32 v4, 192, v3
    s_mov_b32 m0, s63
    s_nop 0
    buffer_load_dwordx4 v4, s[52:55], s18 offen lds
    s_add_u32 s18, s18, 16384
    s_add_u32 s63, s63, 1024
    v_xor_b32 v4, 224, v3
    s_mov_b32 m0, s63
    s_nop 0
    buffer_load_dwordx4 v4, s[52:55], s18 offen lds
    s_add_u32 s18, s18, 16384
    s_add_u32 s63, s63, 1024
    s_branch Lp_stagedB
Lp_stageWo:
    v_lshrrev_b32 v10, 3, v2
    v_mul_u32_u24 v4, 896, v10
    v_and_b32 v10, 7, v2
    v_lshl_add_u32 v4, v10, 4, v4
    s_mul_i32 s18, s62, 229376
    s_mul_i32 s19, s12, 57344
    s_add_u32 s18, s18, s19
    s_lshl_b32 s19, s61, 7
    s_add_u32 s18, s18, s19
    s_mov_b32 m0, s63
    s_nop 0
    buffer_load_dwordx4 v4, s[52:55], s18 offen lds
    s_add_u32 s18, s18, 7168
    s_add_u32 s63, s63, 1024
    s_mov_b32 m0, s63
    s_nop 0
    buffer_load_dwordx4 v4, s[52:55], s18 offen lds
    s_add_u32 s18, s18, 7168
    s_add_u32 s63, s63, 1024
    s_mov_b32 m0, s63
    s_nop 0
    buffer_load_dwordx4 v4, s[52:55], s18 offen lds
    s_add_u32 s18, s18, 7168
    s_add_u32 s63, s63, 1024
    s_mov_b32 m0, s63
    s_nop 0
    buffer_load_dwordx4 v4, s[52:55], s18 offen lds
    s_add_u32 s18, s18, 7168
    s_add_u32 s63, s63, 1024
    s_mov_b32 m0, s63
    s_nop 0
    buffer_load_dwordx4 v4, s[52:55], s18 offen lds
    s_add_u32 s18, s18, 7168
    s_add_u32 s63, s63, 1024
    s_mov_b32 m0, s63
    s_nop 0
    buffer_load_dwordx4 v4, s[52:55], s18 offen lds
    s_add_u32 s18, s18, 7168
    s_add_u32 s63, s63, 1024
    s_mov_b32 m0, s63
    s_nop 0
    buffer_load_dwordx4 v4, s[52:55], s18 offen lds
    s_add_u32 s18, s18, 7168
    s_add_u32 s63, s63, 1024
    s_mov_b32 m0, s63
    s_nop 0
    buffer_load_dwordx4 v4, s[52:55], s18 offen lds
    s_add_u32 s18, s18, 7168
    s_add_u32 s63, s63, 1024
Lp_stagedB:
    s_lshl_b32 s66, s12, 15
    s_add_u32 s66, s66, 32768
    s_and_b32 s19, s12, 3
    s_lshl_b32 s18, s61, 1
    s_add_u32 s18, s18, s19
    s_add_u32 s18, s18, 0
    s_cmp_ge_u32 s18, 14
    s_cselect_b32 s19, 14, 0
    s_sub_u32 s70, s18, s19
    s_and_b32 s19, s12, 3
    s_lshl_b32 s18, s61, 1
    s_add_u32 s18, s18, s19
    s_add_u32 s18, s18, 4
    s_cmp_ge_u32 s18, 14
    s_cselect_b32 s19, 14, 0
    s_sub_u32 s71, s18, s19
    s_and_b32 s19, s12, 3
    s_lshl_b32 s18, s61, 1
    s_add_u32 s18, s18, s19
    s_add_u32 s18, s18, 8
    s_cmp_ge_u32 s18, 14
    s_cselect_b32 s19, 14, 0
    s_sub_u32 s72, s18, s19
    s_and_b32 s19, s12, 1
    s_lshl_b32 s18, s61, 1
    s_add_u32 s18, s18, s19
    s_add_u32 s18, s18, 12
    s_cmp_ge_u32 s18, 14
    s_cselect_b32 s19, 14, 0
    s_sub_u32 s73, s18, s19
    s_cmp_lt_u32 s12, 2
    s_cbranch_scc1 Lp_go0
    s_waitcnt vmcnt(0)
Lp_go0:
    s_lshl_b32 s18, s70, 18
    s_lshl_b32 s19, s62, 9
    s_add_u32 s18, s18, s19
    v_xor_b32 v4, 0, v3
    s_add_u32 s19, s18, 0
    s_add_u32 m0, s66, 0
    s_nop 0
    buffer_load_dwordx4 v4, s[48:51], s19 offen lds
    v_xor_b32 v4, 32, v3
    s_add_u32 s19, s18, 16384
    s_add_u32 m0, s66, 1024
    s_nop 0
    buffer_load_dwordx4 v4, s[48:51], s19 offen lds
    v_xor_b32 v4, 64, v3
    s_add_u32 s19, s18, 65536
    s_add_u32 m0, s66, 2048
    s_nop 0
    buffer_load_dwordx4 v4, s[48:51], s19 offen lds
    v_xor_b32 v4, 96, v3
    s_add_u32 s19, s18, 81920
    s_add_u32 m0, s66, 3072
    s_nop 0
    buffer_load_dwordx4 v4, s[48:51], s19 offen lds
    v_xor_b32 v4, 128, v3
    s_add_u32 s19, s18, 32768
    s_add_u32 m0, s66, 4096
    s_nop 0
    buffer_load_dwordx4 v4, s[48:51], s19 offen lds
    v_xor_b32 v4, 160, v3
    s_add_u32 s19, s18, 49152
    s_add_u32 m0, s66, 5120
    s_nop 0
    buffer_load_dwordx4 v4, s[48:51], s19 offen lds
    v_xor_b32 v4, 192, v3
    s_add_u32 s19, s18, 98304
    s_add_u32 m0, s66, 6144
    s_nop 0
    buffer_load_dwordx4 v4, s[48:51], s19 offen lds
    v_xor_b32 v4, 224, v3
    s_add_u32 s19, s18, 114688
    s_add_u32 m0, s66, 7168
    s_nop 0
    buffer_load_dwordx4 v4, s[48:51], s19 offen lds
    v_xor_b32 v4, 0, v3
    s_add_u32 s19, s18, 131072
    s_add_u32 m0, s66, 8192
    s_nop 0
    buffer_load_dwordx4 v4, s[48:51], s19 offen lds
    v_xor_b32 v4, 32, v3
    s_add_u32 s19, s18, 147456
    s_add_u32 m0, s66, 9216
    s_nop 0
    buffer_load_dwordx4 v4, s[48:51], s19 offen lds
    v_xor_b32 v4, 64, v3
    s_add_u32 s19, s18, 196608
    s_add_u32 m0, s66, 10240
    s_nop 0
    buffer_load_dwordx4 v4, s[48:51], s19 offen lds
    v_xor_b32 v4, 96, v3
    s_add_u32 s19, s18, 212992
    s_add_u32 m0, s66, 11264
    s_nop 0
    buffer_load_dwordx4 v4, s[48:51], s19 offen lds
    v_xor_b32 v4, 128, v3
    s_add_u32 s19, s18, 163840
    s_add_u32 m0, s66, 12288
    s_nop 0
    buffer_load_dwordx4 v4, s[48:51], s19 offen lds
    v_xor_b32 v4, 160, v3
    s_add_u32 s19, s18, 180224
    s_add_u32 m0, s66, 13312
    s_nop 0
    buffer_load_dwordx4 v4, s[48:51], s19 offen lds
    v_xor_b32 v4, 192, v3
    s_add_u32 s19, s18, 229376
    s_add_u32 m0, s66, 14336
    s_nop 0
    buffer_load_dwordx4 v4, s[48:51], s19 offen lds
    v_xor_b32 v4, 224, v3
    s_add_u32 s19, s18, 245760
    s_add_u32 m0, s66, 15360
    s_nop 0
    buffer_load_dwordx4 v4, s[48:51], s19 offen lds
    v_and_b32 v10, 15, v9
    v_xor_b32 v10, v10, v8
    v_lshlrev_b32 v10, 4, v10
    v_lshl_add_u32 v6, v9, 9, v10
    v_add_u32 v5, s66, v6
    s_cmp_ge_u32 s60, 16
    s_mov_b32 s18, 114688
    s_cselect_b32 s74, s18, 7168
    s_cselect_b32 s75, 6720, 0
    s_mul_i32 s18, s62, 448
    s_add_u32 s18, s18, 6422528
    s_mul_i32 s65, s60, 401408
    s_cmp_ge_u32 s60, 16
    s_cselect_b32 s65, s18, s65
    s_lshl_b32 s18, s61, 6
    s_add_u32 s18, s18, 0
    v_add_u32 v10, s18, v9
    v_mul_u32_u24 v11, 2341, v10
    v_lshrrev_b32 v11, 16, v11
    v_mul_lo_u32 v11, s75, v11
    v_lshl_add_u32 v11, v10, 4, v11
    v_mul_lo_u32 v10, s74, v8
    v_add_u32 v7, v10, v11
    s_lshl_b32 s18, s61, 6
    s_add_u32 s18, s18, 32
    v_add_u32 v10, s18, v9
    v_mul_u32_u24 v11, 2341, v10
    v_lshrrev_b32 v11, 16, v11
    v_mul_lo_u32 v11, s75, v11
    v_lshl_add_u32 v11, v10, 4, v11
    v_mul_lo_u32 v10, s74, v8
    v_add_u32 v14, v10, v11
    s_lshl_b32 s67, s60, 7
    s_add_u32 s67, s67, 108552192
    v_xor_b32 v224, 0, v5
    v_xor_b32 v225, 32, v5
    v_xor_b32 v226, 64, v5
    v_xor_b32 v227, 96, v5
    v_xor_b32 v228, 128, v5
    v_xor_b32 v229, 160, v5
    v_xor_b32 v230, 192, v5
    v_xor_b32 v231, 224, v5
    s_waitcnt vmcnt(16)
    s_barrier
    s_cmp_ge_u32 s60, 16
    s_cbranch_scc1 Lp_readWo
    v_and_b32 v11, 1, v9
    v_bfe_u32 v10, v9, 3, 1
    v_lshl_or_b32 v11, v10, 4, v11
    v_bfe_u32 v10, v9, 1, 1
    v_lshl_or_b32 v11, v10, 3, v11
    v_bfe_u32 v10, v9, 4, 1
    v_lshl_or_b32 v11, v10, 2, v11
    v_bfe_u32 v10, v9, 2, 1
    v_lshl_or_b32 v11, v10, 1, v11
    v_and_b32 v10, 15, v11
    v_xor_b32 v10, v10, v8
    v_lshlrev_b32 v10, 4, v10
    v_lshl_add_u32 v6, v11, 9, v10
    v_xor_b32 v10, 0, v6
    ds_read_b128 v[16:19], v10 offset:0
    ds_read_b128 v[80:83], v10 offset:16384
    s_lshl_b32 s18, s71, 18
    s_lshl_b32 s19, s62, 9
    s_add_u32 s18, s18, s19
    v_xor_b32 v4, 0, v3
    s_add_u32 s19, s18, 0
    s_add_u32 m0, s66, 16384
    s_nop 0
    buffer_load_dwordx4 v4, s[48:51], s19 offen lds
    v_xor_b32 v10, 32, v6
    ds_read_b128 v[20:23], v10 offset:0
    ds_read_b128 v[84:87], v10 offset:16384
    v_xor_b32 v4, 32, v3
    s_add_u32 s19, s18, 16384
    s_add_u32 m0, s66, 17408
    s_nop 0
    buffer_load_dwordx4 v4, s[48:51], s19 offen lds
    v_xor_b32 v10, 64, v6
    ds_read_b128 v[24:27], v10 offset:0
    ds_read_b128 v[88:91], v10 offset:16384
    v_xor_b32 v4, 64, v3
    s_add_u32 s19, s18, 65536
    s_add_u32 m0, s66, 18432
    s_nop 0
    buffer_load_dwordx4 v4, s[48:51], s19 offen lds
    v_xor_b32 v10, 96, v6
    ds_read_b128 v[28:31], v10 offset:0
    ds_read_b128 v[92:95], v10 offset:16384
    v_xor_b32 v4, 96, v3
    s_add_u32 s19, s18, 81920
    s_add_u32 m0, s66, 19456
    s_nop 0
    buffer_load_dwordx4 v4, s[48:51], s19 offen lds
    s_waitcnt lgkmcnt(4)
    v_xor_b32 v10, 128, v6
    ds_read_b128 v[32:35], v10 offset:0
    ds_read_b128 v[96:99], v10 offset:16384
    v_xor_b32 v4, 128, v3
    s_add_u32 s19, s18, 32768
    s_add_u32 m0, s66, 20480
    s_nop 0
    buffer_load_dwordx4 v4, s[48:51], s19 offen lds
    v_xor_b32 v10, 160, v6
    ds_read_b128 v[36:39], v10 offset:0
    ds_read_b128 v[100:103], v10 offset:16384
    v_xor_b32 v4, 160, v3
    s_add_u32 s19, s18, 49152
    s_add_u32 m0, s66, 21504
    s_nop 0
    buffer_load_dwordx4 v4, s[48:51], s19 offen lds
    v_xor_b32 v10, 192, v6
    ds_read_b128 v[40:43], v10 offset:0
    ds_read_b128 v[104:107], v10 offset:16384
    v_xor_b32 v4, 192, v3
    s_add_u32 s19, s18, 98304
    s_add_u32 m0, s66, 22528
    s_nop 0
    buffer_load_dwordx4 v4, s[48:51], s19 offen lds
    v_xor_b32 v10, 224, v6
    ds_read_b128 v[44:47], v10 offset:0
    ds_read_b128 v[108:111], v10 offset:16384
    v_xor_b32 v4, 224, v3
    s_add_u32 s19, s18, 114688
    s_add_u32 m0, s66, 23552
    s_nop 0
    buffer_load_dwordx4 v4, s[48:51], s19 offen lds
    s_waitcnt lgkmcnt(4)
    v_xor_b32 v10, 0, v6
    ds_read_b128 v[48:51], v10 offset:256
    ds_read_b128 v[112:115], v10 offset:16640
    v_xor_b32 v4, 0, v3
    s_add_u32 s19, s18, 131072
    s_add_u32 m0, s66, 24576
    s_nop 0
    buffer_load_dwordx4 v4, s[48:51], s19 offen lds
    v_xor_b32 v10, 32, v6
    ds_read_b128 v[52:55], v10 offset:256
    ds_read_b128 v[116:119], v10 offset:16640
    v_xor_b32 v4, 32, v3
    s_add_u32 s19, s18, 147456
    s_add_u32 m0, s66, 25600
    s_nop 0
    buffer_load_dwordx4 v4, s[48:51], s19 offen lds
    v_xor_b32 v10, 64, v6
    ds_read_b128 v[56:59], v10 offset:256
    ds_read_b128 v[120:123], v10 offset:16640
    v_xor_b32 v4, 64, v3
    s_add_u32 s19, s18, 196608
    s_add_u32 m0, s66, 26624
    s_nop 0
    buffer_load_dwordx4 v4, s[48:51], s19 offen lds
    v_xor_b32 v10, 96, v6
    ds_read_b128 v[60:63], v10 offset:256
    ds_read_b128 v[124:127], v10 offset:16640
    v_xor_b32 v4, 96, v3
    s_add_u32 s19, s18, 212992
    s_add_u32 m0, s66, 27648
    s_nop 0
    buffer_load_dwordx4 v4, s[48:51], s19 offen lds
    s_waitcnt lgkmcnt(4)
    v_xor_b32 v10, 128, v6
    ds_read_b128 v[64:67], v10 offset:256
    ds_read_b128 v[128:131], v10 offset:16640
    v_xor_b32 v4, 128, v3
    s_add_u32 s19, s18, 163840
    s_add_u32 m0, s66, 28672
    s_nop 0
    buffer_load_dwordx4 v4, s[48:51], s19 offen lds
    v_xor_b32 v10, 160, v6
    ds_read_b128 v[68:71], v10 offset:256
    ds_read_b128 v[132:135], v10 offset:16640
    v_xor_b32 v4, 160, v3
    s_add_u32 s19, s18, 180224
    s_add_u32 m0, s66, 29696
    s_nop 0
    buffer_load_dwordx4 v4, s[48:51], s19 offen lds
    v_xor_b32 v10, 192, v6
    ds_read_b128 v[72:75], v10 offset:256
    ds_read_b128 v[136:139], v10 offset:16640
    v_xor_b32 v4, 192, v3
    s_add_u32 s19, s18, 229376
    s_add_u32 m0, s66, 30720
    s_nop 0
    buffer_load_dwordx4 v4, s[48:51], s19 offen lds
    v_xor_b32 v10, 224, v6
    ds_read_b128 v[76:79], v10 offset:256
    ds_read_b128 v[140:143], v10 offset:16640
    v_xor_b32 v4, 224, v3
    s_add_u32 s19, s18, 245760
    s_add_u32 m0, s66, 31744
    s_nop 0
    buffer_load_dwordx4 v4, s[48:51], s19 offen lds
    s_waitcnt lgkmcnt(4)
    s_branch Lp_gotB
Lp_readWo:
    v_bfe_u32 v10, v2, 2, 2
    v_lshl_add_u32 v10, v8, 3, v10
    v_lshlrev_b32 v11, 7, v10
    v_bfe_u32 v10, v2, 4, 1
    v_lshl_add_u32 v11, v10, 5, v11
    v_and_b32 v10, 3, v2
    v_lshl_add_u32 v11, v10, 3, v11
    ds_read_b64_tr_b16 v[16:17], v11 offset:0
    ds_read_b64_tr_b16 v[18:19], v11 offset:512
    ds_read_b64_tr_b16 v[80:81], v11 offset:64
    ds_read_b64_tr_b16 v[82:83], v11 offset:576
    s_lshl_b32 s18, s71, 18
    s_lshl_b32 s19, s62, 9
    s_add_u32 s18, s18, s19
    v_xor_b32 v4, 0, v3
    s_add_u32 s19, s18, 0
    s_add_u32 m0, s66, 16384
    s_nop 0
    buffer_load_dwordx4 v4, s[48:51], s19 offen lds
    ds_read_b64_tr_b16 v[20:21], v11 offset:2048
    ds_read_b64_tr_b16 v[22:23], v11 offset:2560
    ds_read_b64_tr_b16 v[84:85], v11 offset:2112
    ds_read_b64_tr_b16 v[86:87], v11 offset:2624
    v_xor_b32 v4, 32, v3
    s_add_u32 s19, s18, 16384
    s_add_u32 m0, s66, 17408
    s_nop 0
    buffer_load_dwordx4 v4, s[48:51], s19 offen lds
    s_waitcnt lgkmcnt(4)
    ds_read_b64_tr_b16 v[24:25], v11 offset:4096
    ds_read_b64_tr_b16 v[26:27], v11 offset:4608
    ds_read_b64_tr_b16 v[88:89], v11 offset:4160
    ds_read_b64_tr_b16 v[90:91], v11 offset:4672
    v_xor_b32 v4, 64, v3
    s_add_u32 s19, s18, 65536
    s_add_u32 m0, s66, 18432
    s_nop 0
    buffer_load_dwordx4 v4, s[48:51], s19 offen lds
    ds_read_b64_tr_b16 v[28:29], v11 offset:6144
    ds_read_b64_tr_b16 v[30:31], v11 offset:6656
    ds_read_b64_tr_b16 v[92:93], v11 offset:6208
    ds_read_b64_tr_b16 v[94:95], v11 offset:6720
    v_xor_b32 v4, 96, v3
    s_add_u32 s19, s18, 81920
    s_add_u32 m0, s66, 19456
    s_nop 0
    buffer_load_dwordx4 v4, s[48:51], s19 offen lds
    s_waitcnt lgkmcnt(4)
    ds_read_b64_tr_b16 v[32:33], v11 offset:8192
    ds_read_b64_tr_b16 v[34:35], v11 offset:8704
    ds_read_b64_tr_b16 v[96:97], v11 offset:8256
    ds_read_b64_tr_b16 v[98:99], v11 offset:8768
    v_xor_b32 v4, 128, v3
    s_add_u32 s19, s18, 32768
    s_add_u32 m0, s66, 20480
    s_nop 0
    buffer_load_dwordx4 v4, s[48:51], s19 offen lds
    ds_read_b64_tr_b16 v[36:37], v11 offset:10240
    ds_read_b64_tr_b16 v[38:39], v11 offset:10752
    ds_read_b64_tr_b16 v[100:101], v11 offset:10304
    ds_read_b64_tr_b16 v[102:103], v11 offset:10816
    v_xor_b32 v4, 160, v3
    s_add_u32 s19, s18, 49152
    s_add_u32 m0, s66, 21504
    s_nop 0
    buffer_load_dwordx4 v4, s[48:51], s19 offen lds
    s_waitcnt lgkmcnt(4)
    ds_read_b64_tr_b16 v[40:41], v11 offset:12288
    ds_read_b64_tr_b16 v[42:43], v11 offset:12800
    ds_read_b64_tr_b16 v[104:105], v11 offset:12352
    ds_read_b64_tr_b16 v[106:107], v11 offset:12864
    v_xor_b32 v4, 192, v3
    s_add_u32 s19, s18, 98304
    s_add_u32 m0, s66, 22528
    s_nop 0
    buffer_load_dwordx4 v4, s[48:51], s19 offen lds
    ds_read_b64_tr_b16 v[44:45], v11 offset:14336
    ds_read_b64_tr_b16 v[46:47], v11 offset:14848
    ds_read_b64_tr_b16 v[108:109], v11 offset:14400
    ds_read_b64_tr_b16 v[110:111], v11 offset:14912
    v_xor_b32 v4, 224, v3
    s_add_u32 s19, s18, 114688
    s_add_u32 m0, s66, 23552
    s_nop 0
    buffer_load_dwordx4 v4, s[48:51], s19 offen lds
    s_waitcnt lgkmcnt(4)
    ds_read_b64_tr_b16 v[48:49], v11 offset:16384
    ds_read_b64_tr_b16 v[50:51], v11 offset:16896
    ds_read_b64_tr_b16 v[112:113], v11 offset:16448
    ds_read_b64_tr_b16 v[114:115], v11 offset:16960
    v_xor_b32 v4, 0, v3
    s_add_u32 s19, s18, 131072
    s_add_u32 m0, s66, 24576
    s_nop 0
    buffer_load_dwordx4 v4, s[48:51], s19 offen lds
    ds_read_b64_tr_b16 v[52:53], v11 offset:18432
    ds_read_b64_tr_b16 v[54:55], v11 offset:18944
    ds_read_b64_tr_b16 v[116:117], v11 offset:18496
    ds_read_b64_tr_b16 v[118:119], v11 offset:19008
    v_xor_b32 v4, 32, v3
    s_add_u32 s19, s18, 147456
    s_add_u32 m0, s66, 25600
    s_nop 0
    buffer_load_dwordx4 v4, s[48:51], s19 offen lds
    s_waitcnt lgkmcnt(4)
    ds_read_b64_tr_b16 v[56:57], v11 offset:20480
    ds_read_b64_tr_b16 v[58:59], v11 offset:20992
    ds_read_b64_tr_b16 v[120:121], v11 offset:20544
    ds_read_b64_tr_b16 v[122:123], v11 offset:21056
    v_xor_b32 v4, 64, v3
    s_add_u32 s19, s18, 196608
    s_add_u32 m0, s66, 26624
    s_nop 0
    buffer_load_dwordx4 v4, s[48:51], s19 offen lds
    ds_read_b64_tr_b16 v[60:61], v11 offset:22528
    ds_read_b64_tr_b16 v[62:63], v11 offset:23040
    ds_read_b64_tr_b16 v[124:125], v11 offset:22592
    ds_read_b64_tr_b16 v[126:127], v11 offset:23104
    v_xor_b32 v4, 96, v3
    s_add_u32 s19, s18, 212992
    s_add_u32 m0, s66, 27648
    s_nop 0
    buffer_load_dwordx4 v4, s[48:51], s19 offen lds
    s_waitcnt lgkmcnt(4)
    ds_read_b64_tr_b16 v[64:65], v11 offset:24576
    ds_read_b64_tr_b16 v[66:67], v11 offset:25088
    ds_read_b64_tr_b16 v[128:129], v11 offset:24640
    ds_read_b64_tr_b16 v[130:131], v11 offset:25152
    v_xor_b32 v4, 128, v3
    s_add_u32 s19, s18, 163840
    s_add_u32 m0, s66, 28672
    s_nop 0
    buffer_load_dwordx4 v4, s[48:51], s19 offen lds
    ds_read_b64_tr_b16 v[68:69], v11 offset:26624
    ds_read_b64_tr_b16 v[70:71], v11 offset:27136
    ds_read_b64_tr_b16 v[132:133], v11 offset:26688
    ds_read_b64_tr_b16 v[134:135], v11 offset:27200
    v_xor_b32 v4, 160, v3
    s_add_u32 s19, s18, 180224
    s_add_u32 m0, s66, 29696
    s_nop 0
    buffer_load_dwordx4 v4, s[48:51], s19 offen lds
    s_waitcnt lgkmcnt(4)
    ds_read_b64_tr_b16 v[72:73], v11 offset:28672
    ds_read_b64_tr_b16 v[74:75], v11 offset:29184
    ds_read_b64_tr_b16 v[136:137], v11 offset:28736
    ds_read_b64_tr_b16 v[138:139], v11 offset:29248
    v_xor_b32 v4, 192, v3
    s_add_u32 s19, s18, 229376
    s_add_u32 m0, s66, 30720
    s_nop 0
    buffer_load_dwordx4 v4, s[48:51], s19 offen lds
    ds_read_b64_tr_b16 v[76:77], v11 offset:30720
    ds_read_b64_tr_b16 v[78:79], v11 offset:31232
    ds_read_b64_tr_b16 v[140:141], v11 offset:30784
    ds_read_b64_tr_b16 v[142:143], v11 offset:31296
    v_xor_b32 v4, 224, v3
    s_add_u32 s19, s18, 245760
    s_add_u32 m0, s66, 31744
    s_nop 0
    buffer_load_dwordx4 v4, s[48:51], s19 offen lds
    s_waitcnt lgkmcnt(4)
Lp_gotB:
    s_waitcnt vmcnt(16) lgkmcnt(0)
    ds_read_b128 a[0:3], v224 offset:0
    ds_read_b128 a[4:7], v225 offset:0
    ds_read_b128 a[8:11], v226 offset:0
    ds_read_b128 a[12:15], v227 offset:0
    ds_read_b128 a[16:19], v228 offset:0
    ds_read_b128 a[20:23], v229 offset:0
    ds_read_b128 a[24:27], v230 offset:0
    ds_read_b128 a[28:31], v231 offset:0
    s_waitcnt lgkmcnt(4)
    ds_read_b128 a[32:35], v224 offset:256
    ds_read_b128 a[36:39], v225 offset:256
    ds_read_b128 a[40:43], v226 offset:256
    ds_read_b128 a[44:47], v227 offset:256
    ds_read_b128 a[48:51], v228 offset:256
    ds_read_b128 a[52:55], v229 offset:256
    ds_read_b128 a[56:59], v230 offset:256
    ds_read_b128 a[60:63], v231 offset:256
    s_waitcnt lgkmcnt(0)
    v_mfma_f32_32x32x16_bf16 v[144:159], a[0:3], v[16:19], 0
    s_lshl_b32 s18, s72, 18
    s_lshl_b32 s19, s62, 9
    s_add_u32 s18, s18, s19
    v_xor_b32 v4, 0, v3
    s_add_u32 s19, s18, 0
    s_add_u32 m0, s66, 0
    s_nop 0
    buffer_load_dwordx4 v4, s[48:51], s19 offen lds
    v_mfma_f32_32x32x16_bf16 v[160:175], a[0:3], v[80:83], 0
    v_xor_b32 v4, 32, v3
    s_add_u32 s19, s18, 16384
    s_add_u32 m0, s66, 1024
    s_nop 0
    buffer_load_dwordx4 v4, s[48:51], s19 offen lds
    v_mfma_f32_32x32x16_bf16 v[144:159], a[4:7], v[20:23], v[144:159]
    v_xor_b32 v4, 64, v3
    s_add_u32 s19, s18, 65536
    s_add_u32 m0, s66, 2048
    s_nop 0
    buffer_load_dwordx4 v4, s[48:51], s19 offen lds
    v_mfma_f32_32x32x16_bf16 v[160:175], a[4:7], v[84:87], v[160:175]
    v_xor_b32 v4, 96, v3
    s_add_u32 s19, s18, 81920
    s_add_u32 m0, s66, 3072
    s_nop 0
    buffer_load_dwordx4 v4, s[48:51], s19 offen lds
    v_mfma_f32_32x32x16_bf16 v[144:159], a[8:11], v[24:27], v[144:159]
    v_xor_b32 v4, 128, v3
    s_add_u32 s19, s18, 32768
    s_add_u32 m0, s66, 4096
    s_nop 0
    buffer_load_dwordx4 v4, s[48:51], s19 offen lds
    v_mfma_f32_32x32x16_bf16 v[160:175], a[8:11], v[88:91], v[160:175]
    v_xor_b32 v4, 160, v3
    s_add_u32 s19, s18, 49152
    s_add_u32 m0, s66, 5120
    s_nop 0
    buffer_load_dwordx4 v4, s[48:51], s19 offen lds
    v_mfma_f32_32x32x16_bf16 v[144:159], a[12:15], v[28:31], v[144:159]
    v_xor_b32 v4, 192, v3
    s_add_u32 s19, s18, 98304
    s_add_u32 m0, s66, 6144
    s_nop 0
    buffer_load_dwordx4 v4, s[48:51], s19 offen lds
    v_mfma_f32_32x32x16_bf16 v[160:175], a[12:15], v[92:95], v[160:175]
    v_xor_b32 v4, 224, v3
    s_add_u32 s19, s18, 114688
    s_add_u32 m0, s66, 7168
    s_nop 0
    buffer_load_dwordx4 v4, s[48:51], s19 offen lds
    v_mfma_f32_32x32x16_bf16 v[144:159], a[16:19], v[32:35], v[144:159]
    v_xor_b32 v4, 0, v3
    s_add_u32 s19, s18, 131072
    s_add_u32 m0, s66, 8192
    s_nop 0
    buffer_load_dwordx4 v4, s[48:51], s19 offen lds
    v_mfma_f32_32x32x16_bf16 v[160:175], a[16:19], v[96:99], v[160:175]
    v_xor_b32 v4, 32, v3
    s_add_u32 s19, s18, 147456
    s_add_u32 m0, s66, 9216
    s_nop 0
    buffer_load_dwordx4 v4, s[48:51], s19 offen lds
    v_mfma_f32_32x32x16_bf16 v[144:159], a[20:23], v[36:39], v[144:159]
    v_xor_b32 v4, 64, v3
    s_add_u32 s19, s18, 196608
    s_add_u32 m0, s66, 10240
    s_nop 0
    buffer_load_dwordx4 v4, s[48:51], s19 offen lds
    v_mfma_f32_32x32x16_bf16 v[160:175], a[20:23], v[100:103], v[160:175]
    v_xor_b32 v4, 96, v3
    s_add_u32 s19, s18, 212992
    s_add_u32 m0, s66, 11264
    s_nop 0
    buffer_load_dwordx4 v4, s[48:51], s19 offen lds
    v_mfma_f32_32x32x16_bf16 v[144:159], a[24:27], v[40:43], v[144:159]
    v_xor_b32 v4, 128, v3
    s_add_u32 s19, s18, 163840
    s_add_u32 m0, s66, 12288
    s_nop 0
    buffer_load_dwordx4 v4, s[48:51], s19 offen lds
    v_mfma_f32_32x32x16_bf16 v[160:175], a[24:27], v[104:107], v[160:175]
    v_xor_b32 v4, 160, v3
    s_add_u32 s19, s18, 180224
    s_add_u32 m0, s66, 13312
    s_nop 0
    buffer_load_dwordx4 v4, s[48:51], s19 offen lds
    v_mfma_f32_32x32x16_bf16 v[144:159], a[28:31], v[44:47], v[144:159]
    v_xor_b32 v4, 192, v3
    s_add_u32 s19, s18, 229376
    s_add_u32 m0, s66, 14336
    s_nop 0
    buffer_load_dwordx4 v4, s[48:51], s19 offen lds
    v_mfma_f32_32x32x16_bf16 v[160:175], a[28:31], v[108:111], v[160:175]
    v_xor_b32 v4, 224, v3
    s_add_u32 s19, s18, 245760
    s_add_u32 m0, s66, 15360
    s_nop 0
    buffer_load_dwordx4 v4, s[48:51], s19 offen lds
    v_mfma_f32_32x32x16_bf16 v[144:159], a[32:35], v[48:51], v[144:159]
    s_waitcnt vmcnt(16)
    ds_read_b128 a[64:67], v224 offset:16384
    v_mfma_f32_32x32x16_bf16 v[160:175], a[32:35], v[112:115], v[160:175]
    ds_read_b128 a[68:71], v225 offset:16384
    v_mfma_f32_32x32x16_bf16 v[144:159], a[36:39], v[52:55], v[144:159]
    ds_read_b128 a[72:75], v226 offset:16384
    v_mfma_f32_32x32x16_bf16 v[160:175], a[36:39], v[116:119], v[160:175]
    ds_read_b128 a[76:79], v227 offset:16384
    v_mfma_f32_32x32x16_bf16 v[144:159], a[40:43], v[56:59], v[144:159]
    ds_read_b128 a[80:83], v228 offset:16384
    v_mfma_f32_32x32x16_bf16 v[160:175], a[40:43], v[120:123], v[160:175]
    ds_read_b128 a[84:87], v229 offset:16384
    v_mfma_f32_32x32x16_bf16 v[144:159], a[44:47], v[60:63], v[144:159]
    ds_read_b128 a[88:91], v230 offset:16384
    v_mfma_f32_32x32x16_bf16 v[160:175], a[44:47], v[124:127], v[160:175]
    ds_read_b128 a[92:95], v231 offset:16384
    v_mfma_f32_32x32x16_bf16 v[144:159], a[48:51], v[64:67], v[144:159]
    ds_read_b128 a[96:99], v224 offset:16640
    v_mfma_f32_32x32x16_bf16 v[160:175], a[48:51], v[128:131], v[160:175]
    ds_read_b128 a[100:103], v225 offset:16640
    v_mfma_f32_32x32x16_bf16 v[144:159], a[52:55], v[68:71], v[144:159]
    ds_read_b128 a[104:107], v226 offset:16640
    v_mfma_f32_32x32x16_bf16 v[160:175], a[52:55], v[132:135], v[160:175]
    ds_read_b128 a[108:111], v227 offset:16640
    v_mfma_f32_32x32x16_bf16 v[144:159], a[56:59], v[72:75], v[144:159]
    ds_read_b128 a[112:115], v228 offset:16640
    v_mfma_f32_32x32x16_bf16 v[160:175], a[56:59], v[136:139], v[160:175]
    ds_read_b128 a[116:119], v229 offset:16640
    v_mfma_f32_32x32x16_bf16 v[144:159], a[60:63], v[76:79], v[144:159]
    ds_read_b128 a[120:123], v230 offset:16640
    v_mfma_f32_32x32x16_bf16 v[160:175], a[60:63], v[140:143], v[160:175]
    ds_read_b128 a[124:127], v231 offset:16640
    s_waitcnt lgkmcnt(0)
    v_mfma_f32_32x32x16_bf16 v[176:191], a[64:67], v[16:19], 0
    s_lshl_b32 s18, s73, 18
    s_lshl_b32 s19, s62, 9
    s_add_u32 s18, s18, s19
    v_xor_b32 v4, 0, v3
    s_add_u32 s19, s18, 0
    s_add_u32 m0, s66, 16384
    s_nop 0
    buffer_load_dwordx4 v4, s[48:51], s19 offen lds
    v_mfma_f32_32x32x16_bf16 v[192:207], a[64:67], v[80:83], 0
    v_xor_b32 v4, 32, v3
    s_add_u32 s19, s18, 16384
    s_add_u32 m0, s66, 17408
    s_nop 0
    buffer_load_dwordx4 v4, s[48:51], s19 offen lds
    v_mfma_f32_32x32x16_bf16 v[176:191], a[68:71], v[20:23], v[176:191]
    v_xor_b32 v4, 64, v3
    s_add_u32 s19, s18, 65536
    s_add_u32 m0, s66, 18432
    s_nop 0
    buffer_load_dwordx4 v4, s[48:51], s19 offen lds
    v_mul_f32 v144, s68, v144
    v_mul_f32 v145, s68, v145
    v_mul_f32 v146, s68, v146
    v_mul_f32 v147, s68, v147
    v_mfma_f32_32x32x16_bf16 v[192:207], a[68:71], v[84:87], v[192:207]
    v_xor_b32 v4, 96, v3
    s_add_u32 s19, s18, 81920
    s_add_u32 m0, s66, 19456
    s_nop 0
    buffer_load_dwordx4 v4, s[48:51], s19 offen lds
    v_mul_f32 v148, s68, v148
    v_mul_f32 v149, s68, v149
    v_mul_f32 v150, s68, v150
    v_mul_f32 v151, s68, v151
    v_mfma_f32_32x32x16_bf16 v[176:191], a[72:75], v[24:27], v[176:191]
    v_xor_b32 v4, 128, v3
    s_add_u32 s19, s18, 32768
    s_add_u32 m0, s66, 20480
    s_nop 0
    buffer_load_dwordx4 v4, s[48:51], s19 offen lds
    v_mul_f32 v152, s68, v152
    v_mul_f32 v153, s68, v153
    v_mul_f32 v154, s68, v154
    v_mul_f32 v155, s68, v155
    v_mfma_f32_32x32x16_bf16 v[192:207], a[72:75], v[88:91], v[192:207]
    v_xor_b32 v4, 160, v3
    s_add_u32 s19, s18, 49152
    s_add_u32 m0, s66, 21504
    s_nop 0
    buffer_load_dwordx4 v4, s[48:51], s19 offen lds
    v_mul_f32 v156, s68, v156
    v_mul_f32 v157, s68, v157
    v_mul_f32 v158, s68, v158
    v_mul_f32 v159, s68, v159
    v_mfma_f32_32x32x16_bf16 v[176:191], a[76:79], v[28:31], v[176:191]
    v_xor_b32 v4, 192, v3
    s_add_u32 s19, s18, 98304
    s_add_u32 m0, s66, 22528
    s_nop 0
    buffer_load_dwordx4 v4, s[48:51], s19 offen lds
    v_mul_f32 v160, s68, v160
    v_mul_f32 v161, s68, v161
    v_mul_f32 v162, s68, v162
    v_mul_f32 v163, s68, v163
    v_mfma_f32_32x32x16_bf16 v[192:207], a[76:79], v[92:95], v[192:207]
    v_xor_b32 v4, 224, v3
    s_add_u32 s19, s18, 114688
    s_add_u32 m0, s66, 23552
    s_nop 0
    buffer_load_dwordx4 v4, s[48:51], s19 offen lds
    v_mul_f32 v164, s68, v164
    v_mul_f32 v165, s68, v165
    v_mul_f32 v166, s68, v166
    v_mul_f32 v167, s68, v167
    v_mfma_f32_32x32x16_bf16 v[176:191], a[80:83], v[32:35], v[176:191]
    v_xor_b32 v4, 0, v3
    s_add_u32 s19, s18, 131072
    s_add_u32 m0, s66, 24576
    s_nop 0
    buffer_load_dwordx4 v4, s[48:51], s19 offen lds
    v_mul_f32 v168, s68, v168
    v_mul_f32 v169, s68, v169
    v_mul_f32 v170, s68, v170
    v_mul_f32 v171, s68, v171
    v_mfma_f32_32x32x16_bf16 v[192:207], a[80:83], v[96:99], v[192:207]
    v_xor_b32 v4, 32, v3
    s_add_u32 s19, s18, 147456
    s_add_u32 m0, s66, 25600
    s_nop 0
    buffer_load_dwordx4 v4, s[48:51], s19 offen lds
    v_mul_f32 v172, s68, v172
    v_mul_f32 v173, s68, v173
    v_mul_f32 v174, s68, v174
    v_mul_f32 v175, s68, v175
    v_mfma_f32_32x32x16_bf16 v[176:191], a[84:87], v[36:39], v[176:191]
    v_xor_b32 v4, 64, v3
    s_add_u32 s19, s18, 196608
    s_add_u32 m0, s66, 26624
    s_nop 0
    buffer_load_dwordx4 v4, s[48:51], s19 offen lds
    v_cvt_pk_bf16_f32 v208, v144, v145
    v_cvt_pk_bf16_f32 v209, v146, v147
    v_cvt_pk_bf16_f32 v210, v148, v149
    v_cvt_pk_bf16_f32 v211, v150, v151
    v_mfma_f32_32x32x16_bf16 v[192:207], a[84:87], v[100:103], v[192:207]
    v_xor_b32 v4, 96, v3
    s_add_u32 s19, s18, 212992
    s_add_u32 m0, s66, 27648
    s_nop 0
    buffer_load_dwordx4 v4, s[48:51], s19 offen lds
    v_cvt_pk_bf16_f32 v212, v152, v153
    v_cvt_pk_bf16_f32 v213, v154, v155
    v_cvt_pk_bf16_f32 v214, v156, v157
    v_cvt_pk_bf16_f32 v215, v158, v159
    v_mfma_f32_32x32x16_bf16 v[176:191], a[88:91], v[40:43], v[176:191]
    v_xor_b32 v4, 128, v3
    s_add_u32 s19, s18, 163840
    s_add_u32 m0, s66, 28672
    s_nop 0
    buffer_load_dwordx4 v4, s[48:51], s19 offen lds
    v_cvt_pk_bf16_f32 v216, v160, v161
    v_cvt_pk_bf16_f32 v217, v162, v163
    v_cvt_pk_bf16_f32 v218, v164, v165
    v_cvt_pk_bf16_f32 v219, v166, v167
    v_mfma_f32_32x32x16_bf16 v[192:207], a[88:91], v[104:107], v[192:207]
    v_xor_b32 v4, 160, v3
    s_add_u32 s19, s18, 180224
    s_add_u32 m0, s66, 29696
    s_nop 0
    buffer_load_dwordx4 v4, s[48:51], s19 offen lds
    v_cvt_pk_bf16_f32 v220, v168, v169
    v_cvt_pk_bf16_f32 v221, v170, v171
    v_cvt_pk_bf16_f32 v222, v172, v173
    v_cvt_pk_bf16_f32 v223, v174, v175
    v_mfma_f32_32x32x16_bf16 v[176:191], a[92:95], v[44:47], v[176:191]
    v_xor_b32 v4, 192, v3
    s_add_u32 s19, s18, 229376
    s_add_u32 m0, s66, 30720
    s_nop 0
    buffer_load_dwordx4 v4, s[48:51], s19 offen lds
    v_mfma_f32_32x32x16_bf16 v[192:207], a[92:95], v[108:111], v[192:207]
    v_xor_b32 v4, 224, v3
    s_add_u32 s19, s18, 245760
    s_add_u32 m0, s66, 31744
    s_nop 0
    buffer_load_dwordx4 v4, s[48:51], s19 offen lds
    s_mul_i32 s20, s70, s74
    s_lshl_b32 s20, s20, 2
    s_add_u32 s20, s20, s65
    s_lshl_b32 s21, s74, 1
    s_add_u32 s21, s21, s20
    buffer_store_dwordx4 v[208:211], v7, s[8:11], s20 offen sc1
    buffer_store_dwordx4 v[212:215], v7, s[8:11], s21 offen sc1
    buffer_store_dwordx4 v[216:219], v14, s[8:11], s20 offen sc1
    buffer_store_dwordx4 v[220:223], v14, s[8:11], s21 offen sc1
    v_mfma_f32_32x32x16_bf16 v[176:191], a[96:99], v[48:51], v[176:191]
    s_waitcnt vmcnt(20)
    ds_read_b128 a[0:3], v224 offset:0
    v_mfma_f32_32x32x16_bf16 v[192:207], a[96:99], v[112:115], v[192:207]
    ds_read_b128 a[4:7], v225 offset:0
    v_mfma_f32_32x32x16_bf16 v[176:191], a[100:103], v[52:55], v[176:191]
    ds_read_b128 a[8:11], v226 offset:0
    v_mfma_f32_32x32x16_bf16 v[192:207], a[100:103], v[116:119], v[192:207]
    ds_read_b128 a[12:15], v227 offset:0
    v_mfma_f32_32x32x16_bf16 v[176:191], a[104:107], v[56:59], v[176:191]
    ds_read_b128 a[16:19], v228 offset:0
    v_mfma_f32_32x32x16_bf16 v[192:207], a[104:107], v[120:123], v[192:207]
    ds_read_b128 a[20:23], v229 offset:0
    v_mfma_f32_32x32x16_bf16 v[176:191], a[108:111], v[60:63], v[176:191]
    ds_read_b128 a[24:27], v230 offset:0
    v_mfma_f32_32x32x16_bf16 v[192:207], a[108:111], v[124:127], v[192:207]
    ds_read_b128 a[28:31], v231 offset:0
    v_mfma_f32_32x32x16_bf16 v[176:191], a[112:115], v[64:67], v[176:191]
    ds_read_b128 a[32:35], v224 offset:256
    v_mfma_f32_32x32x16_bf16 v[192:207], a[112:115], v[128:131], v[192:207]
    ds_read_b128 a[36:39], v225 offset:256
    v_mfma_f32_32x32x16_bf16 v[176:191], a[116:119], v[68:71], v[176:191]
    ds_read_b128 a[40:43], v226 offset:256
    v_mfma_f32_32x32x16_bf16 v[192:207], a[116:119], v[132:135], v[192:207]
    ds_read_b128 a[44:47], v227 offset:256
    v_mfma_f32_32x32x16_bf16 v[176:191], a[120:123], v[72:75], v[176:191]
    ds_read_b128 a[48:51], v228 offset:256
    v_mfma_f32_32x32x16_bf16 v[192:207], a[120:123], v[136:139], v[192:207]
    ds_read_b128 a[52:55], v229 offset:256
    v_mfma_f32_32x32x16_bf16 v[176:191], a[124:127], v[76:79], v[176:191]
    ds_read_b128 a[56:59], v230 offset:256
    v_mfma_f32_32x32x16_bf16 v[192:207], a[124:127], v[140:143], v[192:207]
    ds_read_b128 a[60:63], v231 offset:256
    s_waitcnt lgkmcnt(0)
    v_mfma_f32_32x32x16_bf16 v[144:159], a[0:3], v[16:19], 0
    v_mfma_f32_32x32x16_bf16 v[160:175], a[0:3], v[80:83], 0
    v_mfma_f32_32x32x16_bf16 v[144:159], a[4:7], v[20:23], v[144:159]
    s_nop 4
    v_mul_f32 v176, s68, v176
    v_mul_f32 v177, s68, v177
    v_mul_f32 v178, s68, v178
    v_mul_f32 v179, s68, v179
    v_mfma_f32_32x32x16_bf16 v[160:175], a[4:7], v[84:87], v[160:175]
    v_mul_f32 v180, s68, v180
    v_mul_f32 v181, s68, v181
    v_mul_f32 v182, s68, v182
    v_mul_f32 v183, s68, v183
    v_mfma_f32_32x32x16_bf16 v[144:159], a[8:11], v[24:27], v[144:159]
    v_mul_f32 v184, s68, v184
    v_mul_f32 v185, s68, v185
    v_mul_f32 v186, s68, v186
    v_mul_f32 v187, s68, v187
    v_mfma_f32_32x32x16_bf16 v[160:175], a[8:11], v[88:91], v[160:175]
    v_mul_f32 v188, s68, v188
    v_mul_f32 v189, s68, v189
    v_mul_f32 v190, s68, v190
    v_mul_f32 v191, s68, v191
    v_mfma_f32_32x32x16_bf16 v[144:159], a[12:15], v[28:31], v[144:159]
    v_mul_f32 v192, s68, v192
    v_mul_f32 v193, s68, v193
    v_mul_f32 v194, s68, v194
    v_mul_f32 v195, s68, v195
    v_mfma_f32_32x32x16_bf16 v[160:175], a[12:15], v[92:95], v[160:175]
    v_mul_f32 v196, s68, v196
    v_mul_f32 v197, s68, v197
    v_mul_f32 v198, s68, v198
    v_mul_f32 v199, s68, v199
    v_mfma_f32_32x32x16_bf16 v[144:159], a[16:19], v[32:35], v[144:159]
    v_mul_f32 v200, s68, v200
    v_mul_f32 v201, s68, v201
    v_mul_f32 v202, s68, v202
    v_mul_f32 v203, s68, v203
    v_mfma_f32_32x32x16_bf16 v[160:175], a[16:19], v[96:99], v[160:175]
    v_mul_f32 v204, s68, v204
    v_mul_f32 v205, s68, v205
    v_mul_f32 v206, s68, v206
    v_mul_f32 v207, s68, v207
    v_mfma_f32_32x32x16_bf16 v[144:159], a[20:23], v[36:39], v[144:159]
    v_cvt_pk_bf16_f32 v208, v176, v177
    v_cvt_pk_bf16_f32 v209, v178, v179
    v_cvt_pk_bf16_f32 v210, v180, v181
    v_cvt_pk_bf16_f32 v211, v182, v183
    v_mfma_f32_32x32x16_bf16 v[160:175], a[20:23], v[100:103], v[160:175]
    v_cvt_pk_bf16_f32 v212, v184, v185
    v_cvt_pk_bf16_f32 v213, v186, v187
    v_cvt_pk_bf16_f32 v214, v188, v189
    v_cvt_pk_bf16_f32 v215, v190, v191
    v_mfma_f32_32x32x16_bf16 v[144:159], a[24:27], v[40:43], v[144:159]
    v_cvt_pk_bf16_f32 v216, v192, v193
    v_cvt_pk_bf16_f32 v217, v194, v195
    v_cvt_pk_bf16_f32 v218, v196, v197
    v_cvt_pk_bf16_f32 v219, v198, v199
    v_mfma_f32_32x32x16_bf16 v[160:175], a[24:27], v[104:107], v[160:175]
    v_cvt_pk_bf16_f32 v220, v200, v201
    v_cvt_pk_bf16_f32 v221, v202, v203
    v_cvt_pk_bf16_f32 v222, v204, v205
    v_cvt_pk_bf16_f32 v223, v206, v207
    v_mfma_f32_32x32x16_bf16 v[144:159], a[28:31], v[44:47], v[144:159]
    v_mfma_f32_32x32x16_bf16 v[160:175], a[28:31], v[108:111], v[160:175]
    s_mul_i32 s20, s71, s74
    s_lshl_b32 s20, s20, 2
    s_add_u32 s20, s20, s65
    s_lshl_b32 s21, s74, 1
    s_add_u32 s21, s21, s20
    buffer_store_dwordx4 v[208:211], v7, s[8:11], s20 offen sc1
    buffer_store_dwordx4 v[212:215], v7, s[8:11], s21 offen sc1
    buffer_store_dwordx4 v[216:219], v14, s[8:11], s20 offen sc1
    buffer_store_dwordx4 v[220:223], v14, s[8:11], s21 offen sc1
    v_mfma_f32_32x32x16_bf16 v[144:159], a[32:35], v[48:51], v[144:159]
    s_waitcnt vmcnt(8)
    ds_read_b128 a[64:67], v224 offset:16384
    v_mfma_f32_32x32x16_bf16 v[160:175], a[32:35], v[112:115], v[160:175]
    ds_read_b128 a[68:71], v225 offset:16384
    v_mfma_f32_32x32x16_bf16 v[144:159], a[36:39], v[52:55], v[144:159]
    ds_read_b128 a[72:75], v226 offset:16384
    v_mfma_f32_32x32x16_bf16 v[160:175], a[36:39], v[116:119], v[160:175]
    ds_read_b128 a[76:79], v227 offset:16384
    v_mov_b32 v232, -1
    v_mov_b32 v236, 0
    v_mov_b32 v233, -1
    v_mov_b32 v237, 0
    v_mov_b32 v234, -1
    v_mov_b32 v238, 0
    v_mov_b32 v235, -1
    v_mov_b32 v239, 0
    v_lshlrev_b32 v240, 4, v0
    s_lshl_b32 s19, s3, 12
    s_add_u32 s56, s4, 106961920
    s_addc_u32 s57, s5, 0
    s_and_b32 s57, s57, 0xffff
    s_mov_b32 s58, 1106944
    s_mov_b32 s59, 0x20000
    s_add_u32 s20, s19, 0
    buffer_store_dwordx4 v[232:235], v240, s[56:59], s20 offen sc1
    s_add_u32 s20, s19, 1048576
    buffer_store_dwordx4 v[232:235], v240, s[56:59], s20 offen sc1
    s_add_u32 s56, s4, 108076032
    s_addc_u32 s57, s5, 0
    s_and_b32 s57, s57, 0xffff
    s_mov_b32 s58, 451584
    s_mov_b32 s59, 0x20000
    s_add_u32 s20, s19, 0
    buffer_store_dwordx4 v[232:235], v240, s[56:59], s20 offen sc1
    s_add_u32 s56, s4, 108527616
    s_addc_u32 s57, s5, 0
    s_and_b32 s57, s57, 0xffff
    s_mov_b32 s58, 10240
    s_mov_b32 s59, 0x20000
    s_add_u32 s20, s19, 0
    buffer_store_dwordx4 v[236:239], v240, s[56:59], s20 offen sc1
    v_mfma_f32_32x32x16_bf16 v[144:159], a[40:43], v[56:59], v[144:159]
    ds_read_b128 a[80:83], v228 offset:16384
    v_mfma_f32_32x32x16_bf16 v[160:175], a[40:43], v[120:123], v[160:175]
    ds_read_b128 a[84:87], v229 offset:16384
    v_mfma_f32_32x32x16_bf16 v[144:159], a[44:47], v[60:63], v[144:159]
    ds_read_b128 a[88:91], v230 offset:16384
    v_mfma_f32_32x32x16_bf16 v[160:175], a[44:47], v[124:127], v[160:175]
    ds_read_b128 a[92:95], v231 offset:16384
    v_mfma_f32_32x32x16_bf16 v[144:159], a[48:51], v[64:67], v[144:159]
    ds_read_b128 a[96:99], v224 offset:16640
    v_mfma_f32_32x32x16_bf16 v[160:175], a[48:51], v[128:131], v[160:175]
    ds_read_b128 a[100:103], v225 offset:16640
    v_mfma_f32_32x32x16_bf16 v[144:159], a[52:55], v[68:71], v[144:159]
    ds_read_b128 a[104:107], v226 offset:16640
    v_mfma_f32_32x32x16_bf16 v[160:175], a[52:55], v[132:135], v[160:175]
    ds_read_b128 a[108:111], v227 offset:16640
    v_mfma_f32_32x32x16_bf16 v[144:159], a[56:59], v[72:75], v[144:159]
    ds_read_b128 a[112:115], v228 offset:16640
    v_mfma_f32_32x32x16_bf16 v[160:175], a[56:59], v[136:139], v[160:175]
    ds_read_b128 a[116:119], v229 offset:16640
    v_mfma_f32_32x32x16_bf16 v[144:159], a[60:63], v[76:79], v[144:159]
    ds_read_b128 a[120:123], v230 offset:16640
    v_mfma_f32_32x32x16_bf16 v[160:175], a[60:63], v[140:143], v[160:175]
    ds_read_b128 a[124:127], v231 offset:16640
    s_waitcnt lgkmcnt(0)
    s_cmp_ge_u32 s12, 2
    s_cbranch_scc1 Lp_fin2
    v_mfma_f32_32x32x16_bf16 v[176:191], a[64:67], v[16:19], 0
    v_mfma_f32_32x32x16_bf16 v[176:191], a[68:71], v[20:23], v[176:191]
    v_mfma_f32_32x32x16_bf16 v[176:191], a[72:75], v[24:27], v[176:191]
    s_nop 2
    v_mul_f32 v144, s68, v144
    v_mul_f32 v145, s68, v145
    v_mul_f32 v146, s68, v146
    v_mul_f32 v147, s68, v147
    v_mul_f32 v148, s68, v148
    v_mfma_f32_32x32x16_bf16 v[176:191], a[76:79], v[28:31], v[176:191]
    v_mul_f32 v149, s68, v149
    v_mul_f32 v150, s68, v150
    v_mul_f32 v151, s68, v151
    v_mul_f32 v152, s68, v152
    v_mul_f32 v153, s68, v153
    v_mfma_f32_32x32x16_bf16 v[176:191], a[80:83], v[32:35], v[176:191]
    v_mul_f32 v154, s68, v154
    v_mul_f32 v155, s68, v155
    v_mul_f32 v156, s68, v156
    v_mul_f32 v157, s68, v157
    v_mul_f32 v158, s68, v158
    v_mfma_f32_32x32x16_bf16 v[176:191], a[84:87], v[36:39], v[176:191]
    v_mul_f32 v159, s68, v159
    v_mul_f32 v160, s68, v160
    v_mul_f32 v161, s68, v161
    v_mul_f32 v162, s68, v162
    v_mul_f32 v163, s68, v163
    v_mfma_f32_32x32x16_bf16 v[176:191], a[88:91], v[40:43], v[176:191]
    v_mul_f32 v164, s68, v164
    v_mul_f32 v165, s68, v165
    v_mul_f32 v166, s68, v166
    v_mul_f32 v167, s68, v167
    v_mul_f32 v168, s68, v168
    v_mfma_f32_32x32x16_bf16 v[176:191], a[92:95], v[44:47], v[176:191]
    v_mul_f32 v169, s68, v169
    v_mul_f32 v170, s68, v170
    v_mul_f32 v171, s68, v171
    v_mul_f32 v172, s68, v172
    v_mul_f32 v173, s68, v173
    v_mfma_f32_32x32x16_bf16 v[176:191], a[96:99], v[48:51], v[176:191]
    v_mul_f32 v174, s68, v174
    v_mul_f32 v175, s68, v175
    v_cvt_pk_bf16_f32 v208, v144, v145
    v_cvt_pk_bf16_f32 v209, v146, v147
    v_cvt_pk_bf16_f32 v210, v148, v149
    v_mfma_f32_32x32x16_bf16 v[176:191], a[100:103], v[52:55], v[176:191]
    v_cvt_pk_bf16_f32 v211, v150, v151
    v_cvt_pk_bf16_f32 v212, v152, v153
    v_cvt_pk_bf16_f32 v213, v154, v155
    v_cvt_pk_bf16_f32 v214, v156, v157
    v_cvt_pk_bf16_f32 v215, v158, v159
    v_mfma_f32_32x32x16_bf16 v[176:191], a[104:107], v[56:59], v[176:191]
    v_cvt_pk_bf16_f32 v216, v160, v161
    v_cvt_pk_bf16_f32 v217, v162, v163
    v_cvt_pk_bf16_f32 v218, v164, v165
    v_cvt_pk_bf16_f32 v219, v166, v167
    v_cvt_pk_bf16_f32 v220, v168, v169
    v_mfma_f32_32x32x16_bf16 v[176:191], a[108:111], v[60:63], v[176:191]
    v_cvt_pk_bf16_f32 v221, v170, v171
    v_cvt_pk_bf16_f32 v222, v172, v173
    v_cvt_pk_bf16_f32 v223, v174, v175
    v_mfma_f32_32x32x16_bf16 v[176:191], a[112:115], v[64:67], v[176:191]
    s_mul_i32 s20, s72, s74
    s_lshl_b32 s20, s20, 2
    s_add_u32 s20, s20, s65
    s_lshl_b32 s21, s74, 1
    s_add_u32 s21, s21, s20
    buffer_store_dwordx4 v[208:211], v7, s[8:11], s20 offen sc1
    buffer_store_dwordx4 v[212:215], v7, s[8:11], s21 offen sc1
    buffer_store_dwordx4 v[216:219], v14, s[8:11], s20 offen sc1
    buffer_store_dwordx4 v[220:223], v14, s[8:11], s21 offen sc1
    v_mfma_f32_32x32x16_bf16 v[176:191], a[116:119], v[68:71], v[176:191]
    v_mfma_f32_32x32x16_bf16 v[176:191], a[120:123], v[72:75], v[176:191]
    v_mfma_f32_32x32x16_bf16 v[176:191], a[124:127], v[76:79], v[176:191]
    s_nop 11
    v_mul_f32 v176, s68, v176
    v_mul_f32 v177, s68, v177
    v_mul_f32 v178, s68, v178
    v_mul_f32 v179, s68, v179
    v_mul_f32 v180, s68, v180
    v_mul_f32 v181, s68, v181
    v_mul_f32 v182, s68, v182
    v_mul_f32 v183, s68, v183
    v_mul_f32 v184, s68, v184
    v_mul_f32 v185, s68, v185
    v_mul_f32 v186, s68, v186
    v_mul_f32 v187, s68, v187
    v_mul_f32 v188, s68, v188
    v_mul_f32 v189, s68, v189
    v_mul_f32 v190, s68, v190
    v_mul_f32 v191, s68, v191
    v_cvt_pk_bf16_f32 v232, v176, v177
    v_cvt_pk_bf16_f32 v233, v178, v179
    v_cvt_pk_bf16_f32 v234, v180, v181
    v_cvt_pk_bf16_f32 v235, v182, v183
    v_cvt_pk_bf16_f32 v236, v184, v185
    v_cvt_pk_bf16_f32 v237, v186, v187
    v_cvt_pk_bf16_f32 v238, v188, v189
    v_cvt_pk_bf16_f32 v239, v190, v191
    s_mul_i32 s20, s73, s74
    s_lshl_b32 s20, s20, 2
    s_add_u32 s20, s20, s65
    s_lshl_b32 s21, s74, 1
    s_add_u32 s21, s21, s20
    buffer_store_dwordx4 v[232:235], v7, s[8:11], s20 offen sc1
    buffer_store_dwordx4 v[236:239], v7, s[8:11], s21 offen sc1
    s_branch Lp_sig
Lp_fin2:
    s_nop 2
    v_mfma_f32_32x32x16_bf16 v[192:207], a[64:67], v[80:83], 0
    v_mfma_f32_32x32x16_bf16 v[192:207], a[68:71], v[84:87], v[192:207]
    v_mfma_f32_32x32x16_bf16 v[192:207], a[72:75], v[88:91], v[192:207]
    v_mul_f32 v144, s68, v144
    v_mul_f32 v145, s68, v145
    v_mul_f32 v146, s68, v146
    v_mul_f32 v147, s68, v147
    v_mul_f32 v148, s68, v148
    v_mfma_f32_32x32x16_bf16 v[192:207], a[76:79], v[92:95], v[192:207]
    v_mul_f32 v149, s68, v149
    v_mul_f32 v150, s68, v150
    v_mul_f32 v151, s68, v151
    v_mul_f32 v152, s68, v152
    v_mul_f32 v153, s68, v153
    v_mfma_f32_32x32x16_bf16 v[192:207], a[80:83], v[96:99], v[192:207]
    v_mul_f32 v154, s68, v154
    v_mul_f32 v155, s68, v155
    v_mul_f32 v156, s68, v156
    v_mul_f32 v157, s68, v157
    v_mul_f32 v158, s68, v158
    v_mfma_f32_32x32x16_bf16 v[192:207], a[84:87], v[100:103], v[192:207]
    v_mul_f32 v159, s68, v159
    v_mul_f32 v160, s68, v160
    v_mul_f32 v161, s68, v161
    v_mul_f32 v162, s68, v162
    v_mul_f32 v163, s68, v163
    v_mfma_f32_32x32x16_bf16 v[192:207], a[88:91], v[104:107], v[192:207]
    v_mul_f32 v164, s68, v164
    v_mul_f32 v165, s68, v165
    v_mul_f32 v166, s68, v166
    v_mul_f32 v167, s68, v167
    v_mul_f32 v168, s68, v168
    v_mfma_f32_32x32x16_bf16 v[192:207], a[92:95], v[108:111], v[192:207]
    v_mul_f32 v169, s68, v169
    v_mul_f32 v170, s68, v170
    v_mul_f32 v171, s68, v171
    v_mul_f32 v172, s68, v172
    v_mul_f32 v173, s68, v173
    v_mfma_f32_32x32x16_bf16 v[192:207], a[96:99], v[112:115], v[192:207]
    v_mul_f32 v174, s68, v174
    v_mul_f32 v175, s68, v175
    v_cvt_pk_bf16_f32 v208, v144, v145
    v_cvt_pk_bf16_f32 v209, v146, v147
    v_cvt_pk_bf16_f32 v210, v148, v149
    v_mfma_f32_32x32x16_bf16 v[192:207], a[100:103], v[116:119], v[192:207]
    v_cvt_pk_bf16_f32 v211, v150, v151
    v_cvt_pk_bf16_f32 v212, v152, v153
    v_cvt_pk_bf16_f32 v213, v154, v155
    v_cvt_pk_bf16_f32 v214, v156, v157
    v_cvt_pk_bf16_f32 v215, v158, v159
    v_mfma_f32_32x32x16_bf16 v[192:207], a[104:107], v[120:123], v[192:207]
    v_cvt_pk_bf16_f32 v216, v160, v161
    v_cvt_pk_bf16_f32 v217, v162, v163
    v_cvt_pk_bf16_f32 v218, v164, v165
    v_cvt_pk_bf16_f32 v219, v166, v167
    v_cvt_pk_bf16_f32 v220, v168, v169
    v_mfma_f32_32x32x16_bf16 v[192:207], a[108:111], v[124:127], v[192:207]
    v_cvt_pk_bf16_f32 v221, v170, v171
    v_cvt_pk_bf16_f32 v222, v172, v173
    v_cvt_pk_bf16_f32 v223, v174, v175
    v_mfma_f32_32x32x16_bf16 v[192:207], a[112:115], v[128:131], v[192:207]
    s_mul_i32 s20, s72, s74
    s_lshl_b32 s20, s20, 2
    s_add_u32 s20, s20, s65
    s_lshl_b32 s21, s74, 1
    s_add_u32 s21, s21, s20
    buffer_store_dwordx4 v[208:211], v7, s[8:11], s20 offen sc1
    buffer_store_dwordx4 v[212:215], v7, s[8:11], s21 offen sc1
    buffer_store_dwordx4 v[216:219], v14, s[8:11], s20 offen sc1
    buffer_store_dwordx4 v[220:223], v14, s[8:11], s21 offen sc1
    v_mfma_f32_32x32x16_bf16 v[192:207], a[116:119], v[132:135], v[192:207]
    v_mfma_f32_32x32x16_bf16 v[192:207], a[120:123], v[136:139], v[192:207]
    v_mfma_f32_32x32x16_bf16 v[192:207], a[124:127], v[140:143], v[192:207]
    s_nop 11
    v_mul_f32 v192, s68, v192
    v_mul_f32 v193, s68, v193
    v_mul_f32 v194, s68, v194
    v_mul_f32 v195, s68, v195
    v_mul_f32 v196, s68, v196
    v_mul_f32 v197, s68, v197
    v_mul_f32 v198, s68, v198
    v_mul_f32 v199, s68, v199
    v_mul_f32 v200, s68, v200
    v_mul_f32 v201, s68, v201
    v_mul_f32 v202, s68, v202
    v_mul_f32 v203, s68, v203
    v_mul_f32 v204, s68, v204
    v_mul_f32 v205, s68, v205
    v_mul_f32 v206, s68, v206
    v_mul_f32 v207, s68, v207
    v_cvt_pk_bf16_f32 v240, v192, v193
    v_cvt_pk_bf16_f32 v241, v194, v195
    v_cvt_pk_bf16_f32 v242, v196, v197
    v_cvt_pk_bf16_f32 v243, v198, v199
    v_cvt_pk_bf16_f32 v244, v200, v201
    v_cvt_pk_bf16_f32 v245, v202, v203
    v_cvt_pk_bf16_f32 v246, v204, v205
    v_cvt_pk_bf16_f32 v247, v206, v207
    s_mul_i32 s20, s73, s74
    s_lshl_b32 s20, s20, 2
    s_add_u32 s20, s20, s65
    s_lshl_b32 s21, s74, 1
    s_add_u32 s21, s21, s20
    buffer_store_dwordx4 v[240:243], v14, s[8:11], s20 offen sc1
    buffer_store_dwordx4 v[244:247], v14, s[8:11], s21 offen sc1
    s_branch Lp_sig
Lp_ln:
    s_mov_b32 s56, s76
    s_and_b32 s57, s77, 0xffff
    s_mov_b32 s58, 1835008
    s_mov_b32 s59, 0x20000
    s_sub_u32 s60, s3, 224
    s_lshl_b32 s19, s12, 4
    v_lshrrev_b32 v14, 2, v2
    v_add_u32 v14, s19, v14
    v_and_b32 v15, 3, v2
    v_mul_u32_u24 v10, 896, v14
    v_lshl_add_u32 v10, v15, 5, v10
    s_mul_i32 s18, s60, 57344
    buffer_load_dwordx4 v[16:19], v10, s[56:59], s18 offen offset:0
    buffer_load_dwordx4 v[20:23], v10, s[56:59], s18 offen offset:16
    buffer_load_dwordx4 v[24:27], v10, s[56:59], s18 offen offset:128
    buffer_load_dwordx4 v[28:31], v10, s[56:59], s18 offen offset:144
    buffer_load_dwordx4 v[32:35], v10, s[56:59], s18 offen offset:256
    buffer_load_dwordx4 v[36:39], v10, s[56:59], s18 offen offset:272
    buffer_load_dwordx4 v[40:43], v10, s[56:59], s18 offen offset:384
    buffer_load_dwordx4 v[44:47], v10, s[56:59], s18 offen offset:400
    buffer_load_dwordx4 v[48:51], v10, s[56:59], s18 offen offset:512
    buffer_load_dwordx4 v[52:55], v10, s[56:59], s18 offen offset:528
    buffer_load_dwordx4 v[56:59], v10, s[56:59], s18 offen offset:640
    buffer_load_dwordx4 v[60:63], v10, s[56:59], s18 offen offset:656
    buffer_load_dwordx4 v[64:67], v10, s[56:59], s18 offen offset:768
    buffer_load_dwordx4 v[68:71], v10, s[56:59], s18 offen offset:784
    s_mov_b32 s48, s78
    s_and_b32 s49, s79, 0xffff
    s_mov_b32 s50, 7168
    s_mov_b32 s51, 0x20000
    s_lshl_b32 s19, s60, 8
    v_add_u32 v241, s19, v0
    v_lshlrev_b32 v242, 2, v241
    buffer_load_dword v243, v242, s[48:51], 0 offen
    v_lshrrev_b32 v245, 5, v241
    v_mul_u32_u24 v245, 9363, v245
    v_lshrrev_b32 v242, 16, v245
    v_mul_u32_u24 v244, 224, v242
    v_sub_u32 v241, v241, v244
    v_lshrrev_b32 v244, 3, v241
    v_lshlrev_b32 v244, 8, v244
    v_lshrrev_b32 v245, 1, v242
    v_lshl_add_u32 v244, v245, 6, v244
    v_and_b32 v245, 1, v241
    v_lshl_add_u32 v244, v245, 5, v244
    v_and_b32 v245, 1, v242
    v_lshl_add_u32 v244, v245, 4, v244
    v_and_b32 v245, 6, v241
    v_lshl_add_u32 v244, v245, 1, v244
    s_cmp_lt_u32 s60, 7
    s_mov_b32 s19, 106954752
    s_cselect_b32 s19, s19, 1073741824
    s_waitcnt vmcnt(0)
    v_min_u32 v243, -2, v243
    buffer_store_dword v243, v244, s[8:11], s19 offen sc1
    s_add_u32 s19, s19, 1114112
    buffer_store_dword v243, v244, s[8:11], s19 offen sc1
    v_mov_b32 v232, -1
    v_mov_b32 v236, 0
    v_mov_b32 v233, -1
    v_mov_b32 v237, 0
    v_mov_b32 v234, -1
    v_mov_b32 v238, 0
    v_mov_b32 v235, -1
    v_mov_b32 v239, 0
    v_lshlrev_b32 v240, 4, v0
    s_lshl_b32 s19, s3, 12
    s_add_u32 s56, s4, 106961920
    s_addc_u32 s57, s5, 0
    s_and_b32 s57, s57, 0xffff
    s_mov_b32 s58, 1106944
    s_mov_b32 s59, 0x20000
    s_add_u32 s20, s19, 0
    buffer_store_dwordx4 v[232:235], v240, s[56:59], s20 offen sc1
    s_add_u32 s20, s19, 1048576
    buffer_store_dwordx4 v[232:235], v240, s[56:59], s20 offen sc1
    s_add_u32 s56, s4, 108076032
    s_addc_u32 s57, s5, 0
    s_and_b32 s57, s57, 0xffff
    s_mov_b32 s58, 451584
    s_mov_b32 s59, 0x20000
    s_add_u32 s20, s19, 0
    buffer_store_dwordx4 v[232:235], v240, s[56:59], s20 offen sc1
    s_add_u32 s56, s4, 108527616
    s_addc_u32 s57, s5, 0
    s_and_b32 s57, s57, 0xffff
    s_mov_b32 s58, 10240
    s_mov_b32 s59, 0x20000
    s_add_u32 s20, s19, 0
    buffer_store_dwordx4 v[236:239], v240, s[56:59], s20 offen sc1
    s_mov_b32 s18, 0xffff0000
    v_lshlrev_b32 v72, 16, v16
    v_and_b32 v73, s18, v16
    v_lshlrev_b32 v74, 16, v17
    v_and_b32 v75, s18, v17
    v_lshlrev_b32 v76, 16, v18
    v_and_b32 v77, s18, v18
    v_lshlrev_b32 v78, 16, v19
    v_and_b32 v79, s18, v19
    v_lshlrev_b32 v80, 16, v20
    v_and_b32 v81, s18, v20
    v_lshlrev_b32 v82, 16, v21
    v_and_b32 v83, s18, v21
    v_lshlrev_b32 v84, 16, v22
    v_and_b32 v85, s18, v22
    v_lshlrev_b32 v86, 16, v23
    v_and_b32 v87, s18, v23
    v_lshlrev_b32 v88, 16, v24
    v_and_b32 v89, s18, v24
    v_lshlrev_b32 v90, 16, v25
    v_and_b32 v91, s18, v25
    v_lshlrev_b32 v92, 16, v26
    v_and_b32 v93, s18, v26
    v_lshlrev_b32 v94, 16, v27
    v_and_b32 v95, s18, v27
    v_lshlrev_b32 v96, 16, v28
    v_and_b32 v97, s18, v28
    v_lshlrev_b32 v98, 16, v29
    v_and_b32 v99, s18, v29
    v_lshlrev_b32 v100, 16, v30
    v_and_b32 v101, s18, v30
    v_lshlrev_b32 v102, 16, v31
    v_and_b32 v103, s18, v31
    v_lshlrev_b32 v104, 16, v32
    v_and_b32 v105, s18, v32
    v_lshlrev_b32 v106, 16, v33
    v_and_b32 v107, s18, v33
    v_lshlrev_b32 v108, 16, v34
    v_and_b32 v109, s18, v34
    v_lshlrev_b32 v110, 16, v35
    v_and_b32 v111, s18, v35
    v_lshlrev_b32 v112, 16, v36
    v_and_b32 v113, s18, v36
    v_lshlrev_b32 v114, 16, v37
    v_and_b32 v115, s18, v37
    v_lshlrev_b32 v116, 16, v38
    v_and_b32 v117, s18, v38
    v_lshlrev_b32 v118, 16, v39
    v_and_b32 v119, s18, v39
    v_lshlrev_b32 v120, 16, v40
    v_and_b32 v121, s18, v40
    v_lshlrev_b32 v122, 16, v41
    v_and_b32 v123, s18, v41
    v_lshlrev_b32 v124, 16, v42
    v_and_b32 v125, s18, v42
    v_lshlrev_b32 v126, 16, v43
    v_and_b32 v127, s18, v43
    v_lshlrev_b32 v128, 16, v44
    v_and_b32 v129, s18, v44
    v_lshlrev_b32 v130, 16, v45
    v_and_b32 v131, s18, v45
    v_lshlrev_b32 v132, 16, v46
    v_and_b32 v133, s18, v46
    v_lshlrev_b32 v134, 16, v47
    v_and_b32 v135, s18, v47
    v_lshlrev_b32 v136, 16, v48
    v_and_b32 v137, s18, v48
    v_lshlrev_b32 v138, 16, v49
    v_and_b32 v139, s18, v49
    v_lshlrev_b32 v140, 16, v50
    v_and_b32 v141, s18, v50
    v_lshlrev_b32 v142, 16, v51
    v_and_b32 v143, s18, v51
    v_lshlrev_b32 v144, 16, v52
    v_and_b32 v145, s18, v52
    v_lshlrev_b32 v146, 16, v53
    v_and_b32 v147, s18, v53
    v_lshlrev_b32 v148, 16, v54
    v_and_b32 v149, s18, v54
    v_lshlrev_b32 v150, 16, v55
    v_and_b32 v151, s18, v55
    v_lshlrev_b32 v152, 16, v56
    v_and_b32 v153, s18, v56
    v_lshlrev_b32 v154, 16, v57
    v_and_b32 v155, s18, v57
    v_lshlrev_b32 v156, 16, v58
    v_and_b32 v157, s18, v58
    v_lshlrev_b32 v158, 16, v59
    v_and_b32 v159, s18, v59
    v_lshlrev_b32 v160, 16, v60
    v_and_b32 v161, s18, v60
    v_lshlrev_b32 v162, 16, v61
    v_and_b32 v163, s18, v61
    v_lshlrev_b32 v164, 16, v62
    v_and_b32 v165, s18, v62
    v_lshlrev_b32 v166, 16, v63
    v_and_b32 v167, s18, v63
    v_lshlrev_b32 v168, 16, v64
    v_and_b32 v169, s18, v64
    v_lshlrev_b32 v170, 16, v65
    v_and_b32 v171, s18, v65
    v_lshlrev_b32 v172, 16, v66
    v_and_b32 v173, s18, v66
    v_lshlrev_b32 v174, 16, v67
    v_and_b32 v175, s18, v67
    v_lshlrev_b32 v176, 16, v68
    v_and_b32 v177, s18, v68
    v_lshlrev_b32 v178, 16, v69
    v_and_b32 v179, s18, v69
    v_lshlrev_b32 v180, 16, v70
    v_and_b32 v181, s18, v70
    v_lshlrev_b32 v182, 16, v71
    v_and_b32 v183, s18, v71
    v_pk_add_f32 v[6:7], v[72:73], v[74:75]
    v_pk_add_f32 v[10:11], v[76:77], v[78:79]
    v_pk_add_f32 v[6:7], v[6:7], v[80:81]
    v_pk_add_f32 v[10:11], v[10:11], v[82:83]
    v_pk_add_f32 v[6:7], v[6:7], v[84:85]
    v_pk_add_f32 v[10:11], v[10:11], v[86:87]
    v_pk_add_f32 v[6:7], v[6:7], v[88:89]
    v_pk_add_f32 v[10:11], v[10:11], v[90:91]
    v_pk_add_f32 v[6:7], v[6:7], v[92:93]
    v_pk_add_f32 v[10:11], v[10:11], v[94:95]
    v_pk_add_f32 v[6:7], v[6:7], v[96:97]
    v_pk_add_f32 v[10:11], v[10:11], v[98:99]
    v_pk_add_f32 v[6:7], v[6:7], v[100:101]
    v_pk_add_f32 v[10:11], v[10:11], v[102:103]
    v_pk_add_f32 v[6:7], v[6:7], v[104:105]
    v_pk_add_f32 v[10:11], v[10:11], v[106:107]
    v_pk_add_f32 v[6:7], v[6:7], v[108:109]
    v_pk_add_f32 v[10:11], v[10:11], v[110:111]
    v_pk_add_f32 v[6:7], v[6:7], v[112:113]
    v_pk_add_f32 v[10:11], v[10:11], v[114:115]
    v_pk_add_f32 v[6:7], v[6:7], v[116:117]
    v_pk_add_f32 v[10:11], v[10:11], v[118:119]
    v_pk_add_f32 v[6:7], v[6:7], v[120:121]
    v_pk_add_f32 v[10:11], v[10:11], v[122:123]
    v_pk_add_f32 v[6:7], v[6:7], v[124:125]
    v_pk_add_f32 v[10:11], v[10:11], v[126:127]
    v_pk_add_f32 v[6:7], v[6:7], v[128:129]
    v_pk_add_f32 v[10:11], v[10:11], v[130:131]
    v_pk_add_f32 v[6:7], v[6:7], v[132:133]
    v_pk_add_f32 v[10:11], v[10:11], v[134:135]
    v_pk_add_f32 v[6:7], v[6:7], v[136:137]
    v_pk_add_f32 v[10:11], v[10:11], v[138:139]
    v_pk_add_f32 v[6:7], v[6:7], v[140:141]
    v_pk_add_f32 v[10:11], v[10:11], v[142:143]
    v_pk_add_f32 v[6:7], v[6:7], v[144:145]
    v_pk_add_f32 v[10:11], v[10:11], v[146:147]
    v_pk_add_f32 v[6:7], v[6:7], v[148:149]
    v_pk_add_f32 v[10:11], v[10:11], v[150:151]
    v_pk_add_f32 v[6:7], v[6:7], v[152:153]
    v_pk_add_f32 v[10:11], v[10:11], v[154:155]
    v_pk_add_f32 v[6:7], v[6:7], v[156:157]
    v_pk_add_f32 v[10:11], v[10:11], v[158:159]
    v_pk_add_f32 v[6:7], v[6:7], v[160:161]
    v_pk_add_f32 v[10:11], v[10:11], v[162:163]
    v_pk_add_f32 v[6:7], v[6:7], v[164:165]
    v_pk_add_f32 v[10:11], v[10:11], v[166:167]
    v_pk_add_f32 v[6:7], v[6:7], v[168:169]
    v_pk_add_f32 v[10:11], v[10:11], v[170:171]
    v_pk_add_f32 v[6:7], v[6:7], v[172:173]
    v_pk_add_f32 v[10:11], v[10:11], v[174:175]
    v_pk_add_f32 v[6:7], v[6:7], v[176:177]
    v_pk_add_f32 v[10:11], v[10:11], v[178:179]
    v_pk_add_f32 v[6:7], v[6:7], v[180:181]
    v_pk_add_f32 v[10:11], v[10:11], v[182:183]
    v_pk_add_f32 v[6:7], v[6:7], v[10:11]
    v_add_f32 v6, v6, v7
    s_nop 1
    v_add_f32_dpp v6, v6, v6 quad_perm:[1,0,3,2] row_mask:0xf bank_mask:0xf
    s_nop 1
    v_add_f32_dpp v6, v6, v6 quad_perm:[2,3,0,1] row_mask:0xf bank_mask:0xf
    v_mul_f32 v6, 0xbb124925, v6
    v_mov_b32 v7, v6
    v_pk_add_f32 v[72:73], v[72:73], v[6:7]
    v_pk_add_f32 v[74:75], v[74:75], v[6:7]
    v_pk_add_f32 v[76:77], v[76:77], v[6:7]
    v_pk_add_f32 v[78:79], v[78:79], v[6:7]
    v_pk_add_f32 v[80:81], v[80:81], v[6:7]
    v_pk_add_f32 v[82:83], v[82:83], v[6:7]
    v_pk_add_f32 v[84:85], v[84:85], v[6:7]
    v_pk_add_f32 v[86:87], v[86:87], v[6:7]
    v_pk_add_f32 v[88:89], v[88:89], v[6:7]
    v_pk_add_f32 v[90:91], v[90:91], v[6:7]
    v_pk_add_f32 v[92:93], v[92:93], v[6:7]
    v_pk_add_f32 v[94:95], v[94:95], v[6:7]
    v_pk_add_f32 v[96:97], v[96:97], v[6:7]
    v_pk_add_f32 v[98:99], v[98:99], v[6:7]
    v_pk_add_f32 v[100:101], v[100:101], v[6:7]
    v_pk_add_f32 v[102:103], v[102:103], v[6:7]
    v_pk_add_f32 v[104:105], v[104:105], v[6:7]
    v_pk_add_f32 v[106:107], v[106:107], v[6:7]
    v_pk_add_f32 v[108:109], v[108:109], v[6:7]
    v_pk_add_f32 v[110:111], v[110:111], v[6:7]
    v_pk_add_f32 v[112:113], v[112:113], v[6:7]
    v_pk_add_f32 v[114:115], v[114:115], v[6:7]
    v_pk_add_f32 v[116:117], v[116:117], v[6:7]
    v_pk_add_f32 v[118:119], v[118:119], v[6:7]
    v_pk_add_f32 v[120:121], v[120:121], v[6:7]
    v_pk_add_f32 v[122:123], v[122:123], v[6:7]
    v_pk_add_f32 v[124:125], v[124:125], v[6:7]
    v_pk_add_f32 v[126:127], v[126:127], v[6:7]
    v_pk_add_f32 v[128:129], v[128:129], v[6:7]
    v_pk_add_f32 v[130:131], v[130:131], v[6:7]
    v_pk_add_f32 v[132:133], v[132:133], v[6:7]
    v_pk_add_f32 v[134:135], v[134:135], v[6:7]
    v_pk_add_f32 v[136:137], v[136:137], v[6:7]
    v_pk_add_f32 v[138:139], v[138:139], v[6:7]
    v_pk_add_f32 v[140:141], v[140:141], v[6:7]
    v_pk_add_f32 v[142:143], v[142:143], v[6:7]
    v_pk_add_f32 v[144:145], v[144:145], v[6:7]
    v_pk_add_f32 v[146:147], v[146:147], v[6:7]
    v_pk_add_f32 v[148:149], v[148:149], v[6:7]
    v_pk_add_f32 v[150:151], v[150:151], v[6:7]
    v_pk_add_f32 v[152:153], v[152:153], v[6:7]
    v_pk_add_f32 v[154:155], v[154:155], v[6:7]
    v_pk_add_f32 v[156:157], v[156:157], v[6:7]
    v_pk_add_f32 v[158:159], v[158:159], v[6:7]
    v_pk_add_f32 v[160:161], v[160:161], v[6:7]
    v_pk_add_f32 v[162:163], v[162:163], v[6:7]
    v_pk_add_f32 v[164:165], v[164:165], v[6:7]
    v_pk_add_f32 v[166:167], v[166:167], v[6:7]
    v_pk_add_f32 v[168:169], v[168:169], v[6:7]
    v_pk_add_f32 v[170:171], v[170:171], v[6:7]
    v_pk_add_f32 v[172:173], v[172:173], v[6:7]
    v_pk_add_f32 v[174:175], v[174:175], v[6:7]
    v_pk_add_f32 v[176:177], v[176:177], v[6:7]
    v_pk_add_f32 v[178:179], v[178:179], v[6:7]
    v_pk_add_f32 v[180:181], v[180:181], v[6:7]
    v_pk_add_f32 v[182:183], v[182:183], v[6:7]
    v_pk_mul_f32 v[10:11], v[72:73], v[72:73]
    v_pk_mul_f32 v[4:5], v[74:75], v[74:75]
    v_pk_fma_f32 v[10:11], v[76:77], v[76:77], v[10:11]
    v_pk_fma_f32 v[4:5], v[78:79], v[78:79], v[4:5]
    v_pk_fma_f32 v[10:11], v[80:81], v[80:81], v[10:11]
    v_pk_fma_f32 v[4:5], v[82:83], v[82:83], v[4:5]
    v_pk_fma_f32 v[10:11], v[84:85], v[84:85], v[10:11]
    v_pk_fma_f32 v[4:5], v[86:87], v[86:87], v[4:5]
    v_pk_fma_f32 v[10:11], v[88:89], v[88:89], v[10:11]
    v_pk_fma_f32 v[4:5], v[90:91], v[90:91], v[4:5]
    v_pk_fma_f32 v[10:11], v[92:93], v[92:93], v[10:11]
    v_pk_fma_f32 v[4:5], v[94:95], v[94:95], v[4:5]
    v_pk_fma_f32 v[10:11], v[96:97], v[96:97], v[10:11]
    v_pk_fma_f32 v[4:5], v[98:99], v[98:99], v[4:5]
    v_pk_fma_f32 v[10:11], v[100:101], v[100:101], v[10:11]
    v_pk_fma_f32 v[4:5], v[102:103], v[102:103], v[4:5]
    v_pk_fma_f32 v[10:11], v[104:105], v[104:105], v[10:11]
    v_pk_fma_f32 v[4:5], v[106:107], v[106:107], v[4:5]
    v_pk_fma_f32 v[10:11], v[108:109], v[108:109], v[10:11]
    v_pk_fma_f32 v[4:5], v[110:111], v[110:111], v[4:5]
    v_pk_fma_f32 v[10:11], v[112:113], v[112:113], v[10:11]
    v_pk_fma_f32 v[4:5], v[114:115], v[114:115], v[4:5]
    v_pk_fma_f32 v[10:11], v[116:117], v[116:117], v[10:11]
    v_pk_fma_f32 v[4:5], v[118:119], v[118:119], v[4:5]
    v_pk_fma_f32 v[10:11], v[120:121], v[120:121], v[10:11]
    v_pk_fma_f32 v[4:5], v[122:123], v[122:123], v[4:5]
    v_pk_fma_f32 v[10:11], v[124:125], v[124:125], v[10:11]
    v_pk_fma_f32 v[4:5], v[126:127], v[126:127], v[4:5]
    v_pk_fma_f32 v[10:11], v[128:129], v[128:129], v[10:11]
    v_pk_fma_f32 v[4:5], v[130:131], v[130:131], v[4:5]
    v_pk_fma_f32 v[10:11], v[132:133], v[132:133], v[10:11]
    v_pk_fma_f32 v[4:5], v[134:135], v[134:135], v[4:5]
    v_pk_fma_f32 v[10:11], v[136:137], v[136:137], v[10:11]
    v_pk_fma_f32 v[4:5], v[138:139], v[138:139], v[4:5]
    v_pk_fma_f32 v[10:11], v[140:141], v[140:141], v[10:11]
    v_pk_fma_f32 v[4:5], v[142:143], v[142:143], v[4:5]
    v_pk_fma_f32 v[10:11], v[144:145], v[144:145], v[10:11]
    v_pk_fma_f32 v[4:5], v[146:147], v[146:147], v[4:5]
    v_pk_fma_f32 v[10:11], v[148:149], v[148:149], v[10:11]
    v_pk_fma_f32 v[4:5], v[150:151], v[150:151], v[4:5]
    v_pk_fma_f32 v[10:11], v[152:153], v[152:153], v[10:11]
    v_pk_fma_f32 v[4:5], v[154:155], v[154:155], v[4:5]
    v_pk_fma_f32 v[10:11], v[156:157], v[156:157], v[10:11]
    v_pk_fma_f32 v[4:5], v[158:159], v[158:159], v[4:5]
    v_pk_fma_f32 v[10:11], v[160:161], v[160:161], v[10:11]
    v_pk_fma_f32 v[4:5], v[162:163], v[162:163], v[4:5]
    v_pk_fma_f32 v[10:11], v[164:165], v[164:165], v[10:11]
    v_pk_fma_f32 v[4:5], v[166:167], v[166:167], v[4:5]
    v_pk_fma_f32 v[10:11], v[168:169], v[168:169], v[10:11]
    v_pk_fma_f32 v[4:5], v[170:171], v[170:171], v[4:5]
    v_pk_fma_f32 v[10:11], v[172:173], v[172:173], v[10:11]
    v_pk_fma_f32 v[4:5], v[174:175], v[174:175], v[4:5]
    v_pk_fma_f32 v[10:11], v[176:177], v[176:177], v[10:11]
    v_pk_fma_f32 v[4:5], v[178:179], v[178:179], v[4:5]
    v_pk_fma_f32 v[10:11], v[180:181], v[180:181], v[10:11]
    v_pk_fma_f32 v[4:5], v[182:183], v[182:183], v[4:5]
    v_pk_add_f32 v[10:11], v[10:11], v[4:5]
    v_add_f32 v10, v10, v11
    s_nop 1
    v_add_f32_dpp v10, v10, v10 quad_perm:[1,0,3,2] row_mask:0xf bank_mask:0xf
    s_nop 1
    v_add_f32_dpp v10, v10, v10 quad_perm:[2,3,0,1] row_mask:0xf bank_mask:0xf
    v_mov_b32 v11, 0x3727c5ac
    v_fmac_f32 v11, 0x3b124925, v10
    v_rsq_f32 v10, v11
    s_nop 0
    v_mov_b32 v11, v10
    v_pk_mul_f32 v[72:73], v[72:73], v[10:11]
    v_pk_mul_f32 v[74:75], v[74:75], v[10:11]
    v_pk_mul_f32 v[76:77], v[76:77], v[10:11]
    v_pk_mul_f32 v[78:79], v[78:79], v[10:11]
    v_pk_mul_f32 v[80:81], v[80:81], v[10:11]
    v_pk_mul_f32 v[82:83], v[82:83], v[10:11]
    v_pk_mul_f32 v[84:85], v[84:85], v[10:11]
    v_pk_mul_f32 v[86:87], v[86:87], v[10:11]
    v_pk_mul_f32 v[88:89], v[88:89], v[10:11]
    v_pk_mul_f32 v[90:91], v[90:91], v[10:11]
    v_pk_mul_f32 v[92:93], v[92:93], v[10:11]
    v_pk_mul_f32 v[94:95], v[94:95], v[10:11]
    v_pk_mul_f32 v[96:97], v[96:97], v[10:11]
    v_pk_mul_f32 v[98:99], v[98:99], v[10:11]
    v_pk_mul_f32 v[100:101], v[100:101], v[10:11]
    v_pk_mul_f32 v[102:103], v[102:103], v[10:11]
    v_pk_mul_f32 v[104:105], v[104:105], v[10:11]
    v_pk_mul_f32 v[106:107], v[106:107], v[10:11]
    v_pk_mul_f32 v[108:109], v[108:109], v[10:11]
    v_pk_mul_f32 v[110:111], v[110:111], v[10:11]
    v_pk_mul_f32 v[112:113], v[112:113], v[10:11]
    v_pk_mul_f32 v[114:115], v[114:115], v[10:11]
    v_pk_mul_f32 v[116:117], v[116:117], v[10:11]
    v_pk_mul_f32 v[118:119], v[118:119], v[10:11]
    v_pk_mul_f32 v[120:121], v[120:121], v[10:11]
    v_pk_mul_f32 v[122:123], v[122:123], v[10:11]
    v_pk_mul_f32 v[124:125], v[124:125], v[10:11]
    v_pk_mul_f32 v[126:127], v[126:127], v[10:11]
    v_pk_mul_f32 v[128:129], v[128:129], v[10:11]
    v_pk_mul_f32 v[130:131], v[130:131], v[10:11]
    v_pk_mul_f32 v[132:133], v[132:133], v[10:11]
    v_pk_mul_f32 v[134:135], v[134:135], v[10:11]
    v_pk_mul_f32 v[136:137], v[136:137], v[10:11]
    v_pk_mul_f32 v[138:139], v[138:139], v[10:11]
    v_pk_mul_f32 v[140:141], v[140:141], v[10:11]
    v_pk_mul_f32 v[142:143], v[142:143], v[10:11]
    v_pk_mul_f32 v[144:145], v[144:145], v[10:11]
    v_pk_mul_f32 v[146:147], v[146:147], v[10:11]
    v_pk_mul_f32 v[148:149], v[148:149], v[10:11]
    v_pk_mul_f32 v[150:151], v[150:151], v[10:11]
    v_pk_mul_f32 v[152:153], v[152:153], v[10:11]
    v_pk_mul_f32 v[154:155], v[154:155], v[10:11]
    v_pk_mul_f32 v[156:157], v[156:157], v[10:11]
    v_pk_mul_f32 v[158:159], v[158:159], v[10:11]
    v_pk_mul_f32 v[160:161], v[160:161], v[10:11]
    v_pk_mul_f32 v[162:163], v[162:163], v[10:11]
    v_pk_mul_f32 v[164:165], v[164:165], v[10:11]
    v_pk_mul_f32 v[166:167], v[166:167], v[10:11]
    v_pk_mul_f32 v[168:169], v[168:169], v[10:11]
    v_pk_mul_f32 v[170:171], v[170:171], v[10:11]
    v_pk_mul_f32 v[172:173], v[172:173], v[10:11]
    v_pk_mul_f32 v[174:175], v[174:175], v[10:11]
    v_pk_mul_f32 v[176:177], v[176:177], v[10:11]
    v_pk_mul_f32 v[178:179], v[178:179], v[10:11]
    v_pk_mul_f32 v[180:181], v[180:181], v[10:11]
    v_pk_mul_f32 v[182:183], v[182:183], v[10:11]
    v_mul_u32_u24 v10, 912, v14
    v_lshl_add_u32 v10, v15, 5, v10
    v_cvt_pk_bf16_f32 v16, v72, v73
    v_cvt_pk_bf16_f32 v184, v72, v73
    v_cvt_pk_bf16_f32 v17, v74, v75
    v_cvt_pk_bf16_f32 v188, v74, v75
    v_cvt_pk_bf16_f32 v18, v76, v77
    v_cvt_pk_bf16_f32 v185, v76, v77
    v_cvt_pk_bf16_f32 v19, v78, v79
    v_cvt_pk_bf16_f32 v189, v78, v79
    v_cvt_pk_bf16_f32 v20, v80, v81
    v_cvt_pk_bf16_f32 v186, v80, v81
    v_cvt_pk_bf16_f32 v21, v82, v83
    v_cvt_pk_bf16_f32 v190, v82, v83
    v_cvt_pk_bf16_f32 v22, v84, v85
    v_cvt_pk_bf16_f32 v187, v84, v85
    v_cvt_pk_bf16_f32 v23, v86, v87
    v_cvt_pk_bf16_f32 v191, v86, v87
    ds_write_b128 v10, v[16:19] offset:0
    ds_write_b128 v10, v[184:187] offset:58368
    ds_write_b128 v10, v[20:23] offset:16
    ds_write_b128 v10, v[188:191] offset:58384
    v_cvt_pk_bf16_f32 v24, v88, v89
    v_cvt_pk_bf16_f32 v192, v88, v89
    v_cvt_pk_bf16_f32 v25, v90, v91
    v_cvt_pk_bf16_f32 v196, v90, v91
    v_cvt_pk_bf16_f32 v26, v92, v93
    v_cvt_pk_bf16_f32 v193, v92, v93
    v_cvt_pk_bf16_f32 v27, v94, v95
    v_cvt_pk_bf16_f32 v197, v94, v95
    v_cvt_pk_bf16_f32 v28, v96, v97
    v_cvt_pk_bf16_f32 v194, v96, v97
    v_cvt_pk_bf16_f32 v29, v98, v99
    v_cvt_pk_bf16_f32 v198, v98, v99
    v_cvt_pk_bf16_f32 v30, v100, v101
    v_cvt_pk_bf16_f32 v195, v100, v101
    v_cvt_pk_bf16_f32 v31, v102, v103
    v_cvt_pk_bf16_f32 v199, v102, v103
    ds_write_b128 v10, v[24:27] offset:128
    ds_write_b128 v10, v[192:195] offset:58496
    ds_write_b128 v10, v[28:31] offset:144
    ds_write_b128 v10, v[196:199] offset:58512
    s_waitcnt lgkmcnt(4)
    v_cvt_pk_bf16_f32 v32, v104, v105
    v_cvt_pk_bf16_f32 v200, v104, v105
    v_cvt_pk_bf16_f32 v33, v106, v107
    v_cvt_pk_bf16_f32 v204, v106, v107
    v_cvt_pk_bf16_f32 v34, v108, v109
    v_cvt_pk_bf16_f32 v201, v108, v109
    v_cvt_pk_bf16_f32 v35, v110, v111
    v_cvt_pk_bf16_f32 v205, v110, v111
    v_cvt_pk_bf16_f32 v36, v112, v113
    v_cvt_pk_bf16_f32 v202, v112, v113
    v_cvt_pk_bf16_f32 v37, v114, v115
    v_cvt_pk_bf16_f32 v206, v114, v115
    v_cvt_pk_bf16_f32 v38, v116, v117
    v_cvt_pk_bf16_f32 v203, v116, v117
    v_cvt_pk_bf16_f32 v39, v118, v119
    v_cvt_pk_bf16_f32 v207, v118, v119
    ds_write_b128 v10, v[32:35] offset:256
    ds_write_b128 v10, v[200:203] offset:58624
    ds_write_b128 v10, v[36:39] offset:272
    ds_write_b128 v10, v[204:207] offset:58640
    v_cvt_pk_bf16_f32 v40, v120, v121
    v_cvt_pk_bf16_f32 v208, v120, v121
    v_cvt_pk_bf16_f32 v41, v122, v123
    v_cvt_pk_bf16_f32 v212, v122, v123
    v_cvt_pk_bf16_f32 v42, v124, v125
    v_cvt_pk_bf16_f32 v209, v124, v125
    v_cvt_pk_bf16_f32 v43, v126, v127
    v_cvt_pk_bf16_f32 v213, v126, v127
    v_cvt_pk_bf16_f32 v44, v128, v129
    v_cvt_pk_bf16_f32 v210, v128, v129
    v_cvt_pk_bf16_f32 v45, v130, v131
    v_cvt_pk_bf16_f32 v214, v130, v131
    v_cvt_pk_bf16_f32 v46, v132, v133
    v_cvt_pk_bf16_f32 v211, v132, v133
    v_cvt_pk_bf16_f32 v47, v134, v135
    v_cvt_pk_bf16_f32 v215, v134, v135
    ds_write_b128 v10, v[40:43] offset:384
    ds_write_b128 v10, v[208:211] offset:58752
    ds_write_b128 v10, v[44:47] offset:400
    ds_write_b128 v10, v[212:215] offset:58768
    s_waitcnt lgkmcnt(4)
    v_cvt_pk_bf16_f32 v48, v136, v137
    v_cvt_pk_bf16_f32 v216, v136, v137
    v_cvt_pk_bf16_f32 v49, v138, v139
    v_cvt_pk_bf16_f32 v220, v138, v139
    v_cvt_pk_bf16_f32 v50, v140, v141
    v_cvt_pk_bf16_f32 v217, v140, v141
    v_cvt_pk_bf16_f32 v51, v142, v143
    v_cvt_pk_bf16_f32 v221, v142, v143
    v_cvt_pk_bf16_f32 v52, v144, v145
    v_cvt_pk_bf16_f32 v218, v144, v145
    v_cvt_pk_bf16_f32 v53, v146, v147
    v_cvt_pk_bf16_f32 v222, v146, v147
    v_cvt_pk_bf16_f32 v54, v148, v149
    v_cvt_pk_bf16_f32 v219, v148, v149
    v_cvt_pk_bf16_f32 v55, v150, v151
    v_cvt_pk_bf16_f32 v223, v150, v151
    ds_write_b128 v10, v[48:51] offset:512
    ds_write_b128 v10, v[216:219] offset:58880
    ds_write_b128 v10, v[52:55] offset:528
    ds_write_b128 v10, v[220:223] offset:58896
    v_cvt_pk_bf16_f32 v56, v152, v153
    v_cvt_pk_bf16_f32 v224, v152, v153
    v_cvt_pk_bf16_f32 v57, v154, v155
    v_cvt_pk_bf16_f32 v228, v154, v155
    v_cvt_pk_bf16_f32 v58, v156, v157
    v_cvt_pk_bf16_f32 v225, v156, v157
    v_cvt_pk_bf16_f32 v59, v158, v159
    v_cvt_pk_bf16_f32 v229, v158, v159
    v_cvt_pk_bf16_f32 v60, v160, v161
    v_cvt_pk_bf16_f32 v226, v160, v161
    v_cvt_pk_bf16_f32 v61, v162, v163
    v_cvt_pk_bf16_f32 v230, v162, v163
    v_cvt_pk_bf16_f32 v62, v164, v165
    v_cvt_pk_bf16_f32 v227, v164, v165
    v_cvt_pk_bf16_f32 v63, v166, v167
    v_cvt_pk_bf16_f32 v231, v166, v167
    ds_write_b128 v10, v[56:59] offset:640
    ds_write_b128 v10, v[224:227] offset:59008
    ds_write_b128 v10, v[60:63] offset:656
    ds_write_b128 v10, v[228:231] offset:59024
    s_waitcnt lgkmcnt(4)
    v_cvt_pk_bf16_f32 v64, v168, v169
    v_cvt_pk_bf16_f32 v232, v168, v169
    v_cvt_pk_bf16_f32 v65, v170, v171
    v_cvt_pk_bf16_f32 v236, v170, v171
    v_cvt_pk_bf16_f32 v66, v172, v173
    v_cvt_pk_bf16_f32 v233, v172, v173
    v_cvt_pk_bf16_f32 v67, v174, v175
    v_cvt_pk_bf16_f32 v237, v174, v175
    v_cvt_pk_bf16_f32 v68, v176, v177
    v_cvt_pk_bf16_f32 v234, v176, v177
    v_cvt_pk_bf16_f32 v69, v178, v179
    v_cvt_pk_bf16_f32 v238, v178, v179
    v_cvt_pk_bf16_f32 v70, v180, v181
    v_cvt_pk_bf16_f32 v235, v180, v181
    v_cvt_pk_bf16_f32 v71, v182, v183
    v_cvt_pk_bf16_f32 v239, v182, v183
    ds_write_b128 v10, v[64:67] offset:768
    ds_write_b128 v10, v[232:235] offset:59136
    ds_write_b128 v10, v[68:71] offset:784
    ds_write_b128 v10, v[236:239] offset:59152
    s_lshr_b32 s18, s12, 1
    s_and_b32 s19, s12, 1
    s_lshl_b32 s61, s60, 1
    s_add_u32 s61, s61, s18
    s_mul_i32 s63, s18, 29184
    s_mul_i32 s20, s19, 448
    s_add_u32 s20, s20, s63
    v_mul_u32_u24 v10, 912, v9
    v_lshl_add_u32 v10, v8, 4, v10
    v_add_u32 v10, s20, v10
    v_lshlrev_b32 v4, 4, v2
    s_mul_i32 s65, s61, 28672
    s_mul_i32 s20, s19, 14336
    s_add_u32 s65, s65, s20
    s_waitcnt lgkmcnt(0)
    s_barrier
    ds_read_b128 v[16:19], v10 offset:0
    ds_read_b128 v[20:23], v10 offset:32
    ds_read_b128 v[24:27], v10 offset:64
    ds_read_b128 v[28:31], v10 offset:96
    ds_read_b128 v[32:35], v10 offset:128
    ds_read_b128 v[36:39], v10 offset:160
    ds_read_b128 v[40:43], v10 offset:192
    ds_read_b128 v[44:47], v10 offset:224
    ds_read_b128 v[48:51], v10 offset:256
    ds_read_b128 v[52:55], v10 offset:288
    ds_read_b128 v[56:59], v10 offset:320
    ds_read_b128 v[60:63], v10 offset:352
    ds_read_b128 v[64:67], v10 offset:384
    ds_read_b128 v[68:71], v10 offset:416
    s_add_u32 s20, s65, 12845056
    s_waitcnt lgkmcnt(13)
    buffer_store_dwordx4 v[16:19], v4, s[8:11], s20 offen offset:0 sc1
    s_waitcnt lgkmcnt(12)
    buffer_store_dwordx4 v[20:23], v4, s[8:11], s20 offen offset:1024 sc1
    s_waitcnt lgkmcnt(11)
    buffer_store_dwordx4 v[24:27], v4, s[8:11], s20 offen offset:2048 sc1
    s_waitcnt lgkmcnt(10)
    buffer_store_dwordx4 v[28:31], v4, s[8:11], s20 offen offset:3072 sc1
    s_add_u32 s20, s65, 12849152
    s_waitcnt lgkmcnt(9)
    buffer_store_dwordx4 v[32:35], v4, s[8:11], s20 offen offset:0 sc1
    s_waitcnt lgkmcnt(8)
    buffer_store_dwordx4 v[36:39], v4, s[8:11], s20 offen offset:1024 sc1
    s_waitcnt lgkmcnt(7)
    buffer_store_dwordx4 v[40:43], v4, s[8:11], s20 offen offset:2048 sc1
    s_waitcnt lgkmcnt(6)
    buffer_store_dwordx4 v[44:47], v4, s[8:11], s20 offen offset:3072 sc1
    s_add_u32 s20, s65, 12853248
    s_waitcnt lgkmcnt(5)
    buffer_store_dwordx4 v[48:51], v4, s[8:11], s20 offen offset:0 sc1
    s_waitcnt lgkmcnt(4)
    buffer_store_dwordx4 v[52:55], v4, s[8:11], s20 offen offset:1024 sc1
    s_waitcnt lgkmcnt(3)
    buffer_store_dwordx4 v[56:59], v4, s[8:11], s20 offen offset:2048 sc1
    s_waitcnt lgkmcnt(2)
    buffer_store_dwordx4 v[60:63], v4, s[8:11], s20 offen offset:3072 sc1
    s_add_u32 s20, s65, 12857344
    s_waitcnt lgkmcnt(1)
    buffer_store_dwordx4 v[64:67], v4, s[8:11], s20 offen offset:0 sc1
    s_waitcnt lgkmcnt(0)
    buffer_store_dwordx4 v[68:71], v4, s[8:11], s20 offen offset:1024 sc1
    v_and_b32 v5, 3, v2
    v_lshlrev_b32 v5, 3, v5
    v_bfe_u32 v6, v2, 3, 1
    v_lshl_add_u32 v5, v6, 2, v5
    v_bfe_u32 v6, v2, 2, 1
    v_lshl_add_u32 v5, v6, 1, v5
    v_mul_u32_u24 v5, 912, v5
    v_lshl_add_u32 v5, v8, 4, v5
    v_add_u32 v5, s63, v5
    v_bfe_u32 v6, v2, 4, 1
    s_lshl_b32 s65, s61, 15
    s_lshl_b32 s20, s19, 14
    s_add_u32 s65, s65, s20
    s_add_u32 s65, s65, 14680064
    s_mul_i32 s20, s19, 384
    s_add_u32 s20, s20, 0
    s_mov_b32 s21, 64
    v_mul_lo_u32 v7, s21, v6
    v_add3_u32 v7, v7, v5, s20
    ds_read_b128 v[128:131], v7 offset:58368
    ds_read_b128 v[132:135], v7 offset:58400
    ds_read_b128 v[136:139], v7 offset:59280
    ds_read_b128 v[140:143], v7 offset:59312
    s_mul_i32 s20, s19, 384
    s_add_u32 s20, s20, 128
    s_lshl_b32 s21, s19, 6
    s_add_u32 s21, s21, 768
    s_sub_u32 s21, s21, s20
    v_mul_lo_u32 v7, s21, v6
    v_add3_u32 v7, v7, v5, s20
    ds_read_b128 v[144:147], v7 offset:58368
    ds_read_b128 v[148:151], v7 offset:58400
    ds_read_b128 v[152:155], v7 offset:59280
    ds_read_b128 v[156:159], v7 offset:59312
    s_waitcnt lgkmcnt(0)
    s_add_u32 s20, s65, 0
    buffer_store_dwordx4 v[128:131], v4, s[8:11], s20 offen offset:0 sc1
    buffer_store_dwordx4 v[132:135], v4, s[8:11], s20 offen offset:1024 sc1
    buffer_store_dwordx4 v[136:139], v4, s[8:11], s20 offen offset:2048 sc1
    buffer_store_dwordx4 v[140:143], v4, s[8:11], s20 offen offset:3072 sc1
    s_add_u32 s20, s65, 4096
    buffer_store_dwordx4 v[144:147], v4, s[8:11], s20 offen offset:0 sc1
    buffer_store_dwordx4 v[148:151], v4, s[8:11], s20 offen offset:1024 sc1
    buffer_store_dwordx4 v[152:155], v4, s[8:11], s20 offen offset:2048 sc1
    buffer_store_dwordx4 v[156:159], v4, s[8:11], s20 offen offset:3072 sc1
    s_mul_i32 s20, s19, 384
    s_add_u32 s20, s20, 192
    s_mov_b32 s21, 64
    v_mul_lo_u32 v7, s21, v6
    v_add3_u32 v7, v7, v5, s20
    ds_read_b128 v[160:163], v7 offset:58368
    ds_read_b128 v[164:167], v7 offset:58400
    ds_read_b128 v[168:171], v7 offset:59280
    ds_read_b128 v[172:175], v7 offset:59312
    s_mul_i32 s20, s19, 384
    s_add_u32 s20, s20, 320
    s_lshl_b32 s21, s19, 6
    s_add_u32 s21, s21, 768
    s_sub_u32 s21, s21, s20
    v_mul_lo_u32 v7, s21, v6
    v_add3_u32 v7, v7, v5, s20
    ds_read_b128 v[176:179], v7 offset:58368
    ds_read_b128 v[180:183], v7 offset:58400
    ds_read_b128 v[184:187], v7 offset:59280
    ds_read_b128 v[188:191], v7 offset:59312
    s_waitcnt lgkmcnt(0)
    s_add_u32 s20, s65, 8192
    buffer_store_dwordx4 v[160:163], v4, s[8:11], s20 offen offset:0 sc1
    buffer_store_dwordx4 v[164:167], v4, s[8:11], s20 offen offset:1024 sc1
    buffer_store_dwordx4 v[168:171], v4, s[8:11], s20 offen offset:2048 sc1
    buffer_store_dwordx4 v[172:175], v4, s[8:11], s20 offen offset:3072 sc1
    s_add_u32 s20, s65, 12288
    buffer_store_dwordx4 v[176:179], v4, s[8:11], s20 offen offset:0 sc1
    buffer_store_dwordx4 v[180:183], v4, s[8:11], s20 offen offset:1024 sc1
    buffer_store_dwordx4 v[184:187], v4, s[8:11], s20 offen offset:2048 sc1
    buffer_store_dwordx4 v[188:191], v4, s[8:11], s20 offen offset:3072 sc1
    s_and_b32 s67, s3, 7
    s_lshl_b32 s67, s67, 7
    s_add_u32 s67, s67, 108556288
Lp_sig:
    v_mov_b32 v10, 0
Lwz_1:
    buffer_load_dword v11, v10, s[40:43], 0 offen offset:252 sc1
    s_sub_u32 s15, s15, 1
    s_cbranch_scc1 Lm_exit
    s_waitcnt vmcnt(0)
    v_cmp_eq_u32 vcc, 0, v11
    s_cbranch_vccnz Lwz_1
    s_barrier
    s_cmp_lg_u32 s12, 0
    s_cbranch_scc1 Lp_end
    s_mov_b64 exec, 1
    buffer_atomic_add v12, v13, s[8:11], s67 offen sc1
    s_mov_b64 exec, -1
Lp_end:
    v_mov_b32 v2, 0
    s_cmp_lg_u32 s12, 0
    s_cbranch_scc1 Lm_rolewait
    s_waitcnt vmcnt(0)
    s_mov_b64 exec, 1
    ds_write_b32 v2, v253
    s_mov_b64 exec, -1
    s_waitcnt lgkmcnt(0)
Lm_rolewait:
    s_barrier
    ds_read_b32 v7, v2
    s_waitcnt lgkmcnt(0)
    v_readfirstlane_b32 s13, v7
    s_barrier
    s_cmp_ge_u32 s13, 32
    s_cbranch_scc1 Lm_exit
    s_cmp_lg_u32 s35, 0
    s_cbranch_scc1 Lm_worker
    s_lshl_b32 s36, s12, 9
    s_add_u32 s36, s36, 108554240
    s_cmp_ge_u32 s13, 16
    s_cbranch_scc1 Lm_B
    s_lshl_b32 s36, s13, 7
    s_add_u32 s36, s36, 108552192
    v_and_b32 v44, 63, v0
    v_lshrrev_b32 v45, 4, v44
    v_and_b32 v46, 15, v44
    v_lshlrev_b32 v47, 4, v46
    v_mul_u32_u24 v48, 7168, v45
    v_add_u32 v49, v47, v48
    s_mul_i32 s18, s13, 401408
    s_lshr_b32 s19, s12, 1
    s_add_u32 s19, s19, 12
    s_lshl_b32 s19, s19, 9
    s_and_b32 s20, s12, 1
    s_lshl_b32 s20, s20, 8
    s_add_u32 s19, s19, s20
    s_add_u32 s19, s19, s18
    s_mul_i32 s20, s12, 1536
    s_add_u32 s18, s18, s20
    s_lshl_b32 s20, s12, 1
    v_mbcnt_lo_u32_b32 v60, -1, 0
    v_min_u32 v60, 0, v60
    v_lshlrev_b32 v60, 7, v60
    s_branch Lwc_3
Lww_2:
    s_sleep 2
Lwc_3:
    buffer_load_dword v61, v60, s[8:11], s36 offen sc1
    s_sub_u32 s15, s15, 1
    s_cbranch_scc1 Lm_exit
    s_waitcnt vmcnt(0)
    v_cmp_gt_u32 vcc, 7, v61
    s_cbranch_vccnz Lww_2
    s_mul_i32 s21, s20, 57344
    s_add_u32 s16, s21, s18
    s_add_u32 s17, s21, s19
    buffer_load_dwordx4 a[0:3], v49, s[8:11], s16 offen offset:0 sc1
    buffer_load_dwordx4 a[56:59], v49, s[8:11], s16 offen offset:256 sc1
    buffer_load_dwordx4 a[112:115], v49, s[8:11], s16 offen offset:512 sc1
    buffer_load_dwordx4 a[168:171], v49, s[8:11], s16 offen offset:768 sc1
    buffer_load_dwordx4 a[224:227], v49, s[8:11], s16 offen offset:1024 sc1
    buffer_load_dwordx4 v[144:147], v49, s[8:11], s16 offen offset:1280 sc1
    buffer_load_dwordx4 v[200:203], v49, s[8:11], s17 offen sc1
    s_mul_i32 s21, s20, 57344
    s_add_u32 s21, s21, 28672
    s_add_u32 s16, s21, s18
    s_add_u32 s17, s21, s19
    buffer_load_dwordx4 a[4:7], v49, s[8:11], s16 offen offset:0 sc1
    buffer_load_dwordx4 a[60:63], v49, s[8:11], s16 offen offset:256 sc1
    buffer_load_dwordx4 a[116:119], v49, s[8:11], s16 offen offset:512 sc1
    buffer_load_dwordx4 a[172:175], v49, s[8:11], s16 offen offset:768 sc1
    buffer_load_dwordx4 a[228:231], v49, s[8:11], s16 offen offset:1024 sc1
    buffer_load_dwordx4 v[148:151], v49, s[8:11], s16 offen offset:1280 sc1
    buffer_load_dwordx4 v[204:207], v49, s[8:11], s17 offen sc1
    s_add_u32 s20, s20, 1
    s_cmp_eq_u32 s20, 7
    s_cselect_b32 s20, 0, s20
    s_mul_i32 s21, s20, 57344
    s_add_u32 s16, s21, s18
    s_add_u32 s17, s21, s19
    buffer_load_dwordx4 a[8:11], v49, s[8:11], s16 offen offset:0 sc1
    buffer_load_dwordx4 a[64:67], v49, s[8:11], s16 offen offset:256 sc1
    buffer_load_dwordx4 a[120:123], v49, s[8:11], s16 offen offset:512 sc1
    buffer_load_dwordx4 a[176:179], v49, s[8:11], s16 offen offset:768 sc1
    buffer_load_dwordx4 a[232:235], v49, s[8:11], s16 offen offset:1024 sc1
    buffer_load_dwordx4 v[152:155], v49, s[8:11], s16 offen offset:1280 sc1
    buffer_load_dwordx4 v[208:211], v49, s[8:11], s17 offen sc1
    s_mul_i32 s21, s20, 57344
    s_add_u32 s21, s21, 28672
    s_add_u32 s16, s21, s18
    s_add_u32 s17, s21, s19
    buffer_load_dwordx4 a[12:15], v49, s[8:11], s16 offen offset:0 sc1
    buffer_load_dwordx4 a[68:71], v49, s[8:11], s16 offen offset:256 sc1
    buffer_load_dwordx4 a[124:127], v49, s[8:11], s16 offen offset:512 sc1
    buffer_load_dwordx4 a[180:183], v49, s[8:11], s16 offen offset:768 sc1
    buffer_load_dwordx4 a[236:239], v49, s[8:11], s16 offen offset:1024 sc1
    buffer_load_dwordx4 v[156:159], v49, s[8:11], s16 offen offset:1280 sc1
    buffer_load_dwordx4 v[212:215], v49, s[8:11], s17 offen sc1
    s_add_u32 s20, s20, 1
    s_cmp_eq_u32 s20, 7
    s_cselect_b32 s20, 0, s20
    s_mul_i32 s21, s20, 57344
    s_add_u32 s16, s21, s18
    s_add_u32 s17, s21, s19
    buffer_load_dwordx4 a[16:19], v49, s[8:11], s16 offen offset:0 sc1
    buffer_load_dwordx4 a[72:75], v49, s[8:11], s16 offen offset:256 sc1
    buffer_load_dwordx4 a[128:131], v49, s[8:11], s16 offen offset:512 sc1
    buffer_load_dwordx4 a[184:187], v49, s[8:11], s16 offen offset:768 sc1
    buffer_load_dwordx4 a[240:243], v49, s[8:11], s16 offen offset:1024 sc1
    buffer_load_dwordx4 v[160:163], v49, s[8:11], s16 offen offset:1280 sc1
    buffer_load_dwordx4 v[216:219], v49, s[8:11], s17 offen sc1
    s_mul_i32 s21, s20, 57344
    s_add_u32 s21, s21, 28672
    s_add_u32 s16, s21, s18
    s_add_u32 s17, s21, s19
    buffer_load_dwordx4 a[20:23], v49, s[8:11], s16 offen offset:0 sc1
    buffer_load_dwordx4 a[76:79], v49, s[8:11], s16 offen offset:256 sc1
    buffer_load_dwordx4 a[132:135], v49, s[8:11], s16 offen offset:512 sc1
    buffer_load_dwordx4 a[188:191], v49, s[8:11], s16 offen offset:768 sc1
    buffer_load_dwordx4 a[244:247], v49, s[8:11], s16 offen offset:1024 sc1
    buffer_load_dwordx4 v[164:167], v49, s[8:11], s16 offen offset:1280 sc1
    buffer_load_dwordx4 v[220:223], v49, s[8:11], s17 offen sc1
    s_add_u32 s20, s20, 1
    s_cmp_eq_u32 s20, 7
    s_cselect_b32 s20, 0, s20
    s_mul_i32 s21, s20, 57344
    s_add_u32 s16, s21, s18
    s_add_u32 s17, s21, s19
    buffer_load_dwordx4 a[24:27], v49, s[8:11], s16 offen offset:0 sc1
    buffer_load_dwordx4 a[80:83], v49, s[8:11], s16 offen offset:256 sc1
    buffer_load_dwordx4 a[136:139], v49, s[8:11], s16 offen offset:512 sc1
    buffer_load_dwordx4 a[192:195], v49, s[8:11], s16 offen offset:768 sc1
    buffer_load_dwordx4 a[248:251], v49, s[8:11], s16 offen offset:1024 sc1
    buffer_load_dwordx4 v[168:171], v49, s[8:11], s16 offen offset:1280 sc1
    buffer_load_dwordx4 v[224:227], v49, s[8:11], s17 offen sc1
    s_mul_i32 s21, s20, 57344
    s_add_u32 s21, s21, 28672
    s_add_u32 s16, s21, s18
    s_add_u32 s17, s21, s19
    buffer_load_dwordx4 a[28:31], v49, s[8:11], s16 offen offset:0 sc1
    buffer_load_dwordx4 a[84:87], v49, s[8:11], s16 offen offset:256 sc1
    buffer_load_dwordx4 a[140:143], v49, s[8:11], s16 offen offset:512 sc1
    buffer_load_dwordx4 a[196:199], v49, s[8:11], s16 offen offset:768 sc1
    buffer_load_dwordx4 a[252:255], v49, s[8:11], s16 offen offset:1024 sc1
    buffer_load_dwordx4 v[172:175], v49, s[8:11], s16 offen offset:1280 sc1
    buffer_load_dwordx4 v[228:231], v49, s[8:11], s17 offen sc1
    s_add_u32 s20, s20, 1
    s_cmp_eq_u32 s20, 7
    s_cselect_b32 s20, 0, s20
    s_waitcnt vmcnt(42)
    s_mul_i32 s21, s20, 57344
    s_add_u32 s16, s21, s18
    s_add_u32 s17, s21, s19
    buffer_load_dwordx4 a[32:35], v49, s[8:11], s16 offen offset:0 sc1
    buffer_load_dwordx4 a[88:91], v49, s[8:11], s16 offen offset:256 sc1
    buffer_load_dwordx4 a[144:147], v49, s[8:11], s16 offen offset:512 sc1
    buffer_load_dwordx4 a[200:203], v49, s[8:11], s16 offen offset:768 sc1
    buffer_load_dwordx4 v[120:123], v49, s[8:11], s16 offen offset:1024 sc1
    buffer_load_dwordx4 v[176:179], v49, s[8:11], s16 offen offset:1280 sc1
    buffer_load_dwordx4 v[232:235], v49, s[8:11], s17 offen sc1
    s_mul_i32 s21, s20, 57344
    s_add_u32 s21, s21, 28672
    s_add_u32 s16, s21, s18
    s_add_u32 s17, s21, s19
    buffer_load_dwordx4 a[36:39], v49, s[8:11], s16 offen offset:0 sc1
    buffer_load_dwordx4 a[92:95], v49, s[8:11], s16 offen offset:256 sc1
    buffer_load_dwordx4 a[148:151], v49, s[8:11], s16 offen offset:512 sc1
    buffer_load_dwordx4 a[204:207], v49, s[8:11], s16 offen offset:768 sc1
    buffer_load_dwordx4 v[124:127], v49, s[8:11], s16 offen offset:1024 sc1
    buffer_load_dwordx4 v[180:183], v49, s[8:11], s16 offen offset:1280 sc1
    buffer_load_dwordx4 v[236:239], v49, s[8:11], s17 offen sc1
    s_add_u32 s20, s20, 1
    s_cmp_eq_u32 s20, 7
    s_cselect_b32 s20, 0, s20
    s_waitcnt vmcnt(42)
    v_lshlrev_b32 v60, 7, v44
    v_add_u32 v60, 8192, v60
    v_mov_b32 v61, 7
    v_cmp_le_u32 vcc, 32, v44
    s_nop 1
    v_cndmask_b32 v61, v61, 4, vcc
    v_and_b32 v62, 7, v44
    v_lshlrev_b32 v62, 7, v62
    v_mov_b32 v63, 28
    v_cmp_le_u32 vcc, 40, v44
    s_nop 1
    v_cndmask_b32 v60, v60, v62, vcc
    v_cndmask_b32 v61, v61, v63, vcc
    s_mov_b32 s36, 108544000
    buffer_load_dword v62, v60, s[8:11], s36 offen sc1
    s_mul_i32 s21, s20, 57344
    s_add_u32 s16, s21, s18
    s_add_u32 s17, s21, s19
    buffer_load_dwordx4 a[40:43], v49, s[8:11], s16 offen offset:0 sc1
    buffer_load_dwordx4 a[96:99], v49, s[8:11], s16 offen offset:256 sc1
    buffer_load_dwordx4 a[152:155], v49, s[8:11], s16 offen offset:512 sc1
    buffer_load_dwordx4 a[208:211], v49, s[8:11], s16 offen offset:768 sc1
    buffer_load_dwordx4 v[128:131], v49, s[8:11], s16 offen offset:1024 sc1
    buffer_load_dwordx4 v[184:187], v49, s[8:11], s16 offen offset:1280 sc1
    buffer_load_dwordx4 v[240:243], v49, s[8:11], s17 offen sc1
    s_mul_i32 s21, s20, 57344
    s_add_u32 s21, s21, 28672
    s_add_u32 s16, s21, s18
    s_add_u32 s17, s21, s19
    buffer_load_dwordx4 a[44:47], v49, s[8:11], s16 offen offset:0 sc1
    buffer_load_dwordx4 a[100:103], v49, s[8:11], s16 offen offset:256 sc1
    buffer_load_dwordx4 a[156:159], v49, s[8:11], s16 offen offset:512 sc1
    buffer_load_dwordx4 a[212:215], v49, s[8:11], s16 offen offset:768 sc1
    buffer_load_dwordx4 v[132:135], v49, s[8:11], s16 offen offset:1024 sc1
    buffer_load_dwordx4 v[188:191], v49, s[8:11], s16 offen offset:1280 sc1
    buffer_load_dwordx4 v[244:247], v49, s[8:11], s17 offen sc1
    s_add_u32 s20, s20, 1
    s_cmp_eq_u32 s20, 7
    s_cselect_b32 s20, 0, s20
    s_waitcnt vmcnt(42)
    s_mul_i32 s21, s20, 57344
    s_add_u32 s16, s21, s18
    s_add_u32 s17, s21, s19
    buffer_load_dwordx4 a[48:51], v49, s[8:11], s16 offen offset:0 sc1
    buffer_load_dwordx4 a[104:107], v49, s[8:11], s16 offen offset:256 sc1
    buffer_load_dwordx4 a[160:163], v49, s[8:11], s16 offen offset:512 sc1
    buffer_load_dwordx4 a[216:219], v49, s[8:11], s16 offen offset:768 sc1
    buffer_load_dwordx4 v[136:139], v49, s[8:11], s16 offen offset:1024 sc1
    buffer_load_dwordx4 v[192:195], v49, s[8:11], s16 offen offset:1280 sc1
    buffer_load_dwordx4 v[248:251], v49, s[8:11], s17 offen sc1
    s_mul_i32 s21, s20, 57344
    s_add_u32 s21, s21, 28672
    s_add_u32 s16, s21, s18
    s_add_u32 s17, s21, s19
    buffer_load_dwordx4 a[52:55], v49, s[8:11], s16 offen offset:0 sc1
    buffer_load_dwordx4 a[108:111], v49, s[8:11], s16 offen offset:256 sc1
    buffer_load_dwordx4 a[164:167], v49, s[8:11], s16 offen offset:512 sc1
    buffer_load_dwordx4 a[220:223], v49, s[8:11], s16 offen offset:768 sc1
    buffer_load_dwordx4 v[140:143], v49, s[8:11], s16 offen offset:1024 sc1
    buffer_load_dwordx4 v[196:199], v49, s[8:11], s16 offen offset:1280 sc1
    buffer_load_dwordx4 v[252:255], v49, s[8:11], s17 offen sc1
    s_add_u32 s20, s20, 1
    s_cmp_eq_u32 s20, 7
    s_cselect_b32 s20, 0, s20
    s_waitcnt vmcnt(42)
    v_mov_b32 v0, 0x4444
    v_and_b32 v47, 2, v44
    v_cmp_ne_u32 vcc, 0, v47
    v_mov_b32 v47, 0xeeee
    s_nop 0
    v_cndmask_b32 v0, v0, v47, vcc
    s_and_b32 s20, s12, 1
    s_cmp_eq_u32 s20, 0
    s_mov_b32 s18, 0x4400
    s_mov_b32 s19, 0xee00
    s_cselect_b32 s20, s18, s19
    v_and_b32 v47, 0xff, v0
    v_or_b32 v47, s20, v47
    v_lshl_or_b32 v0, v47, 16, v0
    v_lshlrev_b32 v47, 4, v44
    s_lshl_b32 s20, s12, 1
    s_lshl_b32 s21, s20, 10
    v_add_u32 v2, s21, v47
    s_add_u32 s20, s20, 1
    s_cmp_eq_u32 s20, 7
    s_cselect_b32 s20, 0, s20
    s_lshl_b32 s21, s20, 10
    v_add_u32 v49, s21, v47
    s_add_u32 s20, s20, 1
    s_cmp_eq_u32 s20, 7
    s_cselect_b32 s20, 0, s20
    s_lshl_b32 s21, s20, 10
    v_add_u32 v11, s21, v47
    s_add_u32 s20, s20, 1
    s_cmp_eq_u32 s20, 7
    s_cselect_b32 s20, 0, s20
    s_lshl_b32 s21, s20, 10
    v_add_u32 v12, s21, v47
    s_add_u32 s20, s20, 1
    s_cmp_eq_u32 s20, 7
    s_cselect_b32 s20, 0, s20
    s_lshl_b32 s21, s20, 10
    v_add_u32 v13, s21, v47
    s_add_u32 s20, s20, 1
    s_cmp_eq_u32 s20, 7
    s_cselect_b32 s20, 0, s20
    s_lshl_b32 s21, s20, 10
    v_add_u32 v14, s21, v47
    s_add_u32 s20, s20, 1
    s_cmp_eq_u32 s20, 7
    s_cselect_b32 s20, 0, s20
    s_lshl_b32 s21, s20, 10
    v_add_u32 v15, s21, v47
    s_add_u32 s20, s20, 1
    s_cmp_eq_u32 s20, 7
    s_cselect_b32 s20, 0, s20
    s_lshl_b32 s20, s12, 11
    s_add_u32 s20, s20, 16384
    v_lshrrev_b32 v47, 2, v46
    v_xor_b32 v47, v47, v45
    v_lshlrev_b32 v47, 3, v47
    v_lshl_add_u32 v47, v46, 5, v47
    v_add_u32 v3, s20, v47
    v_and_b32 v47, 3, v44
    v_xor_b32 v47, v47, v45
    v_lshlrev_b32 v47, 3, v47
    v_lshrrev_b32 v48, 2, v44
    v_lshl_add_u32 v47, v48, 5, v47
    v_add_u32 v4, s20, v47
    v_and_b32 v47, 6, v46
    v_lshlrev_b32 v47, 5, v47
    v_and_b32 v48, 2, v45
    v_lshl_add_u32 v47, v48, 4, v47
    v_and_b32 v48, 1, v46
    v_lshl_add_u32 v47, v48, 4, v47
    v_and_b32 v48, 1, v45
    s_mul_i32 s20, s12, 1536
    v_lshl_add_u32 v5, v48, 9, v47
    v_add_u32 v5, s20, v5
    s_add_u32 s20, s20, 1024
    s_lshr_b32 s21, s12, 1
    s_add_u32 s21, s21, 12
    s_lshl_b32 s21, s21, 9
    s_sub_u32 s21, s21, s20
    v_mul_lo_u32 v48, s21, v48
    v_add3_u32 v6, v47, v48, s20
    s_lshl_b32 s20, s12, 11
    s_add_u32 s20, s20, 33792
    v_lshlrev_b32 v47, 3, v44
    v_add_u32 v7, s20, v47
    v_lshlrev_b32 v47, 2, v45
    v_sub_u32 v47, v46, v47
    v_and_b32 v48, 1, v47
    v_lshlrev_b32 v48, 4, v48
    v_mov_b32 v50, 0x3f80
    v_lshlrev_b32 v48, v48, v50
    v_lshrrev_b32 v47, 1, v47
    v_cmp_eq_u32 vcc, 0, v47
    s_nop 1
    v_cndmask_b32 v50, 0, v48, vcc
    v_cmp_eq_u32 vcc, 1, v47
    s_nop 1
    v_cndmask_b32 v51, 0, v48, vcc
    ds_write_b64 v7, v[50:51] offset:512
    v_and_b32 v48, 1, v45
    s_lshl_b32 s20, s12, 8
    s_add_u32 s20, s20, 32768
    v_lshlrev_b32 v47, 4, v46
    v_lshl_add_u32 v47, v48, 3, v47
    v_add_u32 v8, s20, v47
    s_lshl_b32 s20, s12, 7
    s_add_u32 s20, s20, 33792
    v_lshlrev_b32 v47, 3, v46
    v_lshl_add_u32 v47, v48, 2, v47
    v_and_b32 v49, 8, v46
    v_lshl_add_u32 v47, v49, 9, v47
    v_add_u32 v9, s20, v47
    s_lshl_b32 s20, s12, 6
    v_lshlrev_b32 v48, 4, v48
    v_add_u32 v48, s20, v48
    v_lshl_add_u32 v10, v49, 5, v48
    v_and_b32 v47, 4, v46
    v_lshl_add_u32 v10, v47, 3, v10
    v_and_b32 v47, 3, v46
    v_lshl_add_u32 v10, v47, 2, v10
    v_lshrrev_b32 v48, 1, v48
    v_and_b32 v47, 2, v46
    v_lshl_add_u32 v48, v47, 3, v48
    v_and_b32 v47, 4, v46
    v_add3_u32 v48, v47, v48, 64
    v_add_u32 v48, 448, v48
    v_and_b32 v49, 9, v46
    v_mov_b32 v47, 1073741824
    v_cmp_ne_u32 vcc, 0, v49
    s_nop 1
    v_cndmask_b32 v48, v48, v47, vcc
    v_cmp_lt_u32 vcc, 31, v44
    s_nop 1
    v_cndmask_b32 v10, v10, v48, vcc
    s_mov_b32 s77, 1073741824
    s_mov_b32 s38, 0
    s_mov_b32 s39, -1
    s_mov_b32 s14, 0
    s_mov_b32 s29, -2
    s_mov_b32 s16, 106954752
    s_cmp_eq_u32 s12, 3
    s_mov_b32 s18, 106955776
    s_mov_b32 s19, 106948608
    s_cselect_b32 s17, s19, s18
    s_mul_i32 s23, s13, 640
    s_add_u32 s23, s23, 107413504
    s_mul_i32 s24, s12, 6144
    s_add_u32 s24, s24, 14680064
    s_lshl_b32 s18, s12, 14
    s_mul_i32 s19, s12, 512
    s_add_u32 s19, s19, 108527616
    s_sub_u32 s19, s19, s18
    s_add_u32 s64, s4, s19
    s_addc_u32 s65, s5, 0
    s_and_b32 s65, s65, 0xffff
    s_add_u32 s66, s18, 512
    s_mov_b32 s67, 0x20000
    s_lshl_b32 s69, s13, 2
    s_mov_b32 s70, 1
    s_and_b32 s68, s13, 15
    s_lshl_b32 s68, s68, 8
    s_lshl_b32 s18, s12, 9
    s_sub_u32 s68, s68, s18
    s_add_u32 s68, s68, 108529664
    s_waitcnt vmcnt(28)
    s_branch Lrc_5
Lrp_4:
    s_sleep 1
    buffer_load_dword v62, v60, s[8:11], s36 offen sc1
    s_sub_u32 s15, s15, 1
    s_cbranch_scc1 Lm_exit
    s_waitcnt vmcnt(0)
Lrc_5:
    v_cmp_gt_u32 vcc, v61, v62
    s_cbranch_vccnz Lrp_4
    s_add_u32 s76, s24, 4096
    buffer_load_dwordx4 v[72:75], v2, s[8:11], s24 offen offset:0 sc1
    buffer_load_dwordx4 v[76:79], v2, s[8:11], s24 offen offset:1024 sc1
    buffer_load_dwordx4 v[80:83], v2, s[8:11], s24 offen offset:2048 sc1
    buffer_load_dwordx4 v[84:87], v2, s[8:11], s24 offen offset:3072 sc1
    buffer_load_dwordx4 v[88:91], v2, s[8:11], s76 offen offset:0 sc1
    buffer_load_dwordx4 v[92:95], v2, s[8:11], s76 offen offset:1024 sc1
    buffer_load_dwordx4 v[96:99], v2, s[8:11], s76 offen offset:2048 sc1
    buffer_load_dwordx4 v[100:103], v2, s[8:11], s76 offen offset:3072 sc1
    s_lshl_b32 s18, s12, 14
    s_mul_i32 s19, s12, 7168
    s_add_u32 s19, s19, 17235968
    s_sub_u32 s19, s19, s18
    s_add_u32 s72, s4, s19
    s_addc_u32 s73, s5, 0
    s_and_b32 s73, s73, 0xffff
    s_add_u32 s74, s18, 7168
    s_mov_b32 s75, 0x20000
    s_mul_i32 s18, s13, 28672
    s_add_u32 s72, s72, s18
    s_addc_u32 s73, s73, 0
    s_getpc_b64 s[84:85]
Lpc_6:
    s_add_u32 s84, s84, LstepA-Lpc_6
    s_addc_u32 s85, s85, 0
    v_lshlrev_b32 v104, 7, v44
    global_load_dword v104, v104, s[84:85]
    v_mov_b64 v[44:45], 0
    v_mov_b64 v[46:47], 0
    v_mov_b64 v[48:49], 0
    v_mov_b64 v[50:51], 0
    v_mov_b64 v[52:53], 0
    v_mov_b64 v[54:55], 0
    v_mov_b64 v[56:57], 0
    v_mov_b64 v[58:59], 0
    v_mov_b64 v[60:61], 0
    v_mov_b64 v[62:63], 0
    v_mov_b64 v[64:65], 0
    v_mov_b64 v[66:67], 0
    v_mov_b64 v[68:69], 0
    v_mov_b64 v[70:71], 0
    s_waitcnt vmcnt(0) lgkmcnt(0)
    s_barrier
.p2align 6
    s_nop 0
    s_nop 0
    s_nop 0
    s_nop 0
    s_nop 0
    s_nop 0
    s_nop 0
    s_nop 0
LstepA:
    v_lshrrev_b32 v36, 2, v2
    v_mov_b32 v38, 0
Lh_12:
    v_cmp_gt_u32 vcc, s14, v38
    s_cbranch_vccz Lgo_13
    buffer_load_dword v38, v36, s[8:11], s68 offen sc1
    s_waitcnt vmcnt(24)
    v_cmp_gt_u32 vcc, s14, v38
    s_cbranch_vccz Lgo_13
    buffer_load_dword v38, v36, s[8:11], s68 offen sc1
    s_sub_u32 s15, s15, 1
    s_cbranch_scc0 Lh_12
    s_branch Lm_exit
.p2align 6
Lgo_13:
    s_nop 9
    buffer_load_dwordx4 v[16:19], v2, s[8:11], s16 offen sc1
    v_lshlrev_b32 v1, 3, v2
    s_add_u32 s76, s24, 4096
    s_nop 1
    s_nop 0
    s_nop 2
    s_nop 0
    buffer_load_dwordx4 v[20:23], v2, s[8:11], s17 offen sc1
    s_barrier
    s_nop 0
    buffer_load_dwordx4 v[88:91], v2, s[8:11], s76 offen offset:0 sc1
    s_nop 0
    buffer_load_dwordx4 v[92:95], v2, s[8:11], s76 offen offset:1024 sc1
    s_nop 0
    buffer_load_dwordx4 v[96:99], v2, s[8:11], s76 offen offset:2048 sc1
    s_nop 0
    buffer_load_dwordx4 v[100:103], v2, s[8:11], s76 offen offset:3072 sc1
    s_waitcnt vmcnt(5)
LspecA_7:
    v_smfmac_f32_16x16x64_bf16 v[44:47], v[16:19], a[0:7], v0
    ds_write_b128 v2, v[16:19]
    v_max3_u32 v104, v16, v17, v18
    v_smfmac_f32_16x16x64_bf16 v[48:51], v[16:19], a[56:63], v0
    v_smfmac_f32_16x16x64_bf16 v[52:55], v[16:19], a[112:119], v0
    v_smfmac_f32_16x16x64_bf16 v[56:59], v[16:19], a[168:175], v0
    s_waitcnt vmcnt(4)
    ds_write_b128 v2, v[20:23] offset:1024
    v_max3_u32 v105, v19, v20, v21
    v_smfmac_f32_16x16x64_bf16 v[60:63], v[16:19], a[224:231], v0
    v_max3_u32 v104, v104, v22, v23
    v_smfmac_f32_16x16x64_bf16 v[64:67], v[16:19], v[144:151], v0
    v_max_u32 v104, v104, v105
    v_smfmac_f32_16x16x64_bf16 v[68:71], v[16:19], v[200:207], v0
    v_cmp_eq_u32 vcc, -1, v104
    v_smfmac_f32_16x16x64_bf16 v[44:47], v[20:23], a[8:15], v0
    v_smfmac_f32_16x16x64_bf16 v[48:51], v[20:23], a[64:71], v0
    s_cbranch_vccnz LretryA_8
    v_smfmac_f32_16x16x64_bf16 v[52:55], v[20:23], a[120:127], v0
    s_waitcnt lgkmcnt(0)
    s_barrier
    ds_read_b128 v[24:27], v11
    v_smfmac_f32_16x16x64_bf16 v[56:59], v[20:23], a[176:183], v0
    buffer_load_dword v1, v1, s[72:75], 0 offen sc1
    ds_read_b128 v[28:31], v12
    v_smfmac_f32_16x16x64_bf16 v[60:63], v[20:23], a[232:239], v0
    ds_read_b128 v[32:35], v13
    v_smfmac_f32_16x16x64_bf16 v[64:67], v[20:23], v[152:159], v0
    ds_read_b128 v[36:39], v14
    v_smfmac_f32_16x16x64_bf16 v[68:71], v[20:23], v[208:215], v0
    ds_read_b128 v[40:43], v15
    s_waitcnt lgkmcnt(4)
    v_smfmac_f32_16x16x64_bf16 v[44:47], v[24:27], a[16:23], v0
    ds_read_b128 v[104:107], v5
    v_smfmac_f32_16x16x64_bf16 v[48:51], v[24:27], a[72:79], v0
    ds_read_b128 v[108:111], v5 offset:256
    v_smfmac_f32_16x16x64_bf16 v[52:55], v[24:27], a[128:135], v0
    ds_read_b128 v[112:115], v6
    v_smfmac_f32_16x16x64_bf16 v[56:59], v[24:27], a[184:191], v0
    ds_read_b128 v[116:119], v6 offset:256
    v_smfmac_f32_16x16x64_bf16 v[60:63], v[24:27], a[240:247], v0
    v_smfmac_f32_16x16x64_bf16 v[64:67], v[24:27], v[160:167], v0
    s_waitcnt lgkmcnt(4)
    v_mov_b64 v[16:17], 0
    v_smfmac_f32_16x16x64_bf16 v[44:47], v[28:31], a[24:31], v0
    v_mov_b64 v[18:19], 0
    v_smfmac_f32_16x16x64_bf16 v[44:47], v[32:35], a[32:39], v0
    v_mov_b64 v[20:21], 0
    v_smfmac_f32_16x16x64_bf16 v[44:47], v[36:39], a[40:47], v0
    v_mov_b64 v[22:23], 0
    v_smfmac_f32_16x16x64_bf16 v[44:47], v[40:43], a[48:55], v0
    s_nop 1
    v_smfmac_f32_16x16x64_bf16 v[48:51], v[28:31], a[80:87], v0
    s_nop 1
    v_smfmac_f32_16x16x64_bf16 v[48:51], v[32:35], a[88:95], v0
    s_nop 1
    v_add_f32 v44, v44, v46
    v_smfmac_f32_16x16x64_bf16 v[48:51], v[36:39], a[96:103], v0
    v_add_f32 v45, v45, v47
    v_smfmac_f32_16x16x64_bf16 v[48:51], v[40:43], a[104:111], v0
    s_nop 1
    v_cvt_pk_bf16_f32 v46, v44, v45
    v_smfmac_f32_16x16x64_bf16 v[52:55], v[28:31], a[136:143], v0
    s_nop 1
    v_smfmac_f32_16x16x64_bf16 v[52:55], v[32:35], a[144:151], v0
    s_nop 1
    v_add_f32 v48, v48, v50
    v_smfmac_f32_16x16x64_bf16 v[52:55], v[36:39], a[152:159], v0
    v_add_f32 v49, v49, v51
    v_smfmac_f32_16x16x64_bf16 v[52:55], v[40:43], a[160:167], v0
    s_nop 1
    v_cvt_pk_bf16_f32 v47, v48, v49
    v_smfmac_f32_16x16x64_bf16 v[56:59], v[28:31], a[192:199], v0
    ds_write_b64 v3, v[46:47] offset:0
    ds_read_b64_tr_b16 v[44:45], v4 offset:0
    v_smfmac_f32_16x16x64_bf16 v[56:59], v[32:35], a[200:207], v0
    s_nop 1
    v_add_f32 v52, v52, v54
    v_smfmac_f32_16x16x64_bf16 v[56:59], v[36:39], a[208:215], v0
    v_add_f32 v53, v53, v55
    v_smfmac_f32_16x16x64_bf16 v[56:59], v[40:43], a[216:223], v0
    s_nop 1
    v_cvt_pk_bf16_f32 v54, v52, v53
    v_smfmac_f32_16x16x64_bf16 v[60:63], v[28:31], a[248:255], v0
    s_nop 1
    v_mov_b64 v[48:49], 0
    v_smfmac_f32_16x16x64_bf16 v[60:63], v[32:35], v[120:127], v0
    s_nop 1
    v_add_f32 v56, v56, v58
    v_smfmac_f32_16x16x64_bf16 v[60:63], v[36:39], v[128:135], v0
    v_add_f32 v57, v57, v59
    v_smfmac_f32_16x16x64_bf16 v[60:63], v[40:43], v[136:143], v0
    s_nop 1
    v_cvt_pk_bf16_f32 v55, v56, v57
    v_smfmac_f32_16x16x64_bf16 v[64:67], v[28:31], v[168:175], v0
    ds_write_b64 v3, v[54:55] offset:512
    ds_read_b64_tr_b16 v[46:47], v4 offset:512
    v_mov_b64 v[50:51], 0
    v_smfmac_f32_16x16x64_bf16 v[64:67], v[32:35], v[176:183], v0
    s_nop 1
    v_add_f32 v60, v60, v62
    v_smfmac_f32_16x16x64_bf16 v[64:67], v[36:39], v[184:191], v0
    ds_read_b64 v[56:57], v7 offset:512
    v_add_f32 v61, v61, v63
    v_smfmac_f32_16x16x64_bf16 v[64:67], v[40:43], v[192:199], v0
    s_nop 1
    v_cvt_pk_bf16_f32 v62, v60, v61
    v_smfmac_f32_16x16x64_bf16 v[68:71], v[24:27], v[216:223], v0
    s_nop 1
    v_smfmac_f32_16x16x64_bf16 v[68:71], v[28:31], v[224:231], v0
    s_nop 1
    v_add_f32 v64, v64, v66
    v_smfmac_f32_16x16x64_bf16 v[68:71], v[32:35], v[232:239], v0
    v_add_f32 v65, v65, v67
    v_smfmac_f32_16x16x64_bf16 v[68:71], v[36:39], v[240:247], v0
    v_cvt_pk_bf16_f32 v63, v64, v65
    v_smfmac_f32_16x16x64_bf16 v[68:71], v[40:43], v[248:255], v0
    ds_write_b64 v3, v[62:63] offset:1024
    ds_read_b64_tr_b16 v[52:53], v4 offset:1024
    s_waitcnt lgkmcnt(2) vmcnt(1)
    v_smfmac_f32_16x16x64_bf16 v[16:19], v[44:47], v[72:79], v0
    s_nop 1
    v_smfmac_f32_16x16x64_bf16 v[20:23], v[44:47], v[80:87], v0
    s_nop 0
    v_cvt_pk_bf16_f32 v68, v68, v69
    v_cvt_pk_bf16_f32 v69, v70, v71
    s_nop 1
    v_mfma_f32_16x16x16_bf16 v[60:63], v[68:69], v[56:57], 0
    s_nop 1
    v_smfmac_f32_16x16x64_bf16 v[48:51], v[44:47], v[104:111], v0
    s_nop 1
    v_lshlrev_b32 v36, 3, v2
    v_mov_b32 v37, s70
    s_waitcnt lgkmcnt(0)
    v_cvt_pk_bf16_f32 v54, v60, v61
    v_cvt_pk_bf16_f32 v55, v62, v63
    s_nop 1
    v_smfmac_f32_16x16x64_bf16 v[16:19], v[52:55], v[88:95], v0 abid:1
    s_nop 1
    v_smfmac_f32_16x16x64_bf16 v[20:23], v[52:55], v[96:103], v0 abid:1
    s_nop 1
    v_smfmac_f32_16x16x64_bf16 v[48:51], v[52:55], v[112:119], v0 abid:1
    s_nop 1
    v_add_f32 v28, v16, v18
    v_add_f32 v30, v17, v19
    s_nop 0
    v_add_f32 v29, v20, v22
    v_add_f32 v31, v21, v23
    ds_write_b128 v2, v[28:31] offset:32768
    v_pk_add_f32 v[32:33], v[48:49], v[50:51]
    ds_write_b64 v7, v[32:33]
    v_mov_b64 v[44:45], 0
    s_nop 2
    v_mov_b64 v[46:47], 0
    s_nop 2
    v_mov_b64 v[56:57], 0
    s_waitcnt lgkmcnt(0)
    s_barrier
    ds_read2st64_b32 v[24:25], v9 offset0:0 offset1:8
    ds_read_b64 v[16:17], v8 offset:0
    ds_read_b64 v[18:19], v8 offset:2048
    ds_read_b64 v[20:21], v8 offset:4096
    ds_read_b64 v[22:23], v8 offset:6144
    v_mov_b64 v[58:59], 0
    s_nop 2
    v_mov_b64 v[60:61], 0
    s_waitcnt lgkmcnt(4)
    v_add_f32 v24, v24, v25
    s_waitcnt lgkmcnt(2)
    v_pk_add_f32 v[16:17], v[16:17], v[18:19]
    v_add_f32_dpp v24, v24, v24 row_ror:8 row_mask:0xf bank_mask:0xf
    buffer_store_dword v37, v36, s[64:67], s69 offen
    s_waitcnt lgkmcnt(0)
    v_pk_add_f32 v[20:21], v[20:21], v[22:23]
    v_exp_f32 v28, v24
    v_pk_add_f32 v[16:17], v[16:17], v[20:21]
    v_exp_f32 v30, v16
    v_exp_f32 v31, v17
    v_fma_f32 v26, 0.5, v28, v30
    v_add_f32 v26, v26, v31
    v_mov_b32_dpp v29, v28 quad_perm:[1,0,3,2] row_mask:0xf bank_mask:0xf
    v_cndmask_b32 v30, v30, v28, s[38:39]
    v_add_f32_dpp v26, v26, v26 quad_perm:[1,0,3,2] row_mask:0xf bank_mask:0xf
    v_cndmask_b32 v31, v31, v29, s[38:39]
    v_max3_f32 v27, abs(v16), abs(v17), abs(v24)
    v_add_f32_dpp v26, v26, v26 quad_perm:[2,3,0,1] row_mask:0xf bank_mask:0xf
    v_cmp_nge_f32 vcc, 0x42800000, v27
    s_nop 0
    v_add_f32_dpp v26, v26, v26 row_half_mirror row_mask:0xf bank_mask:0xf
    s_nop 1
    v_add_f32_dpp v26, v26, v26 row_mirror row_mask:0xf bank_mask:0xf
    v_rcp_f32 v26, v26
    s_cbranch_vccnz LslowA_9
    v_mul_f32 v30, v30, v26
    v_mul_f32 v31, v31, v26
    v_cvt_pk_bf16_f32 v26, v30, v31
LpubA_10:
    buffer_store_dword v26, v10, s[8:11], s23 offen
LncA_14:
    s_add_u32 s24, s24, 32768
    s_add_u32 s76, s24, 4096
    s_sleep 7
    buffer_load_dwordx4 v[72:75], v2, s[8:11], s24 offen offset:0 sc1
    buffer_load_dwordx4 v[76:79], v2, s[8:11], s24 offen offset:1024 sc1
    buffer_load_dwordx4 v[80:83], v2, s[8:11], s24 offen offset:2048 sc1
    buffer_load_dwordx4 v[84:87], v2, s[8:11], s24 offen offset:3072 sc1
    s_add_u32 s23, s23, 10240
    s_add_u32 s72, s72, 458752
    s_addc_u32 s73, s73, 0
    v_mov_b64 v[62:63], 0
    v_mov_b64 v[64:65], 0
    v_mov_b64 v[66:67], 0
    v_mov_b64 v[68:69], 0
    v_mov_b64 v[70:71], 0
    v_mov_b64 v[52:53], 0
    v_mov_b64 v[54:55], 0
    v_mov_b64 v[48:49], 0
    v_mov_b64 v[50:51], 0
    s_add_u32 s16, s16, 7168
    s_add_u32 s17, s17, 7168
    s_add_u32 s70, s70, 1
    s_add_u32 s14, s14, 1
    s_cmp_lt_u32 s14, 63
    s_cbranch_scc1 LstepA
    s_branch LendA_11
LretryA_8:
Lbp_15:
    buffer_load_dwordx4 v[16:19], v2, s[8:11], s16 offen sc1
    buffer_load_dwordx4 v[20:23], v2, s[8:11], s17 offen sc1
    s_sub_u32 s15, s15, 1
    s_cbranch_scc1 Lm_exit
    s_waitcnt vmcnt(0)
    v_max3_u32 v104, v16, v17, v18
    v_max3_u32 v105, v19, v20, v21
    v_max3_u32 v104, v104, v22, v23
    v_max_u32 v104, v104, v105
    v_cmp_eq_u32 vcc, -1, v104
    s_cbranch_vccnz Lbp_15
    v_lshlrev_b32 v1, 3, v2
    v_mov_b64 v[44:45], 0
    v_mov_b64 v[46:47], 0
    v_mov_b64 v[48:49], 0
    v_mov_b64 v[50:51], 0
    v_mov_b64 v[52:53], 0
    v_mov_b64 v[54:55], 0
    v_mov_b64 v[56:57], 0
    v_mov_b64 v[58:59], 0
    v_mov_b64 v[60:61], 0
    v_mov_b64 v[62:63], 0
    v_mov_b64 v[64:65], 0
    v_mov_b64 v[66:67], 0
    v_mov_b64 v[68:69], 0
    v_mov_b64 v[70:71], 0
    s_branch LspecA_7
LslowA_9:
    v_max3_f32 v26, v16, v17, v24
    s_nop 1
    v_max_f32_dpp v26, v26, v26 quad_perm:[1,0,3,2] row_mask:0xf bank_mask:0xf
    s_nop 1
    v_max_f32_dpp v26, v26, v26 quad_perm:[2,3,0,1] row_mask:0xf bank_mask:0xf
    s_nop 1
    v_max_f32_dpp v26, v26, v26 row_half_mirror row_mask:0xf bank_mask:0xf
    s_nop 1
    v_max_f32_dpp v26, v26, v26 row_mirror row_mask:0xf bank_mask:0xf
    v_sub_f32 v28, v24, v26
    v_sub_f32 v30, v16, v26
    v_sub_f32 v31, v17, v26
    v_exp_f32 v28, v28
    v_exp_f32 v30, v30
    v_exp_f32 v31, v31
    v_fma_f32 v26, 0.5, v28, v30
    v_add_f32 v26, v26, v31
    v_mov_b32_dpp v29, v28 quad_perm:[1,0,3,2] row_mask:0xf bank_mask:0xf
    v_cndmask_b32 v30, v30, v28, s[38:39]
    v_add_f32_dpp v26, v26, v26 quad_perm:[1,0,3,2] row_mask:0xf bank_mask:0xf
    v_cndmask_b32 v31, v31, v29, s[38:39]
    s_nop 0
    v_add_f32_dpp v26, v26, v26 quad_perm:[2,3,0,1] row_mask:0xf bank_mask:0xf
    s_nop 1
    v_add_f32_dpp v26, v26, v26 row_half_mirror row_mask:0xf bank_mask:0xf
    s_nop 1
    v_add_f32_dpp v26, v26, v26 row_mirror row_mask:0xf bank_mask:0xf
    v_rcp_f32 v26, v26
    s_nop 0
    v_mul_f32 v30, v30, v26
    v_mul_f32 v31, v31, v26
    v_cvt_pk_bf16_f32 v26, v30, v31
    v_min_u32 v26, s29, v26
    s_branch LpubA_10
LendA_11:
    s_endpgm
Lm_B:
    v_and_b32 v44, 63, v0
    v_lshrrev_b32 v45, 4, v44
    v_and_b32 v46, 15, v44
    s_sub_u32 s34, s13, 16
    s_mul_i32 s18, s12, 1792
    s_mul_i32 s19, s34, 7168
    s_add_u32 s18, s18, s19
    s_add_u32 s18, s18, 6422528
    v_mul_u32_u24 v49, 114688, v45
    v_lshl_add_u32 v52, v46, 4, v49
    s_lshl_b32 s20, s12, 1
    v_mbcnt_lo_u32_b32 v60, -1, 0
    v_min_u32 v60, 3, v60
    v_lshlrev_b32 v60, 7, v60
    s_branch Lwc_17
Lww_16:
    s_sleep 2
Lwc_17:
    buffer_load_dword v61, v60, s[8:11], s36 offen sc1
    s_sub_u32 s15, s15, 1
    s_cbranch_scc1 Lm_exit
    s_waitcnt vmcnt(0)
    v_cmp_gt_u32 vcc, 7, v61
    s_cbranch_vccnz Lww_16
    s_mul_i32 s21, s20, 917504
    s_add_u32 s16, s21, s18
    buffer_load_dwordx4 a[0:3], v52, s[8:11], s16 offen offset:0 sc1
    buffer_load_dwordx4 a[56:59], v52, s[8:11], s16 offen offset:256 sc1
    buffer_load_dwordx4 a[112:115], v52, s[8:11], s16 offen offset:512 sc1
    buffer_load_dwordx4 a[168:171], v52, s[8:11], s16 offen offset:768 sc1
    buffer_load_dwordx4 a[224:227], v52, s[8:11], s16 offen offset:1024 sc1
    buffer_load_dwordx4 v[144:147], v52, s[8:11], s16 offen offset:1280 sc1
    buffer_load_dwordx4 v[200:203], v52, s[8:11], s16 offen offset:1536 sc1
    s_mul_i32 s21, s20, 917504
    s_add_u32 s21, s21, 458752
    s_add_u32 s16, s21, s18
    buffer_load_dwordx4 a[4:7], v52, s[8:11], s16 offen offset:0 sc1
    buffer_load_dwordx4 a[60:63], v52, s[8:11], s16 offen offset:256 sc1
    buffer_load_dwordx4 a[116:119], v52, s[8:11], s16 offen offset:512 sc1
    buffer_load_dwordx4 a[172:175], v52, s[8:11], s16 offen offset:768 sc1
    buffer_load_dwordx4 a[228:231], v52, s[8:11], s16 offen offset:1024 sc1
    buffer_load_dwordx4 v[148:151], v52, s[8:11], s16 offen offset:1280 sc1
    buffer_load_dwordx4 v[204:207], v52, s[8:11], s16 offen offset:1536 sc1
    s_add_u32 s20, s20, 1
    s_cmp_eq_u32 s20, 7
    s_cselect_b32 s20, 0, s20
    s_mul_i32 s21, s20, 917504
    s_add_u32 s16, s21, s18
    buffer_load_dwordx4 a[8:11], v52, s[8:11], s16 offen offset:0 sc1
    buffer_load_dwordx4 a[64:67], v52, s[8:11], s16 offen offset:256 sc1
    buffer_load_dwordx4 a[120:123], v52, s[8:11], s16 offen offset:512 sc1
    buffer_load_dwordx4 a[176:179], v52, s[8:11], s16 offen offset:768 sc1
    buffer_load_dwordx4 a[232:235], v52, s[8:11], s16 offen offset:1024 sc1
    buffer_load_dwordx4 v[152:155], v52, s[8:11], s16 offen offset:1280 sc1
    buffer_load_dwordx4 v[208:211], v52, s[8:11], s16 offen offset:1536 sc1
    s_mul_i32 s21, s20, 917504
    s_add_u32 s21, s21, 458752
    s_add_u32 s16, s21, s18
    buffer_load_dwordx4 a[12:15], v52, s[8:11], s16 offen offset:0 sc1
    buffer_load_dwordx4 a[68:71], v52, s[8:11], s16 offen offset:256 sc1
    buffer_load_dwordx4 a[124:127], v52, s[8:11], s16 offen offset:512 sc1
    buffer_load_dwordx4 a[180:183], v52, s[8:11], s16 offen offset:768 sc1
    buffer_load_dwordx4 a[236:239], v52, s[8:11], s16 offen offset:1024 sc1
    buffer_load_dwordx4 v[156:159], v52, s[8:11], s16 offen offset:1280 sc1
    buffer_load_dwordx4 v[212:215], v52, s[8:11], s16 offen offset:1536 sc1
    s_add_u32 s20, s20, 1
    s_cmp_eq_u32 s20, 7
    s_cselect_b32 s20, 0, s20
    s_mul_i32 s21, s20, 917504
    s_add_u32 s16, s21, s18
    buffer_load_dwordx4 a[16:19], v52, s[8:11], s16 offen offset:0 sc1
    buffer_load_dwordx4 a[72:75], v52, s[8:11], s16 offen offset:256 sc1
    buffer_load_dwordx4 a[128:131], v52, s[8:11], s16 offen offset:512 sc1
    buffer_load_dwordx4 a[184:187], v52, s[8:11], s16 offen offset:768 sc1
    buffer_load_dwordx4 a[240:243], v52, s[8:11], s16 offen offset:1024 sc1
    buffer_load_dwordx4 v[160:163], v52, s[8:11], s16 offen offset:1280 sc1
    buffer_load_dwordx4 v[216:219], v52, s[8:11], s16 offen offset:1536 sc1
    s_mul_i32 s21, s20, 917504
    s_add_u32 s21, s21, 458752
    s_add_u32 s16, s21, s18
    buffer_load_dwordx4 a[20:23], v52, s[8:11], s16 offen offset:0 sc1
    buffer_load_dwordx4 a[76:79], v52, s[8:11], s16 offen offset:256 sc1
    buffer_load_dwordx4 a[132:135], v52, s[8:11], s16 offen offset:512 sc1
    buffer_load_dwordx4 a[188:191], v52, s[8:11], s16 offen offset:768 sc1
    buffer_load_dwordx4 a[244:247], v52, s[8:11], s16 offen offset:1024 sc1
    buffer_load_dwordx4 v[164:167], v52, s[8:11], s16 offen offset:1280 sc1
    buffer_load_dwordx4 v[220:223], v52, s[8:11], s16 offen offset:1536 sc1
    s_add_u32 s20, s20, 1
    s_cmp_eq_u32 s20, 7
    s_cselect_b32 s20, 0, s20
    s_mul_i32 s21, s20, 917504
    s_add_u32 s16, s21, s18
    buffer_load_dwordx4 a[24:27], v52, s[8:11], s16 offen offset:0 sc1
    buffer_load_dwordx4 a[80:83], v52, s[8:11], s16 offen offset:256 sc1
    buffer_load_dwordx4 a[136:139], v52, s[8:11], s16 offen offset:512 sc1
    buffer_load_dwordx4 a[192:195], v52, s[8:11], s16 offen offset:768 sc1
    buffer_load_dwordx4 a[248:251], v52, s[8:11], s16 offen offset:1024 sc1
    buffer_load_dwordx4 v[168:171], v52, s[8:11], s16 offen offset:1280 sc1
    buffer_load_dwordx4 v[224:227], v52, s[8:11], s16 offen offset:1536 sc1
    s_mul_i32 s21, s20, 917504
    s_add_u32 s21, s21, 458752
    s_add_u32 s16, s21, s18
    buffer_load_dwordx4 a[28:31], v52, s[8:11], s16 offen offset:0 sc1
    buffer_load_dwordx4 a[84:87], v52, s[8:11], s16 offen offset:256 sc1
    buffer_load_dwordx4 a[140:143], v52, s[8:11], s16 offen offset:512 sc1
    buffer_load_dwordx4 a[196:199], v52, s[8:11], s16 offen offset:768 sc1
    buffer_load_dwordx4 a[252:255], v52, s[8:11], s16 offen offset:1024 sc1
    buffer_load_dwordx4 v[172:175], v52, s[8:11], s16 offen offset:1280 sc1
    buffer_load_dwordx4 v[228:231], v52, s[8:11], s16 offen offset:1536 sc1
    s_add_u32 s20, s20, 1
    s_cmp_eq_u32 s20, 7
    s_cselect_b32 s20, 0, s20
    s_waitcnt vmcnt(42)
    s_mul_i32 s21, s20, 917504
    s_add_u32 s16, s21, s18
    buffer_load_dwordx4 a[32:35], v52, s[8:11], s16 offen offset:0 sc1
    buffer_load_dwordx4 a[88:91], v52, s[8:11], s16 offen offset:256 sc1
    buffer_load_dwordx4 a[144:147], v52, s[8:11], s16 offen offset:512 sc1
    buffer_load_dwordx4 a[200:203], v52, s[8:11], s16 offen offset:768 sc1
    buffer_load_dwordx4 v[120:123], v52, s[8:11], s16 offen offset:1024 sc1
    buffer_load_dwordx4 v[176:179], v52, s[8:11], s16 offen offset:1280 sc1
    buffer_load_dwordx4 v[232:235], v52, s[8:11], s16 offen offset:1536 sc1
    s_mul_i32 s21, s20, 917504
    s_add_u32 s21, s21, 458752
    s_add_u32 s16, s21, s18
    buffer_load_dwordx4 a[36:39], v52, s[8:11], s16 offen offset:0 sc1
    buffer_load_dwordx4 a[92:95], v52, s[8:11], s16 offen offset:256 sc1
    buffer_load_dwordx4 a[148:151], v52, s[8:11], s16 offen offset:512 sc1
    buffer_load_dwordx4 a[204:207], v52, s[8:11], s16 offen offset:768 sc1
    buffer_load_dwordx4 v[124:127], v52, s[8:11], s16 offen offset:1024 sc1
    buffer_load_dwordx4 v[180:183], v52, s[8:11], s16 offen offset:1280 sc1
    buffer_load_dwordx4 v[236:239], v52, s[8:11], s16 offen offset:1536 sc1
    s_add_u32 s20, s20, 1
    s_cmp_eq_u32 s20, 7
    s_cselect_b32 s20, 0, s20
    s_waitcnt vmcnt(42)
    v_lshlrev_b32 v60, 7, v44
    v_add_u32 v60, 8192, v60
    v_mov_b32 v61, 7
    v_cmp_le_u32 vcc, 32, v44
    s_nop 1
    v_cndmask_b32 v61, v61, 4, vcc
    v_and_b32 v62, 7, v44
    v_lshlrev_b32 v62, 7, v62
    v_mov_b32 v63, 28
    v_cmp_le_u32 vcc, 40, v44
    s_nop 1
    v_cndmask_b32 v60, v60, v62, vcc
    v_cndmask_b32 v61, v61, v63, vcc
    s_mov_b32 s36, 108544000
    buffer_load_dword v62, v60, s[8:11], s36 offen sc1
    s_mul_i32 s21, s20, 917504
    s_add_u32 s16, s21, s18
    buffer_load_dwordx4 a[40:43], v52, s[8:11], s16 offen offset:0 sc1
    buffer_load_dwordx4 a[96:99], v52, s[8:11], s16 offen offset:256 sc1
    buffer_load_dwordx4 a[152:155], v52, s[8:11], s16 offen offset:512 sc1
    buffer_load_dwordx4 a[208:211], v52, s[8:11], s16 offen offset:768 sc1
    buffer_load_dwordx4 v[128:131], v52, s[8:11], s16 offen offset:1024 sc1
    buffer_load_dwordx4 v[184:187], v52, s[8:11], s16 offen offset:1280 sc1
    buffer_load_dwordx4 v[240:243], v52, s[8:11], s16 offen offset:1536 sc1
    s_mul_i32 s21, s20, 917504
    s_add_u32 s21, s21, 458752
    s_add_u32 s16, s21, s18
    buffer_load_dwordx4 a[44:47], v52, s[8:11], s16 offen offset:0 sc1
    buffer_load_dwordx4 a[100:103], v52, s[8:11], s16 offen offset:256 sc1
    buffer_load_dwordx4 a[156:159], v52, s[8:11], s16 offen offset:512 sc1
    buffer_load_dwordx4 a[212:215], v52, s[8:11], s16 offen offset:768 sc1
    buffer_load_dwordx4 v[132:135], v52, s[8:11], s16 offen offset:1024 sc1
    buffer_load_dwordx4 v[188:191], v52, s[8:11], s16 offen offset:1280 sc1
    buffer_load_dwordx4 v[244:247], v52, s[8:11], s16 offen offset:1536 sc1
    s_add_u32 s20, s20, 1
    s_cmp_eq_u32 s20, 7
    s_cselect_b32 s20, 0, s20
    s_waitcnt vmcnt(42)
    s_mul_i32 s21, s20, 917504
    s_add_u32 s16, s21, s18
    buffer_load_dwordx4 a[48:51], v52, s[8:11], s16 offen offset:0 sc1
    buffer_load_dwordx4 a[104:107], v52, s[8:11], s16 offen offset:256 sc1
    buffer_load_dwordx4 a[160:163], v52, s[8:11], s16 offen offset:512 sc1
    buffer_load_dwordx4 a[216:219], v52, s[8:11], s16 offen offset:768 sc1
    buffer_load_dwordx4 v[136:139], v52, s[8:11], s16 offen offset:1024 sc1
    buffer_load_dwordx4 v[192:195], v52, s[8:11], s16 offen offset:1280 sc1
    buffer_load_dwordx4 v[248:251], v52, s[8:11], s16 offen offset:1536 sc1
    s_mul_i32 s21, s20, 917504
    s_add_u32 s21, s21, 458752
    s_add_u32 s16, s21, s18
    buffer_load_dwordx4 a[52:55], v52, s[8:11], s16 offen offset:0 sc1
    buffer_load_dwordx4 a[108:111], v52, s[8:11], s16 offen offset:256 sc1
    buffer_load_dwordx4 a[164:167], v52, s[8:11], s16 offen offset:512 sc1
    buffer_load_dwordx4 a[220:223], v52, s[8:11], s16 offen offset:768 sc1
    buffer_load_dwordx4 v[140:143], v52, s[8:11], s16 offen offset:1024 sc1
    buffer_load_dwordx4 v[196:199], v52, s[8:11], s16 offen offset:1280 sc1
    buffer_load_dwordx4 v[252:255], v52, s[8:11], s16 offen offset:1536 sc1
    s_add_u32 s20, s20, 1
    s_cmp_eq_u32 s20, 7
    s_cselect_b32 s20, 0, s20
    s_waitcnt vmcnt(42)
    v_mov_b32 v0, 0x4444
    v_and_b32 v47, 2, v44
    v_cmp_ne_u32 vcc, 0, v47
    v_mov_b32 v47, 0xeeee
    s_nop 0
    v_cndmask_b32 v0, v0, v47, vcc
    v_lshlrev_b32 v47, 4, v44
    s_lshl_b32 s20, s12, 1
    s_lshl_b32 s21, s20, 10
    v_add_u32 v1, s21, v47
    s_add_u32 s20, s20, 1
    s_cmp_eq_u32 s20, 7
    s_cselect_b32 s20, 0, s20
    s_lshl_b32 s21, s20, 10
    v_add_u32 v49, s21, v47
    s_add_u32 s20, s20, 1
    s_cmp_eq_u32 s20, 7
    s_cselect_b32 s20, 0, s20
    s_lshl_b32 s21, s20, 10
    v_add_u32 v11, s21, v47
    s_add_u32 s20, s20, 1
    s_cmp_eq_u32 s20, 7
    s_cselect_b32 s20, 0, s20
    s_lshl_b32 s21, s20, 10
    v_add_u32 v12, s21, v47
    s_add_u32 s20, s20, 1
    s_cmp_eq_u32 s20, 7
    s_cselect_b32 s20, 0, s20
    s_lshl_b32 s21, s20, 10
    v_add_u32 v13, s21, v47
    s_add_u32 s20, s20, 1
    s_cmp_eq_u32 s20, 7
    s_cselect_b32 s20, 0, s20
    s_lshl_b32 s21, s20, 10
    v_add_u32 v14, s21, v47
    s_add_u32 s20, s20, 1
    s_cmp_eq_u32 s20, 7
    s_cselect_b32 s20, 0, s20
    s_lshl_b32 s21, s20, 10
    v_add_u32 v15, s21, v47
    s_add_u32 s20, s20, 1
    s_cmp_eq_u32 s20, 7
    s_cselect_b32 s20, 0, s20
    s_lshl_b32 s21, s12, 11
    s_add_u32 s21, s21, 40960
    v_lshlrev_b32 v50, 4, v46
    v_lshl_add_u32 v3, v45, 2, v50
    v_add_u32 v3, s21, v3
    v_lshrrev_b32 v47, 1, v45
    v_and_b32 v48, 1, v45
    v_min_u32 v49, 13, v46
    v_mul_u32_u24 v50, 28, v47
    v_lshl_add_u32 v50, v49, 1, v50
    v_lshlrev_b32 v50, 4, v50
    v_add_u32 v4, s21, v50
    v_mul_u32_u24 v50, 28672, v47
    v_mul_u32_u24 v5, 7168, v48
    v_add_u32 v5, v5, v50
    v_lshl_add_u32 v5, v49, 4, v5
    v_mul_u32_u24 v6, 640, v45
    v_lshl_add_u32 v2, v46, 3, v6
    v_lshl_add_u32 v6, v46, 4, v6
    s_lshl_b32 s20, s12, 8
    s_add_u32 s20, s20, 32768
    v_lshlrev_b32 v50, 4, v46
    v_lshl_add_u32 v50, v48, 3, v50
    v_add_u32 v7, s20, v50
    s_lshl_b32 s20, s12, 6
    v_lshlrev_b32 v48, 4, v48
    v_add_u32 v48, s20, v48
    s_mul_i32 s19, s34, 14
    v_add_u32 v49, s19, v46
    v_lshrrev_b32 v47, 3, v49
    v_lshl_add_u32 v9, v47, 8, v48
    v_and_b32 v47, 1, v49
    v_lshl_add_u32 v9, v47, 5, v9
    v_and_b32 v47, 6, v49
    v_lshl_add_u32 v9, v47, 1, v9
    v_mov_b32 v47, 1073741824
    v_cmp_lt_u32 vcc, 13, v46
    s_nop 1
    v_cndmask_b32 v9, v9, v47, vcc
    v_cmp_lt_u32 vcc, 31, v44
    s_nop 1
    v_cndmask_b32 v9, v9, v47, vcc
    s_lshl_b32 s19, s34, 2
    s_add_u32 s69, s19, s12
    s_mul_i32 s19, s69, 0
    s_add_u32 s19, s19, 17235968
    v_lshlrev_b32 v8, 7, v44
    v_add_u32 v8, s19, v8
    v_mov_b32 v10, 458752
    v_cmp_le_u32 vcc, 0, v44
    s_nop 1
    v_cndmask_b32 v8, v8, v47, vcc
    s_mul_i32 s19, s69, 512
    s_add_u32 s19, s19, 14745600
    s_mov_b32 s20, 32768
    v_writelane_b32 v8, s19, 56
    v_writelane_b32 v10, s20, 56
    s_mul_i32 s19, s69, 512
    s_add_u32 s19, s19, 14745728
    s_mov_b32 s20, 32768
    v_writelane_b32 v8, s19, 57
    v_writelane_b32 v10, s20, 57
    s_mul_i32 s19, s69, 512
    s_add_u32 s19, s19, 14745856
    s_mov_b32 s20, 32768
    v_writelane_b32 v8, s19, 58
    v_writelane_b32 v10, s20, 58
    s_mul_i32 s19, s69, 512
    s_add_u32 s19, s19, 14745984
    s_mov_b32 s20, 32768
    v_writelane_b32 v8, s19, 59
    v_writelane_b32 v10, s20, 59
    s_mul_i32 s19, s69, 128
    s_add_u32 s19, s19, 107423744
    s_mov_b32 s20, 10240
    v_writelane_b32 v8, s19, 60
    v_writelane_b32 v10, s20, 60
    s_mul_i32 s19, s69, 32
    s_add_u32 s19, s19, 107431936
    s_mov_b32 s20, 10240
    v_writelane_b32 v8, s19, 61
    v_writelane_b32 v10, s20, 61
    s_mul_i32 s19, s69, 112
    s_add_u32 s19, s19, 106969088
    s_mov_b32 s20, 7168
    v_writelane_b32 v8, s19, 62
    v_writelane_b32 v10, s20, 62
    s_mul_i32 s19, s69, 0
    s_add_u32 s19, s19, 1073741824
    s_mov_b32 s20, 0
    v_writelane_b32 v8, s19, 63
    v_writelane_b32 v10, s20, 63
    s_lshl_b32 s69, s69, 2
    s_mov_b32 s70, 1
    s_lshl_b32 s18, s12, 15
    s_mul_i32 s19, s12, 0
    s_add_u32 s19, s19, 108529664
    s_sub_u32 s19, s19, s18
    s_add_u32 s64, s4, s19
    s_addc_u32 s65, s5, 0
    s_and_b32 s65, s65, 0xffff
    s_add_u32 s66, s18, 4096
    s_mov_b32 s67, 0x20000
    s_and_b32 s76, s13, 15
    s_lshl_b32 s76, s76, 8
    s_lshl_b32 s18, s12, 9
    s_sub_u32 s76, s76, s18
    s_add_u32 s76, s76, 108529664
    s_lshl_b32 s68, s34, 7
    s_lshl_b32 s18, s12, 4
    s_add_u32 s68, s68, s18
    s_add_u32 s68, s68, 108527616
    s_mov_b32 s14, 0
    s_mov_b32 s29, -2
    s_mov_b32 s16, 106954752
    s_cmp_eq_u32 s12, 3
    s_mov_b32 s18, 106955776
    s_mov_b32 s19, 106948608
    s_cselect_b32 s17, s19, s18
    s_mul_i32 s23, s12, 2560
    s_add_u32 s23, s23, 107413504
    s_mul_i32 s24, s12, 114688
    s_mul_i32 s18, s34, 448
    s_add_u32 s24, s24, s18
    s_add_u32 s24, s24, 16777216
    s_mov_b32 s25, 106961920
    s_waitcnt vmcnt(28)
    s_branch Lrc_19
Lrp_18:
    s_sleep 1
    buffer_load_dword v62, v60, s[8:11], s36 offen sc1
    s_sub_u32 s15, s15, 1
    s_cbranch_scc1 Lm_exit
    s_waitcnt vmcnt(0)
Lrc_19:
    v_cmp_gt_u32 vcc, v61, v62
    s_cbranch_vccnz Lrp_18
    s_getpc_b64 s[84:85]
Lpc_20:
    s_add_u32 s84, s84, LstepB-Lpc_20
    s_addc_u32 s85, s85, 0
    v_lshlrev_b32 v104, 7, v44
    global_load_dword v104, v104, s[84:85]
    v_sub_u32 v105, v8, v10
    buffer_load_dword v105, v105, s[8:11], 0 offen sc1
    s_waitcnt vmcnt(0)
    v_mov_b64 v[44:45], 0
    v_mov_b64 v[46:47], 0
    v_mov_b64 v[48:49], 0
    v_mov_b64 v[50:51], 0
    v_mov_b64 v[52:53], 0
    v_mov_b64 v[54:55], 0
    v_mov_b64 v[56:57], 0
    v_mov_b64 v[58:59], 0
    v_mov_b64 v[60:61], 0
    v_mov_b64 v[62:63], 0
    v_mov_b64 v[64:65], 0
    v_mov_b64 v[66:67], 0
    v_mov_b64 v[68:69], 0
    v_mov_b64 v[70:71], 0
    s_barrier
    s_mov_b32 s77, 1073741824
    v_lshrrev_b32 v43, 2, v1
    v_mov_b32 v42, 0
.p2align 6
    s_nop 0
    s_nop 0
    s_nop 0
    s_nop 0
    s_nop 0
    s_nop 0
    s_nop 0
    s_nop 0
LstepB:
Lh_24:
    v_cmp_gt_u32 vcc, s14, v42
    s_cbranch_vccz Lgo_25
    buffer_load_dword v42, v43, s[8:11], s76 offen sc1
    s_waitcnt vmcnt(24)
    v_cmp_gt_u32 vcc, s14, v42
    s_cbranch_vccz Lgo_25
    buffer_load_dword v42, v43, s[8:11], s76 offen sc1
    s_sub_u32 s15, s15, 1
    s_cbranch_scc0 Lh_24
    s_branch Lm_exit
.p2align 6
Lgo_25:
    s_nop 4
    buffer_load_dwordx4 v[16:19], v1, s[8:11], s16 offen sc1
    buffer_load_dwordx4 v[20:23], v1, s[8:11], s17 offen sc1
    s_barrier
    s_add_u32 s19, s25, 1106944
    s_cmp_eq_u32 s14, 0
    s_cselect_b32 s19, 1073741824, s19
    buffer_store_dword v107, v9, s[8:11], s19 offen sc1
    buffer_load_dword v106, v8, s[8:11], 0 offen sc1
    v_and_b32 v108, 0x70, v1
    v_lshlrev_b32 v108, 3, v108
    s_add_u32 s18, s14, 2
    s_lshr_b32 s18, s18, 3
    s_min_u32 s18, s18, 7
    s_lshl_b32 s18, s18, 10
    s_add_u32 s26, s18, 108544000
    v_add_u32 v8, v8, v10
    buffer_load_dword v109, v108, s[8:11], s26 offen sc1
    s_add_u32 s80, s24, 0
    s_add_u32 s81, s24, 57344
    s_add_u32 s82, s24, 14336
    s_add_u32 s83, s24, 71680
    buffer_load_dwordx4 v[72:75], v5, s[8:11], s80 offen offset:0 sc1
    buffer_load_dwordx4 v[80:83], v5, s[8:11], s80 offen offset:224 sc1
    buffer_load_dwordx4 v[76:79], v5, s[8:11], s81 offen offset:0 sc1
    s_waitcnt vmcnt(7)
LspmB_22:
    v_smfmac_f32_16x16x64_bf16 v[44:47], v[16:19], a[0:7], v0
    ds_write_b128 v1, v[16:19]
    v_max3_u32 v104, v16, v17, v18
    v_smfmac_f32_16x16x64_bf16 v[48:51], v[16:19], a[56:63], v0
    s_waitcnt vmcnt(6)
    ds_write_b128 v1, v[20:23] offset:1024
    v_max3_u32 v105, v19, v20, v21
    v_smfmac_f32_16x16x64_bf16 v[52:55], v[16:19], a[112:119], v0
    buffer_load_dwordx4 v[84:87], v5, s[8:11], s81 offen offset:224 sc1
    v_max3_u32 v104, v104, v22, v23
    v_smfmac_f32_16x16x64_bf16 v[56:59], v[16:19], a[168:175], v0
    v_max_u32 v104, v104, v105
    v_smfmac_f32_16x16x64_bf16 v[60:63], v[16:19], a[224:231], v0
    v_cmp_eq_u32 vcc, -1, v104
    v_smfmac_f32_16x16x64_bf16 v[64:67], v[16:19], v[144:151], v0
    buffer_load_dwordx4 v[88:91], v5, s[8:11], s82 offen offset:0 sc1
    v_smfmac_f32_16x16x64_bf16 v[68:71], v[16:19], v[200:207], v0
    s_cbranch_vccnz LremB_23
    v_smfmac_f32_16x16x64_bf16 v[44:47], v[20:23], a[8:15], v0
    v_smfmac_f32_16x16x64_bf16 v[48:51], v[20:23], a[64:71], v0
    s_waitcnt lgkmcnt(0)
    s_barrier
    ds_read_b128 v[24:27], v11
    buffer_load_dwordx4 v[96:99], v5, s[8:11], s82 offen offset:224 sc1
    v_smfmac_f32_16x16x64_bf16 v[52:55], v[20:23], a[120:127], v0
    ds_read_b128 v[28:31], v12
    v_smfmac_f32_16x16x64_bf16 v[56:59], v[20:23], a[176:183], v0
    ds_read_b128 v[32:35], v13
    v_smfmac_f32_16x16x64_bf16 v[60:63], v[20:23], a[232:239], v0
    ds_read_b128 v[36:39], v14
    buffer_load_dwordx4 v[92:95], v5, s[8:11], s83 offen offset:0 sc1
    v_smfmac_f32_16x16x64_bf16 v[64:67], v[20:23], v[152:159], v0
    ds_read_b128 v[40:43], v15
    v_smfmac_f32_16x16x64_bf16 v[68:71], v[20:23], v[208:215], v0
    s_waitcnt lgkmcnt(4)
    v_smfmac_f32_16x16x64_bf16 v[44:47], v[24:27], a[16:23], v0
    s_waitcnt lgkmcnt(3)
    buffer_load_dwordx4 v[100:103], v5, s[8:11], s83 offen offset:224 sc1
    v_smfmac_f32_16x16x64_bf16 v[44:47], v[28:31], a[24:31], v0
    s_waitcnt lgkmcnt(2)
    v_smfmac_f32_16x16x64_bf16 v[44:47], v[32:35], a[32:39], v0
    s_waitcnt lgkmcnt(1)
    v_smfmac_f32_16x16x64_bf16 v[44:47], v[36:39], a[40:47], v0
    s_waitcnt lgkmcnt(0)
    v_smfmac_f32_16x16x64_bf16 v[44:47], v[40:43], a[48:55], v0
    v_mov_b64 v[16:17], 0
    v_smfmac_f32_16x16x64_bf16 v[48:51], v[24:27], a[72:79], v0
    v_mov_b64 v[18:19], 0
    v_smfmac_f32_16x16x64_bf16 v[48:51], v[28:31], a[80:87], v0
    v_mov_b64 v[20:21], 0
    v_smfmac_f32_16x16x64_bf16 v[48:51], v[32:35], a[88:95], v0
    v_mov_b64 v[22:23], 0
    v_smfmac_f32_16x16x64_bf16 v[48:51], v[36:39], a[96:103], v0
    v_and_b32 v110, 0x30, v1
    v_smfmac_f32_16x16x64_bf16 v[48:51], v[40:43], a[104:111], v0
    v_lshrrev_b32 v110, 2, v110
    v_smfmac_f32_16x16x64_bf16 v[52:55], v[24:27], a[128:135], v0
    v_smfmac_f32_16x16x64_bf16 v[52:55], v[28:31], a[136:143], v0
    v_add_f32 v44, v44, v46
    v_smfmac_f32_16x16x64_bf16 v[52:55], v[32:35], a[144:151], v0
    v_add_f32 v45, v45, v47
    v_smfmac_f32_16x16x64_bf16 v[52:55], v[36:39], a[152:159], v0
    v_cvt_pk_bf16_f32 v46, v44, v45
    v_smfmac_f32_16x16x64_bf16 v[52:55], v[40:43], a[160:167], v0
    v_smfmac_f32_16x16x64_bf16 v[56:59], v[24:27], a[184:191], v0
    v_smfmac_f32_16x16x64_bf16 v[56:59], v[28:31], a[192:199], v0
    v_add_f32 v48, v48, v50
    v_smfmac_f32_16x16x64_bf16 v[56:59], v[32:35], a[200:207], v0
    v_add_f32 v49, v49, v51
    v_smfmac_f32_16x16x64_bf16 v[56:59], v[36:39], a[208:215], v0
    v_cvt_pk_bf16_f32 v50, v48, v49
    v_smfmac_f32_16x16x64_bf16 v[56:59], v[40:43], a[216:223], v0
    ds_write2st64_b32 v3, v46, v50 offset0:0 offset1:1
    v_smfmac_f32_16x16x64_bf16 v[60:63], v[24:27], a[240:247], v0
    v_smfmac_f32_16x16x64_bf16 v[60:63], v[28:31], a[248:255], v0
    v_add_f32 v52, v52, v54
    v_smfmac_f32_16x16x64_bf16 v[60:63], v[32:35], v[120:127], v0
    v_add_f32 v53, v53, v55
    v_smfmac_f32_16x16x64_bf16 v[60:63], v[36:39], v[128:135], v0
    v_cvt_pk_bf16_f32 v54, v52, v53
    v_smfmac_f32_16x16x64_bf16 v[60:63], v[40:43], v[136:143], v0
    v_smfmac_f32_16x16x64_bf16 v[64:67], v[24:27], v[160:167], v0
    v_smfmac_f32_16x16x64_bf16 v[64:67], v[28:31], v[168:175], v0
    v_add_f32 v56, v56, v58
    v_smfmac_f32_16x16x64_bf16 v[64:67], v[32:35], v[176:183], v0
    v_add_f32 v57, v57, v59
    v_smfmac_f32_16x16x64_bf16 v[64:67], v[36:39], v[184:191], v0
    v_cvt_pk_bf16_f32 v58, v56, v57
    v_smfmac_f32_16x16x64_bf16 v[64:67], v[40:43], v[192:199], v0
    ds_write2st64_b32 v3, v54, v58 offset0:2 offset1:3
    v_smfmac_f32_16x16x64_bf16 v[68:71], v[24:27], v[216:223], v0
    v_smfmac_f32_16x16x64_bf16 v[68:71], v[28:31], v[224:231], v0
    v_add_f32 v60, v60, v62
    v_smfmac_f32_16x16x64_bf16 v[68:71], v[32:35], v[232:239], v0
    v_add_f32 v61, v61, v63
    v_smfmac_f32_16x16x64_bf16 v[68:71], v[36:39], v[240:247], v0
    v_cvt_pk_bf16_f32 v62, v60, v61
    v_smfmac_f32_16x16x64_bf16 v[68:71], v[40:43], v[248:255], v0
    v_mov_b32 v42, 0
    v_mov_b32 v40, v110
    buffer_load_dword v42, v40, s[8:11], s68 offen sc1
    v_add_f32 v64, v64, v66
    v_add_f32 v65, v65, v67
    v_cvt_pk_bf16_f32 v66, v64, v65
    ds_write2st64_b32 v3, v62, v66 offset0:4 offset1:5
    s_nop 0
    v_add_f32 v68, v68, v70
    v_add_f32 v69, v69, v71
    v_cvt_pk_bf16_f32 v70, v68, v69
    ds_write_b32 v3, v70 offset:1536
    buffer_load_dword v42, v40, s[8:11], s68 offen sc1
    s_waitcnt vmcnt(10)
    v_cmp_gt_u32 vcc, 28, v109
    s_cbranch_vccz Lvx_28
    v_mbcnt_lo_u32_b32 v106, -1, 0
    v_and_b32 v106, 7, v106
    v_lshlrev_b32 v106, 7, v106
    s_mov_b32 s18, s26
Lwd_29:
    buffer_load_dword v107, v106, s[8:11], s18 offen sc1
    s_sub_u32 s15, s15, 1
    s_cbranch_scc1 Lm_exit
    s_waitcnt vmcnt(0)
    v_cmp_gt_u32 vcc, 28, v107
    s_sleep 2
    s_cbranch_vccnz Lwd_29
Lvx_28:
    ds_read_b128 v[104:107], v4 offset:0
    ds_read_b128 v[108:111], v4 offset:896
    ds_read_b128 v[112:115], v4 offset:16
    ds_read_b128 v[116:119], v4 offset:912
Lh_30:
    v_cmp_gt_u32 vcc, s70, v42
    s_cbranch_vccz Lgo_31
    buffer_load_dword v42, v40, s[8:11], s68 offen sc1
    s_waitcnt vmcnt(24)
    v_cmp_gt_u32 vcc, s70, v42
    s_cbranch_vccz Lgo_31
    buffer_load_dword v42, v40, s[8:11], s68 offen sc1
    s_sub_u32 s15, s15, 1
    s_cbranch_scc0 Lh_30
    s_branch Lm_exit
.p2align 6
    s_nop 0
    s_nop 0
Lgo_31:
    s_nop 1
    buffer_load_dwordx4 v[28:31], v6, s[8:11], s23 offen sc1
    buffer_load_dwordx4 v[32:35], v6, s[8:11], s23 offen offset:256 sc1
    buffer_load_dwordx2 v[36:37], v2, s[8:11], s23 offen offset:512 sc1
    v_lshlrev_b32 v40, 4, v1
    v_mov_b32 v41, s70
    s_nop 1
    v_mov_b64 v[38:39], 0
    v_mov_b64 v[44:45], 0
    s_nop 1
    v_mov_b64 v[46:47], 0
    v_mov_b64 v[48:49], 0
    s_nop 1
    v_mov_b64 v[50:51], 0
    v_mov_b64 v[52:53], 0
    s_nop 1
    v_mov_b64 v[54:55], 0
    v_mov_b64 v[56:57], 0
    s_nop 1
    v_mov_b64 v[58:59], 0
    v_mov_b64 v[60:61], 0
    s_nop 1
    v_mov_b64 v[62:63], 0
    v_mov_b64 v[64:65], 0
    s_nop 1
    v_mov_b64 v[66:67], 0
    v_mov_b64 v[68:69], 0
    s_nop 1
    v_mov_b64 v[70:71], 0
    s_waitcnt vmcnt(2) lgkmcnt(0)
LspecB_26:
    v_smfmac_f32_16x16x64_bf16 v[16:19], v[28:31], v[72:79], v0
    v_max3_u32 v24, v28, v29, v30
    v_smfmac_f32_16x16x64_bf16 v[20:23], v[28:31], v[80:87], v0
    s_waitcnt vmcnt(1)
    v_max3_u32 v25, v31, v32, v33
    v_smfmac_f32_16x16x64_bf16 v[16:19], v[32:35], v[88:95], v0
    v_max3_u32 v24, v24, v34, v35
    v_smfmac_f32_16x16x64_bf16 v[20:23], v[32:35], v[96:103], v0
    s_waitcnt vmcnt(0)
    v_max3_u32 v25, v25, v36, v37
    v_smfmac_f32_16x16x64_bf16 v[16:19], v[36:39], v[104:111], v0
    s_nop 1
    v_max_u32 v24, v24, v25
    v_smfmac_f32_16x16x64_bf16 v[20:23], v[36:39], v[112:119], v0
    s_nop 1
    v_cmp_eq_u32 vcc, -1, v24
    s_nop 0
    v_add_f32 v24, v16, v18
    v_add_f32 v26, v17, v19
    s_cbranch_vccnz LretryB_27
    s_nop 0
    v_add_f32 v25, v20, v22
    v_add_f32 v27, v21, v23
    ds_write_b128 v1, v[24:27] offset:32768
    buffer_store_dword v41, v40, s[64:67], s69 offen
    v_lshrrev_b32 v43, 2, v1
    s_nop 2
    v_mov_b32 v42, 0
    s_waitcnt lgkmcnt(0)
    s_barrier
    ds_read_b64 v[104:105], v7 offset:0
    ds_read_b64 v[106:107], v7 offset:2048
    ds_read_b64 v[108:109], v7 offset:4096
    ds_read_b64 v[110:111], v7 offset:6144
    buffer_load_dword v42, v43, s[8:11], s76 offen sc1
    s_waitcnt lgkmcnt(2)
    v_pk_add_f32 v[104:105], v[104:105], v[106:107]
    s_waitcnt lgkmcnt(0)
    v_pk_add_f32 v[108:109], v[108:109], v[110:111]
    v_pk_add_f32 v[104:105], v[104:105], v[108:109]
    v_cvt_pk_bf16_f32 v107, v104, v105
    v_min_u32 v107, s29, v107
    buffer_store_dword v107, v9, s[8:11], s25 offen
    s_add_u32 s16, s16, 7168
    s_add_u32 s17, s17, 7168
    s_add_u32 s25, s25, 7168
    s_add_u32 s23, s23, 10240
    s_add_u32 s14, s14, 1
    s_add_u32 s70, s70, 1
    s_add_u32 s24, s24, 458752
    s_cmp_lt_u32 s14, 63
    s_cbranch_scc1 LstepB
    s_add_u32 s19, s25, 1106944
    buffer_store_dword v107, v9, s[8:11], s19 offen sc1
    s_branch LdoneB_21
LremB_23:
Lbp_32:
    buffer_load_dwordx4 v[16:19], v1, s[8:11], s16 offen sc1
    buffer_load_dwordx4 v[20:23], v1, s[8:11], s17 offen sc1
    s_sub_u32 s15, s15, 1
    s_cbranch_scc1 Lm_exit
    s_waitcnt vmcnt(0)
    v_max3_u32 v104, v16, v17, v18
    v_max3_u32 v105, v19, v20, v21
    v_max3_u32 v104, v104, v22, v23
    v_max_u32 v104, v104, v105
    v_cmp_eq_u32 vcc, -1, v104
    s_cbranch_vccnz Lbp_32
    v_mov_b64 v[44:45], 0
    v_mov_b64 v[46:47], 0
    v_mov_b64 v[48:49], 0
    v_mov_b64 v[50:51], 0
    v_mov_b64 v[52:53], 0
    v_mov_b64 v[54:55], 0
    v_mov_b64 v[56:57], 0
    v_mov_b64 v[58:59], 0
    v_mov_b64 v[60:61], 0
    v_mov_b64 v[62:63], 0
    v_mov_b64 v[64:65], 0
    v_mov_b64 v[66:67], 0
    v_mov_b64 v[68:69], 0
    v_mov_b64 v[70:71], 0
    s_branch LspmB_22
LretryB_27:
Lbp_33:
    buffer_load_dwordx4 v[28:31], v6, s[8:11], s23 offen sc1
    buffer_load_dwordx4 v[32:35], v6, s[8:11], s23 offen offset:256 sc1
    buffer_load_dwordx2 v[36:37], v2, s[8:11], s23 offen offset:512 sc1
    s_sub_u32 s15, s15, 1
    s_cbranch_scc1 Lm_exit
    s_waitcnt vmcnt(0)
    v_max3_u32 v24, v28, v29, v30
    v_max3_u32 v25, v31, v32, v33
    v_max3_u32 v24, v24, v34, v35
    v_max3_u32 v25, v25, v36, v37
    v_max_u32 v24, v24, v25
    v_cmp_eq_u32 vcc, -1, v24
    s_cbranch_vccnz Lbp_33
    v_mov_b64 v[16:17], 0
    v_mov_b64 v[18:19], 0
    v_mov_b64 v[20:21], 0
    v_mov_b64 v[22:23], 0
    s_branch LspecB_26
LdoneB_21:
    s_cmp_lg_u32 s69, 0
    s_cbranch_scc1 Lm_nowb
    s_waitcnt vmcnt(0)
    s_sleep 16
    buffer_wbl2 sc1
    s_waitcnt vmcnt(0)
Lm_nowb:
    s_endpgm
Lm_worker:
    s_sub_u32 s37, s35, 1
    s_lshl_b32 s16, s37, 5
    s_add_u32 s16, s16, s13
    v_and_b32 v1, 63, v0
    v_lshrrev_b32 v2, 5, v1
    v_and_b32 v3, 31, v1
    v_lshlrev_b32 v4, 4, v1
    s_and_b32 s24, s16, 7
    s_lshr_b32 s18, s16, 3
    s_lshl_b32 s18, s18, 2
    s_add_u32 s18, s18, s12
    s_mul_i32 s22, s18, 9363
    s_lshr_b32 s22, s22, 16
    s_mul_i32 s19, s22, 7
    s_sub_u32 s23, s18, s19
    s_lshl_b32 s18, s23, 6
    s_add_u32 s18, s18, 0
    v_add_u32 v8, s18, v3
    v_mul_u32_u24 v9, 2341, v8
    v_lshrrev_b32 v9, 16, v9
    v_mul_u32_u24 v9, 28, v9
    v_sub_u32 v8, v8, v9
    v_cmp_lt_u32 vcc, 13, v8
    v_lshlrev_b32 v8, 1, v8
    v_subrev_u32 v10, 27, v8
    v_cndmask_b32 v8, v8, v10, vcc
    v_lshl_add_u32 v8, v9, 4, v8
    v_mul_u32_u24 v9, 114688, v2
    v_lshl_add_u32 v5, v8, 4, v9
    s_lshl_b32 s18, s23, 6
    s_add_u32 s18, s18, 32
    v_add_u32 v8, s18, v3
    v_mul_u32_u24 v9, 2341, v8
    v_lshrrev_b32 v9, 16, v9
    v_mul_u32_u24 v9, 28, v9
    v_sub_u32 v8, v8, v9
    v_cmp_lt_u32 vcc, 13, v8
    v_lshlrev_b32 v8, 1, v8
    v_subrev_u32 v10, 27, v8
    v_cndmask_b32 v8, v8, v10, vcc
    v_lshl_add_u32 v8, v9, 4, v8
    v_mul_u32_u24 v9, 114688, v2
    v_lshl_add_u32 v6, v8, 4, v9
    v_mul_u32_u24 v7, 14336, v2
    v_lshl_add_u32 v7, v3, 4, v7
    s_mul_i32 s18, s22, 448
    s_add_u32 s18, s18, 6422528
    s_lshl_b32 s26, s23, 10
    s_add_u32 s26, s26, 16777216
    s_and_b32 s30, s16, 7
    s_lshl_b32 s30, s30, 7
    s_add_u32 s30, s30, 108544000
    v_mov_b32 v13, 1
    v_mov_b32 v14, 0
    s_mul_i32 s19, s12, 7168
    s_mul_i32 s25, s24, 28672
    s_add_u32 s25, s25, 12845056
    s_add_u32 s25, s25, s19
    s_add_u32 s19, s19, 1024
    v_add_u32 v15, s19, v4
    v_add_u32 v12, 1024, v4
    s_mul_i32 s19, s24, 458752
    s_add_u32 s26, s26, s19
    s_mul_i32 s19, s22, 28672
    s_add_u32 s26, s26, s19
    s_and_b32 s19, s22, 12
    s_lshl_b32 s19, s19, 7
    s_add_u32 s19, s19, 108554240
    v_mbcnt_lo_u32_b32 v8, -1, 0
    v_min_u32 v8, 3, v8
    v_lshlrev_b32 v8, 7, v8
    s_branch Lwc_35
Lww_34:
    s_sleep 2
Lwc_35:
    buffer_load_dword v9, v8, s[8:11], s19 offen sc1
    s_sub_u32 s15, s15, 1
    s_cbranch_scc1 Lm_exit
    s_waitcnt vmcnt(0)
    v_cmp_gt_u32 vcc, 7, v9
    s_cbranch_vccnz Lww_34
    buffer_load_dwordx4 a[0:3], v5, s[8:11], s18 offen sc1
    buffer_load_dwordx4 a[112:115], v6, s[8:11], s18 offen sc1
    s_add_u32 s18, s18, 229376
    buffer_load_dwordx4 a[4:7], v5, s[8:11], s18 offen sc1
    buffer_load_dwordx4 a[116:119], v6, s[8:11], s18 offen sc1
    s_add_u32 s18, s18, 229376
    buffer_load_dwordx4 a[8:11], v5, s[8:11], s18 offen sc1
    buffer_load_dwordx4 a[120:123], v6, s[8:11], s18 offen sc1
    s_add_u32 s18, s18, 229376
    buffer_load_dwordx4 a[12:15], v5, s[8:11], s18 offen sc1
    buffer_load_dwordx4 a[124:127], v6, s[8:11], s18 offen sc1
    s_add_u32 s18, s18, 229376
    buffer_load_dwordx4 a[16:19], v5, s[8:11], s18 offen sc1
    buffer_load_dwordx4 a[128:131], v6, s[8:11], s18 offen sc1
    s_add_u32 s18, s18, 229376
    buffer_load_dwordx4 a[20:23], v5, s[8:11], s18 offen sc1
    buffer_load_dwordx4 a[132:135], v6, s[8:11], s18 offen sc1
    s_add_u32 s18, s18, 229376
    buffer_load_dwordx4 a[24:27], v5, s[8:11], s18 offen sc1
    buffer_load_dwordx4 a[136:139], v6, s[8:11], s18 offen sc1
    s_add_u32 s18, s18, 229376
    buffer_load_dwordx4 a[28:31], v5, s[8:11], s18 offen sc1
    buffer_load_dwordx4 a[140:143], v6, s[8:11], s18 offen sc1
    s_add_u32 s18, s18, 229376
    buffer_load_dwordx4 a[32:35], v5, s[8:11], s18 offen sc1
    buffer_load_dwordx4 a[144:147], v6, s[8:11], s18 offen sc1
    s_add_u32 s18, s18, 229376
    buffer_load_dwordx4 a[36:39], v5, s[8:11], s18 offen sc1
    buffer_load_dwordx4 a[148:151], v6, s[8:11], s18 offen sc1
    s_add_u32 s18, s18, 229376
    buffer_load_dwordx4 a[40:43], v5, s[8:11], s18 offen sc1
    buffer_load_dwordx4 a[152:155], v6, s[8:11], s18 offen sc1
    s_add_u32 s18, s18, 229376
    buffer_load_dwordx4 a[44:47], v5, s[8:11], s18 offen sc1
    buffer_load_dwordx4 a[156:159], v6, s[8:11], s18 offen sc1
    s_add_u32 s18, s18, 229376
    buffer_load_dwordx4 a[48:51], v5, s[8:11], s18 offen sc1
    buffer_load_dwordx4 a[160:163], v6, s[8:11], s18 offen sc1
    s_add_u32 s18, s18, 229376
    buffer_load_dwordx4 a[52:55], v5, s[8:11], s18 offen sc1
    buffer_load_dwordx4 a[164:167], v6, s[8:11], s18 offen sc1
    s_add_u32 s18, s18, 229376
    buffer_load_dwordx4 a[56:59], v5, s[8:11], s18 offen sc1
    buffer_load_dwordx4 a[168:171], v6, s[8:11], s18 offen sc1
    s_add_u32 s18, s18, 229376
    buffer_load_dwordx4 a[60:63], v5, s[8:11], s18 offen sc1
    buffer_load_dwordx4 a[172:175], v6, s[8:11], s18 offen sc1
    s_add_u32 s18, s18, 229376
    buffer_load_dwordx4 a[64:67], v5, s[8:11], s18 offen sc1
    buffer_load_dwordx4 a[176:179], v6, s[8:11], s18 offen sc1
    s_add_u32 s18, s18, 229376
    buffer_load_dwordx4 a[68:71], v5, s[8:11], s18 offen sc1
    buffer_load_dwordx4 a[180:183], v6, s[8:11], s18 offen sc1
    s_add_u32 s18, s18, 229376
    buffer_load_dwordx4 a[72:75], v5, s[8:11], s18 offen sc1
    buffer_load_dwordx4 a[184:187], v6, s[8:11], s18 offen sc1
    s_add_u32 s18, s18, 229376
    buffer_load_dwordx4 a[76:79], v5, s[8:11], s18 offen sc1
    buffer_load_dwordx4 a[188:191], v6, s[8:11], s18 offen sc1
    s_add_u32 s18, s18, 229376
    buffer_load_dwordx4 a[80:83], v5, s[8:11], s18 offen sc1
    buffer_load_dwordx4 a[192:195], v6, s[8:11], s18 offen sc1
    s_add_u32 s18, s18, 229376
    buffer_load_dwordx4 a[84:87], v5, s[8:11], s18 offen sc1
    buffer_load_dwordx4 a[196:199], v6, s[8:11], s18 offen sc1
    s_add_u32 s18, s18, 229376
    buffer_load_dwordx4 a[88:91], v5, s[8:11], s18 offen sc1
    buffer_load_dwordx4 a[200:203], v6, s[8:11], s18 offen sc1
    s_add_u32 s18, s18, 229376
    buffer_load_dwordx4 a[92:95], v5, s[8:11], s18 offen sc1
    buffer_load_dwordx4 a[204:207], v6, s[8:11], s18 offen sc1
    s_add_u32 s18, s18, 229376
    buffer_load_dwordx4 a[96:99], v5, s[8:11], s18 offen sc1
    buffer_load_dwordx4 a[208:211], v6, s[8:11], s18 offen sc1
    s_add_u32 s18, s18, 229376
    buffer_load_dwordx4 a[100:103], v5, s[8:11], s18 offen sc1
    buffer_load_dwordx4 a[212:215], v6, s[8:11], s18 offen sc1
    s_add_u32 s18, s18, 229376
    buffer_load_dwordx4 a[104:107], v5, s[8:11], s18 offen sc1
    buffer_load_dwordx4 a[216:219], v6, s[8:11], s18 offen sc1
    s_add_u32 s18, s18, 229376
    buffer_load_dwordx4 a[108:111], v5, s[8:11], s18 offen sc1
    buffer_load_dwordx4 a[220:223], v6, s[8:11], s18 offen sc1
    s_add_u32 s18, s18, 229376
    v_mbcnt_lo_u32_b32 v8, -1, 0
    v_and_b32 v8, 7, v8
    v_lshlrev_b32 v8, 7, v8
    s_mov_b32 s18, 108556288
Lwd_36:
    buffer_load_dword v9, v8, s[8:11], s18 offen sc1
    s_sub_u32 s15, s15, 1
    s_cbranch_scc1 Lm_exit
    s_waitcnt vmcnt(0)
    v_cmp_gt_u32 vcc, 4, v9
    s_sleep 2
    s_cbranch_vccnz Lwd_36
    s_add_u32 s20, s25, 4096
    buffer_load_dwordx4 v[16:19], v4, s[8:11], s25 offen offset:0 sc1
    buffer_load_dwordx4 v[20:23], v4, s[8:11], s25 offen offset:1024 sc1
    buffer_load_dwordx4 v[24:27], v4, s[8:11], s25 offen offset:2048 sc1
    buffer_load_dwordx4 v[28:31], v4, s[8:11], s25 offen offset:3072 sc1
    buffer_load_dwordx4 v[32:35], v4, s[8:11], s20 offen offset:0 sc1
    buffer_load_dwordx4 v[36:39], v4, s[8:11], s20 offen offset:1024 sc1
    buffer_load_dwordx4 v[40:43], v4, s[8:11], s20 offen offset:2048 sc1
    s_waitcnt vmcnt(0)
    s_barrier
    ds_write_b128 v15, v[16:19] offset:0
    ds_write_b128 v15, v[20:23] offset:1024
    ds_write_b128 v15, v[24:27] offset:2048
    ds_write_b128 v15, v[28:31] offset:3072
    ds_write_b128 v15, v[32:35] offset:4096
    ds_write_b128 v15, v[36:39] offset:5120
    ds_write_b128 v15, v[40:43] offset:6144
    s_cmp_ge_u32 s16, 98
    s_cbranch_scc1 Ltrend_37
    s_load_dwordx2 s[44:45], s[0:1], 64
    s_load_dwordx2 s[46:47], s[0:1], 80
    s_lshl_b32 s80, s16, 2
    s_add_u32 s80, s80, s12
    s_cmp_ge_u32 s80, 196
    s_cselect_b32 s18, 196, 0
    s_sub_u32 s19, s80, s18
    s_mul_i32 s20, s19, 9363
    s_lshr_b32 s20, s20, 16
    s_mul_i32 s21, s20, 7
    s_sub_u32 s21, s19, s21
    s_waitcnt lgkmcnt(0)
    s_cmp_ge_u32 s80, 196
    s_cselect_b32 s81, s20, s21
    s_cselect_b32 s82, s21, s20
    s_mov_b32 s18, 896
    s_cselect_b32 s83, s18, 3584
    s_cselect_b32 s44, s46, s44
    s_cselect_b32 s45, s47, s45
    s_mov_b32 s18, 83886080
    s_cselect_b32 s85, s18, 81788928
    s_mov_b32 s56, s44
    s_and_b32 s57, s45, 0xffff
    s_mov_b32 s58, 1605632
    s_mov_b32 s59, 0x20000
    s_lshl_b32 s84, s83, 3
    v_lshrrev_b32 v8, 3, v1
    v_mul_lo_u32 v8, s83, v8
    v_and_b32 v9, 7, v1
    v_lshl_add_u32 v8, v9, 4, v8
    s_mul_i32 s18, s81, s83
    s_lshl_b32 s18, s18, 6
    s_lshl_b32 s19, s82, 7
    s_add_u32 s18, s18, s19
    s_lshl_b32 s86, s12, 13
    s_add_u32 s86, s86, 65536
    s_mov_b32 s20, s86
    s_mov_b32 m0, s20
    s_nop 0
    buffer_load_dwordx4 v8, s[56:59], s18 offen lds
    s_add_u32 s18, s18, s84
    s_add_u32 s20, s20, 1024
    s_mov_b32 m0, s20
    s_nop 0
    buffer_load_dwordx4 v8, s[56:59], s18 offen lds
    s_add_u32 s18, s18, s84
    s_add_u32 s20, s20, 1024
    s_mov_b32 m0, s20
    s_nop 0
    buffer_load_dwordx4 v8, s[56:59], s18 offen lds
    s_add_u32 s18, s18, s84
    s_add_u32 s20, s20, 1024
    s_mov_b32 m0, s20
    s_nop 0
    buffer_load_dwordx4 v8, s[56:59], s18 offen lds
    s_add_u32 s18, s18, s84
    s_add_u32 s20, s20, 1024
    s_mov_b32 m0, s20
    s_nop 0
    buffer_load_dwordx4 v8, s[56:59], s18 offen lds
    s_add_u32 s18, s18, s84
    s_add_u32 s20, s20, 1024
    s_mov_b32 m0, s20
    s_nop 0
    buffer_load_dwordx4 v8, s[56:59], s18 offen lds
    s_add_u32 s18, s18, s84
    s_add_u32 s20, s20, 1024
    s_mov_b32 m0, s20
    s_nop 0
    buffer_load_dwordx4 v8, s[56:59], s18 offen lds
    s_add_u32 s18, s18, s84
    s_add_u32 s20, s20, 1024
    s_mov_b32 m0, s20
    s_nop 0
    buffer_load_dwordx4 v8, s[56:59], s18 offen lds
    s_add_u32 s18, s18, s84
    s_add_u32 s20, s20, 1024
Ltrend_37:
    s_mov_b32 s27, 0
Lw1_38:
    s_cmp_lt_u32 s27, 7
    s_cselect_b32 s18, 229376, 0
    s_add_u32 s25, s25, s18
    v_xor_b32 v15, 0x8000, v15
    s_waitcnt lgkmcnt(0)
    s_barrier
    ds_read_b128 v[48:51], v12 offset:0
    ds_read_b128 v[52:55], v12 offset:1024
    ds_read_b128 v[56:59], v12 offset:2048
    ds_read_b128 v[60:63], v12 offset:3072
    ds_read_b128 v[64:67], v12 offset:4096
    ds_read_b128 v[68:71], v12 offset:5120
    ds_read_b128 v[72:75], v12 offset:6144
    s_add_u32 s20, s25, 4096
    s_waitcnt lgkmcnt(6)
    v_mfma_f32_32x32x16_bf16 v[128:143], v[48:51], a[0:3], 0
    ds_read_b128 v[76:79], v12 offset:7168
    v_mfma_f32_32x32x16_bf16 v[144:159], v[48:51], a[112:115], 0
    buffer_load_dwordx4 v[16:19], v4, s[8:11], s25 offen offset:0 sc1
    s_waitcnt lgkmcnt(6)
    v_mfma_f32_32x32x16_bf16 v[128:143], v[52:55], a[4:7], v[128:143]
    ds_read_b128 v[48:51], v12 offset:8192
    v_mfma_f32_32x32x16_bf16 v[144:159], v[52:55], a[116:119], v[144:159]
    buffer_load_dwordx4 v[20:23], v4, s[8:11], s25 offen offset:1024 sc1
    s_waitcnt lgkmcnt(6)
    v_mfma_f32_32x32x16_bf16 v[128:143], v[56:59], a[8:11], v[128:143]
    ds_read_b128 v[52:55], v12 offset:9216
    v_mfma_f32_32x32x16_bf16 v[144:159], v[56:59], a[120:123], v[144:159]
    buffer_load_dwordx4 v[24:27], v4, s[8:11], s25 offen offset:2048 sc1
    s_waitcnt lgkmcnt(6)
    v_mfma_f32_32x32x16_bf16 v[128:143], v[60:63], a[12:15], v[128:143]
    ds_read_b128 v[56:59], v12 offset:10240
    v_mfma_f32_32x32x16_bf16 v[144:159], v[60:63], a[124:127], v[144:159]
    buffer_load_dwordx4 v[28:31], v4, s[8:11], s25 offen offset:3072 sc1
    s_waitcnt lgkmcnt(6)
    v_mfma_f32_32x32x16_bf16 v[128:143], v[64:67], a[16:19], v[128:143]
    ds_read_b128 v[60:63], v12 offset:11264
    v_mfma_f32_32x32x16_bf16 v[144:159], v[64:67], a[128:131], v[144:159]
    buffer_load_dwordx4 v[32:35], v4, s[8:11], s20 offen offset:0 sc1
    s_waitcnt lgkmcnt(6)
    v_mfma_f32_32x32x16_bf16 v[128:143], v[68:71], a[20:23], v[128:143]
    ds_read_b128 v[64:67], v12 offset:12288
    v_mfma_f32_32x32x16_bf16 v[144:159], v[68:71], a[132:135], v[144:159]
    buffer_load_dwordx4 v[36:39], v4, s[8:11], s20 offen offset:1024 sc1
    s_waitcnt lgkmcnt(6)
    v_mfma_f32_32x32x16_bf16 v[128:143], v[72:75], a[24:27], v[128:143]
    ds_read_b128 v[68:71], v12 offset:13312
    v_mfma_f32_32x32x16_bf16 v[144:159], v[72:75], a[136:139], v[144:159]
    buffer_load_dwordx4 v[40:43], v4, s[8:11], s20 offen offset:2048 sc1
    s_waitcnt lgkmcnt(6)
    v_mfma_f32_32x32x16_bf16 v[128:143], v[76:79], a[28:31], v[128:143]
    ds_read_b128 v[72:75], v12 offset:14336
    v_mfma_f32_32x32x16_bf16 v[144:159], v[76:79], a[140:143], v[144:159]
    s_waitcnt lgkmcnt(6)
    v_mfma_f32_32x32x16_bf16 v[128:143], v[48:51], a[32:35], v[128:143]
    ds_read_b128 v[76:79], v12 offset:15360
    v_mfma_f32_32x32x16_bf16 v[144:159], v[48:51], a[144:147], v[144:159]
    s_waitcnt lgkmcnt(6)
    v_mfma_f32_32x32x16_bf16 v[128:143], v[52:55], a[36:39], v[128:143]
    ds_read_b128 v[48:51], v12 offset:16384
    v_mfma_f32_32x32x16_bf16 v[144:159], v[52:55], a[148:151], v[144:159]
    s_waitcnt lgkmcnt(6)
    v_mfma_f32_32x32x16_bf16 v[128:143], v[56:59], a[40:43], v[128:143]
    ds_read_b128 v[52:55], v12 offset:17408
    v_mfma_f32_32x32x16_bf16 v[144:159], v[56:59], a[152:155], v[144:159]
    s_waitcnt lgkmcnt(6)
    v_mfma_f32_32x32x16_bf16 v[128:143], v[60:63], a[44:47], v[128:143]
    ds_read_b128 v[56:59], v12 offset:18432
    v_mfma_f32_32x32x16_bf16 v[144:159], v[60:63], a[156:159], v[144:159]
    s_waitcnt lgkmcnt(6)
    v_mfma_f32_32x32x16_bf16 v[128:143], v[64:67], a[48:51], v[128:143]
    ds_read_b128 v[60:63], v12 offset:19456
    v_mfma_f32_32x32x16_bf16 v[144:159], v[64:67], a[160:163], v[144:159]
    s_waitcnt lgkmcnt(6)
    v_mfma_f32_32x32x16_bf16 v[128:143], v[68:71], a[52:55], v[128:143]
    ds_read_b128 v[64:67], v12 offset:20480
    v_mfma_f32_32x32x16_bf16 v[144:159], v[68:71], a[164:167], v[144:159]
    s_waitcnt lgkmcnt(6)
    v_mfma_f32_32x32x16_bf16 v[128:143], v[72:75], a[56:59], v[128:143]
    ds_read_b128 v[68:71], v12 offset:21504
    v_mfma_f32_32x32x16_bf16 v[144:159], v[72:75], a[168:171], v[144:159]
    s_waitcnt lgkmcnt(6)
    v_mfma_f32_32x32x16_bf16 v[128:143], v[76:79], a[60:63], v[128:143]
    ds_read_b128 v[72:75], v12 offset:22528
    v_mfma_f32_32x32x16_bf16 v[144:159], v[76:79], a[172:175], v[144:159]
    s_waitcnt lgkmcnt(6)
    v_mfma_f32_32x32x16_bf16 v[128:143], v[48:51], a[64:67], v[128:143]
    ds_read_b128 v[76:79], v12 offset:23552
    v_mfma_f32_32x32x16_bf16 v[144:159], v[48:51], a[176:179], v[144:159]
    s_waitcnt lgkmcnt(6)
    v_mfma_f32_32x32x16_bf16 v[128:143], v[52:55], a[68:71], v[128:143]
    ds_read_b128 v[48:51], v12 offset:24576
    v_mfma_f32_32x32x16_bf16 v[144:159], v[52:55], a[180:183], v[144:159]
    s_waitcnt lgkmcnt(6)
    v_mfma_f32_32x32x16_bf16 v[128:143], v[56:59], a[72:75], v[128:143]
    ds_read_b128 v[52:55], v12 offset:25600
    v_mfma_f32_32x32x16_bf16 v[144:159], v[56:59], a[184:187], v[144:159]
    s_waitcnt lgkmcnt(6)
    v_mfma_f32_32x32x16_bf16 v[128:143], v[60:63], a[76:79], v[128:143]
    ds_read_b128 v[56:59], v12 offset:26624
    v_mfma_f32_32x32x16_bf16 v[144:159], v[60:63], a[188:191], v[144:159]
    s_waitcnt lgkmcnt(6)
    v_mfma_f32_32x32x16_bf16 v[128:143], v[64:67], a[80:83], v[128:143]
    ds_read_b128 v[60:63], v12 offset:27648
    v_mfma_f32_32x32x16_bf16 v[144:159], v[64:67], a[192:195], v[144:159]
    s_waitcnt vmcnt(0)
    ds_write_b128 v15, v[16:19] offset:0
    s_waitcnt lgkmcnt(7)
    v_mfma_f32_32x32x16_bf16 v[128:143], v[68:71], a[84:87], v[128:143]
    v_mfma_f32_32x32x16_bf16 v[144:159], v[68:71], a[196:199], v[144:159]
    ds_write_b128 v15, v[20:23] offset:1024
    s_waitcnt lgkmcnt(7)
    v_mfma_f32_32x32x16_bf16 v[128:143], v[72:75], a[88:91], v[128:143]
    v_mfma_f32_32x32x16_bf16 v[144:159], v[72:75], a[200:203], v[144:159]
    s_barrier
    s_cmp_eq_u32 s27, 0
    s_cbranch_scc1 Lw1s_39
    s_cmp_lg_u32 s12, 0
    s_cbranch_scc1 Lw1s_39
    s_mov_b64 exec, 1
    buffer_atomic_add v13, v14, s[8:11], s30 offen sc1
    s_mov_b64 exec, -1
    s_add_u32 s30, s30, 1024
Lw1s_39:
    ds_write_b128 v15, v[24:27] offset:2048
    s_waitcnt lgkmcnt(7)
    v_mfma_f32_32x32x16_bf16 v[128:143], v[76:79], a[92:95], v[128:143]
    v_mfma_f32_32x32x16_bf16 v[144:159], v[76:79], a[204:207], v[144:159]
    ds_write_b128 v15, v[28:31] offset:3072
    s_waitcnt lgkmcnt(7)
    v_mfma_f32_32x32x16_bf16 v[128:143], v[48:51], a[96:99], v[128:143]
    v_mfma_f32_32x32x16_bf16 v[144:159], v[48:51], a[208:211], v[144:159]
    ds_write_b128 v15, v[32:35] offset:4096
    s_waitcnt lgkmcnt(7)
    v_mfma_f32_32x32x16_bf16 v[128:143], v[52:55], a[100:103], v[128:143]
    v_mfma_f32_32x32x16_bf16 v[144:159], v[52:55], a[212:215], v[144:159]
    ds_write_b128 v15, v[36:39] offset:5120
    s_waitcnt lgkmcnt(7)
    v_mfma_f32_32x32x16_bf16 v[128:143], v[56:59], a[104:107], v[128:143]
    v_mfma_f32_32x32x16_bf16 v[144:159], v[56:59], a[216:219], v[144:159]
    ds_write_b128 v15, v[40:43] offset:6144
    s_waitcnt lgkmcnt(7)
    v_mfma_f32_32x32x16_bf16 v[128:143], v[60:63], a[108:111], v[128:143]
    v_mfma_f32_32x32x16_bf16 v[144:159], v[60:63], a[220:223], v[144:159]
    v_xor_b32 v12, 0x8000, v12
    s_nop 9
    v_cvt_pk_bf16_f32 v160, v128, v129
    v_cvt_pk_bf16_f32 v161, v130, v131
    v_cvt_pk_bf16_f32 v162, v132, v133
    v_cvt_pk_bf16_f32 v163, v134, v135
    v_cvt_pk_bf16_f32 v164, v136, v137
    v_cvt_pk_bf16_f32 v165, v138, v139
    v_cvt_pk_bf16_f32 v166, v140, v141
    v_cvt_pk_bf16_f32 v167, v142, v143
    v_cvt_pk_bf16_f32 v168, v144, v145
    v_cvt_pk_bf16_f32 v169, v146, v147
    v_cvt_pk_bf16_f32 v170, v148, v149
    v_cvt_pk_bf16_f32 v171, v150, v151
    v_cvt_pk_bf16_f32 v172, v152, v153
    v_cvt_pk_bf16_f32 v173, v154, v155
    v_cvt_pk_bf16_f32 v174, v156, v157
    v_cvt_pk_bf16_f32 v175, v158, v159
    s_add_u32 s18, s26, 7168
    buffer_store_dwordx4 v[160:163], v7, s[8:11], s26 offen offset:0 sc1
    buffer_store_dwordx4 v[164:167], v7, s[8:11], s18 offen offset:0 sc1
    buffer_store_dwordx4 v[168:171], v7, s[8:11], s26 offen offset:512 sc1
    buffer_store_dwordx4 v[172:175], v7, s[8:11], s18 offen offset:512 sc1
    s_add_u32 s26, s26, 3670016
    s_add_u32 s27, s27, 1
    s_cmp_lt_u32 s27, 8
    s_cbranch_scc1 Lw1_38
    s_waitcnt vmcnt(0)
    s_barrier
    s_cmp_lg_u32 s12, 0
    s_cbranch_scc1 Lw1e_40
    s_mov_b64 exec, 1
    buffer_atomic_add v13, v14, s[8:11], s30 offen sc1
    s_mov_b64 exec, -1
    s_add_u32 s30, s30, 1024
Lw1e_40:
    s_waitcnt lgkmcnt(0)
    s_cmp_ge_u32 s16, 98
    s_cbranch_scc1 Ltrend_41
    v_bfe_u32 v10, v1, 2, 2
    v_lshl_add_u32 v10, v2, 3, v10
    v_lshlrev_b32 v9, 7, v10
    v_bfe_u32 v10, v1, 4, 1
    v_lshl_add_u32 v9, v10, 5, v9
    v_and_b32 v10, 3, v1
    v_lshl_add_u32 v9, v10, 3, v9
    v_add_u32 v9, s86, v9
    v_and_b32 v10, 1, v3
    v_lshrrev_b32 v11, 1, v3
    v_lshl_add_u32 v10, v10, 4, v11
    s_cmp_ge_u32 s80, 196
    s_cselect_b64 vcc, -1, 0
    v_cndmask_b32 v10, v3, v10, vcc
    v_mul_lo_u32 v8, s84, v2
    v_lshl_add_u32 v8, v10, 4, v8
    s_mul_i32 s18, s81, s84
    s_lshl_b32 s18, s18, 3
    s_add_u32 s85, s85, s18
    s_lshl_b32 s18, s82, 10
    s_add_u32 s85, s85, s18
    s_lshl_b32 s84, s84, 1
    ds_read_b64_tr_b16 v[180:181], v9 offset:0
    ds_read_b64_tr_b16 v[182:183], v9 offset:512
    ds_read_b64_tr_b16 v[184:185], v9 offset:64
    ds_read_b64_tr_b16 v[186:187], v9 offset:576
    ds_read_b64_tr_b16 v[188:189], v9 offset:2048
    ds_read_b64_tr_b16 v[190:191], v9 offset:2560
    ds_read_b64_tr_b16 v[192:193], v9 offset:2112
    ds_read_b64_tr_b16 v[194:195], v9 offset:2624
    s_waitcnt lgkmcnt(0)
    ds_read_b64_tr_b16 v[196:197], v9 offset:4096
    ds_read_b64_tr_b16 v[198:199], v9 offset:4608
    ds_read_b64_tr_b16 v[200:201], v9 offset:4160
    ds_read_b64_tr_b16 v[202:203], v9 offset:4672
    ds_read_b64_tr_b16 v[204:205], v9 offset:6144
    ds_read_b64_tr_b16 v[206:207], v9 offset:6656
    ds_read_b64_tr_b16 v[208:209], v9 offset:6208
    ds_read_b64_tr_b16 v[210:211], v9 offset:6720
    s_waitcnt lgkmcnt(0)
    buffer_store_dwordx4 v[180:183], v8, s[8:11], s85 offen offset:0 sc1
    buffer_store_dwordx4 v[184:187], v8, s[8:11], s85 offen offset:512 sc1
    s_add_u32 s85, s85, s84
    buffer_store_dwordx4 v[188:191], v8, s[8:11], s85 offen offset:0 sc1
    buffer_store_dwordx4 v[192:195], v8, s[8:11], s85 offen offset:512 sc1
    s_add_u32 s85, s85, s84
    buffer_store_dwordx4 v[196:199], v8, s[8:11], s85 offen offset:0 sc1
    buffer_store_dwordx4 v[200:203], v8, s[8:11], s85 offen offset:512 sc1
    s_add_u32 s85, s85, s84
    buffer_store_dwordx4 v[204:207], v8, s[8:11], s85 offen offset:0 sc1
    buffer_store_dwordx4 v[208:211], v8, s[8:11], s85 offen offset:512 sc1
    s_add_u32 s85, s85, s84
Ltrend_41:
    v_mov_b32 v16, -1
    v_mov_b32 v17, -1
    v_mov_b32 v18, -1
    v_mov_b32 v19, -1
    s_lshl_b32 s18, s16, 2
    s_add_u32 s18, s18, s12
    s_lshl_b32 s18, s18, 10
    s_add_u32 s19, s18, 917504
    s_add_u32 s56, s4, 85983232
    s_addc_u32 s57, s5, 0
    s_and_b32 s57, s57, 0xffff
    s_mov_b32 s58, 1376256
    s_mov_b32 s59, 0x20000
    buffer_store_dwordx4 v[16:19], v4, s[56:59], s18 offen sc1
    buffer_store_dwordx4 v[16:19], v4, s[56:59], s19 offen sc1
    s_cmp_ge_u32 s37, 6
    s_cbranch_scc1 Laf_42
    s_lshl_b32 s18, s13, 2
    s_add_u32 s18, s18, s12
    s_lshl_b32 s18, s18, 10
    s_mul_i32 s19, s37, 114688
    s_add_u32 s19, s19, 93323264
    s_add_u32 s56, s4, s19
    s_addc_u32 s57, s5, 0
    s_and_b32 s57, s57, 0xffff
    s_mov_b32 s58, 114688
    s_mov_b32 s59, 0x20000
    buffer_store_dwordx4 v[16:19], v4, s[56:59], s18 offen
    s_mul_i32 s19, s37, 40960
    s_add_u32 s19, s19, 100663296
    s_add_u32 s56, s4, s19
    s_addc_u32 s57, s5, 0
    s_and_b32 s57, s57, 0xffff
    s_mov_b32 s58, 40960
    s_mov_b32 s59, 0x20000
    buffer_store_dwordx4 v[16:19], v4, s[56:59], s18 offen
    s_mul_i32 s19, s37, 28672
    s_add_u32 s19, s19, 103284736
    s_add_u32 s56, s4, s19
    s_addc_u32 s57, s5, 0
    s_and_b32 s57, s57, 0xffff
    s_mov_b32 s58, 28672
    s_mov_b32 s59, 0x20000
    buffer_store_dwordx4 v[16:19], v4, s[56:59], s18 offen
    s_mul_i32 s19, s37, 7168
    s_add_u32 s19, s19, 105119744
    s_add_u32 s56, s4, s19
    s_addc_u32 s57, s5, 0
    s_and_b32 s57, s57, 0xffff
    s_mov_b32 s58, 7168
    s_mov_b32 s59, 0x20000
    buffer_store_dwordx4 v[16:19], v4, s[56:59], s18 offen
Laf_42:
    v_and_b32 v8, 5, v3
    v_bfe_u32 v9, v3, 1, 1
    v_lshl_or_b32 v8, v9, 4, v8
    v_bfe_u32 v9, v3, 4, 1
    v_lshl_or_b32 v8, v9, 3, v8
    v_bfe_u32 v9, v3, 3, 1
    v_lshl_or_b32 v8, v9, 1, v8
    v_mul_u32_u24 v9, 7168, v2
    v_lshl_add_u32 v5, v8, 4, v9
    v_add_u32 v6, 512, v5
    v_mov_b32 v7, v4
    s_mul_i32 s18, s22, 401408
    s_lshl_b32 s19, s23, 10
    s_add_u32 s18, s18, s19
    s_lshl_b32 s26, s23, 12
    s_add_u32 s26, s26, 46137344
    s_and_b32 s30, s16, 7
    s_lshl_b32 s30, s30, 7
    s_add_u32 s30, s30, 108544000
    v_mov_b32 v13, 1
    v_mov_b32 v14, 0
    s_mul_i32 s19, s12, 7168
    s_mul_i32 s25, s24, 28672
    s_add_u32 s25, s25, 12845056
    s_add_u32 s25, s25, s19
    s_add_u32 s19, s19, 1024
    v_add_u32 v15, s19, v4
    v_add_u32 v12, 1024, v4
    s_mul_i32 s19, s24, 458752
    s_add_u32 s26, s26, s19
    s_mul_i32 s19, s22, 28672
    s_add_u32 s26, s26, s19
    s_and_b32 s19, s22, 15
    s_lshl_b32 s19, s19, 7
    s_add_u32 s19, s19, 108552192
    v_mbcnt_lo_u32_b32 v8, -1, 0
    v_min_u32 v8, 0, v8
    v_lshlrev_b32 v8, 7, v8
    s_branch Lwc_44
Lww_43:
    s_sleep 2
Lwc_44:
    buffer_load_dword v9, v8, s[8:11], s19 offen sc1
    s_sub_u32 s15, s15, 1
    s_cbranch_scc1 Lm_exit
    s_waitcnt vmcnt(0)
    v_cmp_gt_u32 vcc, 7, v9
    s_cbranch_vccnz Lww_43
    s_add_u32 s20, s25, 4096
    buffer_load_dwordx4 v[16:19], v4, s[8:11], s25 offen offset:0 sc1
    buffer_load_dwordx4 v[20:23], v4, s[8:11], s25 offen offset:1024 sc1
    buffer_load_dwordx4 v[24:27], v4, s[8:11], s25 offen offset:2048 sc1
    buffer_load_dwordx4 v[28:31], v4, s[8:11], s25 offen offset:3072 sc1
    buffer_load_dwordx4 v[32:35], v4, s[8:11], s20 offen offset:0 sc1
    buffer_load_dwordx4 v[36:39], v4, s[8:11], s20 offen offset:1024 sc1
    buffer_load_dwordx4 v[40:43], v4, s[8:11], s20 offen offset:2048 sc1
    buffer_load_dwordx4 a[0:3], v5, s[8:11], s18 offen sc1
    buffer_load_dwordx4 a[112:115], v6, s[8:11], s18 offen sc1
    s_add_u32 s18, s18, 14336
    buffer_load_dwordx4 a[4:7], v5, s[8:11], s18 offen sc1
    buffer_load_dwordx4 a[116:119], v6, s[8:11], s18 offen sc1
    s_add_u32 s18, s18, 14336
    buffer_load_dwordx4 a[8:11], v5, s[8:11], s18 offen sc1
    buffer_load_dwordx4 a[120:123], v6, s[8:11], s18 offen sc1
    s_add_u32 s18, s18, 14336
    buffer_load_dwordx4 a[12:15], v5, s[8:11], s18 offen sc1
    buffer_load_dwordx4 a[124:127], v6, s[8:11], s18 offen sc1
    s_add_u32 s18, s18, 14336
    buffer_load_dwordx4 a[16:19], v5, s[8:11], s18 offen sc1
    buffer_load_dwordx4 a[128:131], v6, s[8:11], s18 offen sc1
    s_add_u32 s18, s18, 14336
    buffer_load_dwordx4 a[20:23], v5, s[8:11], s18 offen sc1
    buffer_load_dwordx4 a[132:135], v6, s[8:11], s18 offen sc1
    s_add_u32 s18, s18, 14336
    buffer_load_dwordx4 a[24:27], v5, s[8:11], s18 offen sc1
    buffer_load_dwordx4 a[136:139], v6, s[8:11], s18 offen sc1
    s_add_u32 s18, s18, 14336
    buffer_load_dwordx4 a[28:31], v5, s[8:11], s18 offen sc1
    buffer_load_dwordx4 a[140:143], v6, s[8:11], s18 offen sc1
    s_add_u32 s18, s18, 14336
    buffer_load_dwordx4 a[32:35], v5, s[8:11], s18 offen sc1
    buffer_load_dwordx4 a[144:147], v6, s[8:11], s18 offen sc1
    s_add_u32 s18, s18, 14336
    buffer_load_dwordx4 a[36:39], v5, s[8:11], s18 offen sc1
    buffer_load_dwordx4 a[148:151], v6, s[8:11], s18 offen sc1
    s_add_u32 s18, s18, 14336
    buffer_load_dwordx4 a[40:43], v5, s[8:11], s18 offen sc1
    buffer_load_dwordx4 a[152:155], v6, s[8:11], s18 offen sc1
    s_add_u32 s18, s18, 14336
    buffer_load_dwordx4 a[44:47], v5, s[8:11], s18 offen sc1
    buffer_load_dwordx4 a[156:159], v6, s[8:11], s18 offen sc1
    s_add_u32 s18, s18, 14336
    buffer_load_dwordx4 a[48:51], v5, s[8:11], s18 offen sc1
    buffer_load_dwordx4 a[160:163], v6, s[8:11], s18 offen sc1
    s_add_u32 s18, s18, 14336
    buffer_load_dwordx4 a[52:55], v5, s[8:11], s18 offen sc1
    buffer_load_dwordx4 a[164:167], v6, s[8:11], s18 offen sc1
    s_add_u32 s18, s18, 14336
    buffer_load_dwordx4 a[56:59], v5, s[8:11], s18 offen sc1
    buffer_load_dwordx4 a[168:171], v6, s[8:11], s18 offen sc1
    s_add_u32 s18, s18, 14336
    buffer_load_dwordx4 a[60:63], v5, s[8:11], s18 offen sc1
    buffer_load_dwordx4 a[172:175], v6, s[8:11], s18 offen sc1
    s_add_u32 s18, s18, 14336
    buffer_load_dwordx4 a[64:67], v5, s[8:11], s18 offen sc1
    buffer_load_dwordx4 a[176:179], v6, s[8:11], s18 offen sc1
    s_add_u32 s18, s18, 14336
    buffer_load_dwordx4 a[68:71], v5, s[8:11], s18 offen sc1
    buffer_load_dwordx4 a[180:183], v6, s[8:11], s18 offen sc1
    s_add_u32 s18, s18, 14336
    buffer_load_dwordx4 a[72:75], v5, s[8:11], s18 offen sc1
    buffer_load_dwordx4 a[184:187], v6, s[8:11], s18 offen sc1
    s_add_u32 s18, s18, 14336
    buffer_load_dwordx4 a[76:79], v5, s[8:11], s18 offen sc1
    buffer_load_dwordx4 a[188:191], v6, s[8:11], s18 offen sc1
    s_add_u32 s18, s18, 14336
    buffer_load_dwordx4 a[80:83], v5, s[8:11], s18 offen sc1
    buffer_load_dwordx4 a[192:195], v6, s[8:11], s18 offen sc1
    s_add_u32 s18, s18, 14336
    buffer_load_dwordx4 a[84:87], v5, s[8:11], s18 offen sc1
    buffer_load_dwordx4 a[196:199], v6, s[8:11], s18 offen sc1
    s_add_u32 s18, s18, 14336
    buffer_load_dwordx4 a[88:91], v5, s[8:11], s18 offen sc1
    buffer_load_dwordx4 a[200:203], v6, s[8:11], s18 offen sc1
    s_add_u32 s18, s18, 14336
    buffer_load_dwordx4 a[92:95], v5, s[8:11], s18 offen sc1
    buffer_load_dwordx4 a[204:207], v6, s[8:11], s18 offen sc1
    s_add_u32 s18, s18, 14336
    buffer_load_dwordx4 a[96:99], v5, s[8:11], s18 offen sc1
    buffer_load_dwordx4 a[208:211], v6, s[8:11], s18 offen sc1
    s_add_u32 s18, s18, 14336
    buffer_load_dwordx4 a[100:103], v5, s[8:11], s18 offen sc1
    buffer_load_dwordx4 a[212:215], v6, s[8:11], s18 offen sc1
    s_add_u32 s18, s18, 14336
    buffer_load_dwordx4 a[104:107], v5, s[8:11], s18 offen sc1
    buffer_load_dwordx4 a[216:219], v6, s[8:11], s18 offen sc1
    s_add_u32 s18, s18, 14336
    buffer_load_dwordx4 a[108:111], v5, s[8:11], s18 offen sc1
    buffer_load_dwordx4 a[220:223], v6, s[8:11], s18 offen sc1
    s_add_u32 s18, s18, 14336
    s_waitcnt vmcnt(0)
    s_barrier
    s_cmp_lg_u32 s12, 0
    s_cbranch_scc1 Lw1d_45
    s_and_b32 s18, s16, 7
    s_lshl_b32 s18, s18, 7
    s_add_u32 s18, s18, 108558336
    v_mov_b32 v8, 1
    v_mov_b32 v9, 0
    s_mov_b64 exec, 1
    buffer_atomic_add v8, v9, s[8:11], s18 offen sc1
    s_mov_b64 exec, -1
Lw1d_45:
    ds_write_b128 v15, v[16:19] offset:0
    ds_write_b128 v15, v[20:23] offset:1024
    ds_write_b128 v15, v[24:27] offset:2048
    ds_write_b128 v15, v[28:31] offset:3072
    ds_write_b128 v15, v[32:35] offset:4096
    ds_write_b128 v15, v[36:39] offset:5120
    ds_write_b128 v15, v[40:43] offset:6144
    s_mov_b32 s27, 0
Lw1_46:
    s_cmp_lt_u32 s27, 7
    s_cselect_b32 s18, 229376, 0
    s_add_u32 s25, s25, s18
    v_xor_b32 v15, 0x8000, v15
    s_waitcnt lgkmcnt(0)
    s_barrier
    ds_read_b128 v[48:51], v12 offset:0
    ds_read_b128 v[52:55], v12 offset:1024
    ds_read_b128 v[56:59], v12 offset:2048
    ds_read_b128 v[60:63], v12 offset:3072
    ds_read_b128 v[64:67], v12 offset:4096
    ds_read_b128 v[68:71], v12 offset:5120
    ds_read_b128 v[72:75], v12 offset:6144
    s_add_u32 s20, s25, 4096
    s_waitcnt lgkmcnt(6)
    v_mfma_f32_32x32x16_bf16 v[128:143], a[0:3], v[48:51], 0
    ds_read_b128 v[76:79], v12 offset:7168
    v_mfma_f32_32x32x16_bf16 v[144:159], a[112:115], v[48:51], 0
    buffer_load_dwordx4 v[16:19], v4, s[8:11], s25 offen offset:0 sc1
    s_waitcnt lgkmcnt(6)
    v_mfma_f32_32x32x16_bf16 v[128:143], a[4:7], v[52:55], v[128:143]
    ds_read_b128 v[48:51], v12 offset:8192
    v_mfma_f32_32x32x16_bf16 v[144:159], a[116:119], v[52:55], v[144:159]
    buffer_load_dwordx4 v[20:23], v4, s[8:11], s25 offen offset:1024 sc1
    s_waitcnt lgkmcnt(6)
    v_mfma_f32_32x32x16_bf16 v[128:143], a[8:11], v[56:59], v[128:143]
    ds_read_b128 v[52:55], v12 offset:9216
    v_mfma_f32_32x32x16_bf16 v[144:159], a[120:123], v[56:59], v[144:159]
    buffer_load_dwordx4 v[24:27], v4, s[8:11], s25 offen offset:2048 sc1
    s_waitcnt lgkmcnt(6)
    v_mfma_f32_32x32x16_bf16 v[128:143], a[12:15], v[60:63], v[128:143]
    ds_read_b128 v[56:59], v12 offset:10240
    v_mfma_f32_32x32x16_bf16 v[144:159], a[124:127], v[60:63], v[144:159]
    buffer_load_dwordx4 v[28:31], v4, s[8:11], s25 offen offset:3072 sc1
    s_waitcnt lgkmcnt(6)
    v_mfma_f32_32x32x16_bf16 v[128:143], a[16:19], v[64:67], v[128:143]
    ds_read_b128 v[60:63], v12 offset:11264
    v_mfma_f32_32x32x16_bf16 v[144:159], a[128:131], v[64:67], v[144:159]
    buffer_load_dwordx4 v[32:35], v4, s[8:11], s20 offen offset:0 sc1
    s_waitcnt lgkmcnt(6)
    v_mfma_f32_32x32x16_bf16 v[128:143], a[20:23], v[68:71], v[128:143]
    ds_read_b128 v[64:67], v12 offset:12288
    v_mfma_f32_32x32x16_bf16 v[144:159], a[132:135], v[68:71], v[144:159]
    buffer_load_dwordx4 v[36:39], v4, s[8:11], s20 offen offset:1024 sc1
    s_waitcnt lgkmcnt(6)
    v_mfma_f32_32x32x16_bf16 v[128:143], a[24:27], v[72:75], v[128:143]
    ds_read_b128 v[68:71], v12 offset:13312
    v_mfma_f32_32x32x16_bf16 v[144:159], a[136:139], v[72:75], v[144:159]
    buffer_load_dwordx4 v[40:43], v4, s[8:11], s20 offen offset:2048 sc1
    s_waitcnt lgkmcnt(6)
    v_mfma_f32_32x32x16_bf16 v[128:143], a[28:31], v[76:79], v[128:143]
    ds_read_b128 v[72:75], v12 offset:14336
    v_mfma_f32_32x32x16_bf16 v[144:159], a[140:143], v[76:79], v[144:159]
    s_waitcnt lgkmcnt(6)
    v_mfma_f32_32x32x16_bf16 v[128:143], a[32:35], v[48:51], v[128:143]
    ds_read_b128 v[76:79], v12 offset:15360
    v_mfma_f32_32x32x16_bf16 v[144:159], a[144:147], v[48:51], v[144:159]
    s_waitcnt lgkmcnt(6)
    v_mfma_f32_32x32x16_bf16 v[128:143], a[36:39], v[52:55], v[128:143]
    ds_read_b128 v[48:51], v12 offset:16384
    v_mfma_f32_32x32x16_bf16 v[144:159], a[148:151], v[52:55], v[144:159]
    s_waitcnt lgkmcnt(6)
    v_mfma_f32_32x32x16_bf16 v[128:143], a[40:43], v[56:59], v[128:143]
    ds_read_b128 v[52:55], v12 offset:17408
    v_mfma_f32_32x32x16_bf16 v[144:159], a[152:155], v[56:59], v[144:159]
    s_waitcnt lgkmcnt(6)
    v_mfma_f32_32x32x16_bf16 v[128:143], a[44:47], v[60:63], v[128:143]
    ds_read_b128 v[56:59], v12 offset:18432
    v_mfma_f32_32x32x16_bf16 v[144:159], a[156:159], v[60:63], v[144:159]
    s_waitcnt lgkmcnt(6)
    v_mfma_f32_32x32x16_bf16 v[128:143], a[48:51], v[64:67], v[128:143]
    ds_read_b128 v[60:63], v12 offset:19456
    v_mfma_f32_32x32x16_bf16 v[144:159], a[160:163], v[64:67], v[144:159]
    s_waitcnt lgkmcnt(6)
    v_mfma_f32_32x32x16_bf16 v[128:143], a[52:55], v[68:71], v[128:143]
    ds_read_b128 v[64:67], v12 offset:20480
    v_mfma_f32_32x32x16_bf16 v[144:159], a[164:167], v[68:71], v[144:159]
    s_waitcnt lgkmcnt(6)
    v_mfma_f32_32x32x16_bf16 v[128:143], a[56:59], v[72:75], v[128:143]
    ds_read_b128 v[68:71], v12 offset:21504
    v_mfma_f32_32x32x16_bf16 v[144:159], a[168:171], v[72:75], v[144:159]
    s_waitcnt lgkmcnt(6)
    v_mfma_f32_32x32x16_bf16 v[128:143], a[60:63], v[76:79], v[128:143]
    ds_read_b128 v[72:75], v12 offset:22528
    v_mfma_f32_32x32x16_bf16 v[144:159], a[172:175], v[76:79], v[144:159]
    s_waitcnt lgkmcnt(6)
    v_mfma_f32_32x32x16_bf16 v[128:143], a[64:67], v[48:51], v[128:143]
    ds_read_b128 v[76:79], v12 offset:23552
    v_mfma_f32_32x32x16_bf16 v[144:159], a[176:179], v[48:51], v[144:159]
    s_waitcnt lgkmcnt(6)
    v_mfma_f32_32x32x16_bf16 v[128:143], a[68:71], v[52:55], v[128:143]
    ds_read_b128 v[48:51], v12 offset:24576
    v_mfma_f32_32x32x16_bf16 v[144:159], a[180:183], v[52:55], v[144:159]
    s_waitcnt lgkmcnt(6)
    v_mfma_f32_32x32x16_bf16 v[128:143], a[72:75], v[56:59], v[128:143]
    ds_read_b128 v[52:55], v12 offset:25600
    v_mfma_f32_32x32x16_bf16 v[144:159], a[184:187], v[56:59], v[144:159]
    s_waitcnt lgkmcnt(6)
    v_mfma_f32_32x32x16_bf16 v[128:143], a[76:79], v[60:63], v[128:143]
    ds_read_b128 v[56:59], v12 offset:26624
    v_mfma_f32_32x32x16_bf16 v[144:159], a[188:191], v[60:63], v[144:159]
    s_waitcnt lgkmcnt(6)
    v_mfma_f32_32x32x16_bf16 v[128:143], a[80:83], v[64:67], v[128:143]
    ds_read_b128 v[60:63], v12 offset:27648
    v_mfma_f32_32x32x16_bf16 v[144:159], a[192:195], v[64:67], v[144:159]
    s_waitcnt vmcnt(0)
    ds_write_b128 v15, v[16:19] offset:0
    s_waitcnt lgkmcnt(7)
    v_mfma_f32_32x32x16_bf16 v[128:143], a[84:87], v[68:71], v[128:143]
    v_mfma_f32_32x32x16_bf16 v[144:159], a[196:199], v[68:71], v[144:159]
    ds_write_b128 v15, v[20:23] offset:1024
    s_waitcnt lgkmcnt(7)
    v_mfma_f32_32x32x16_bf16 v[128:143], a[88:91], v[72:75], v[128:143]
    v_mfma_f32_32x32x16_bf16 v[144:159], a[200:203], v[72:75], v[144:159]
    ds_write_b128 v15, v[24:27] offset:2048
    s_waitcnt lgkmcnt(7)
    v_mfma_f32_32x32x16_bf16 v[128:143], a[92:95], v[76:79], v[128:143]
    v_mfma_f32_32x32x16_bf16 v[144:159], a[204:207], v[76:79], v[144:159]
    ds_write_b128 v15, v[28:31] offset:3072
    s_waitcnt lgkmcnt(7)
    v_mfma_f32_32x32x16_bf16 v[128:143], a[96:99], v[48:51], v[128:143]
    v_mfma_f32_32x32x16_bf16 v[144:159], a[208:211], v[48:51], v[144:159]
    ds_write_b128 v15, v[32:35] offset:4096
    s_waitcnt lgkmcnt(7)
    v_mfma_f32_32x32x16_bf16 v[128:143], a[100:103], v[52:55], v[128:143]
    v_mfma_f32_32x32x16_bf16 v[144:159], a[212:215], v[52:55], v[144:159]
    ds_write_b128 v15, v[36:39] offset:5120
    s_waitcnt lgkmcnt(7)
    v_mfma_f32_32x32x16_bf16 v[128:143], a[104:107], v[56:59], v[128:143]
    v_mfma_f32_32x32x16_bf16 v[144:159], a[216:219], v[56:59], v[144:159]
    ds_write_b128 v15, v[40:43] offset:6144
    s_waitcnt lgkmcnt(7)
    v_mfma_f32_32x32x16_bf16 v[128:143], a[108:111], v[60:63], v[128:143]
    v_mfma_f32_32x32x16_bf16 v[144:159], a[220:223], v[60:63], v[144:159]
    s_lshr_b32 s18, s16, 3
    s_cmp_lg_u32 s18, s27
    s_cbranch_scc1 Lw1x_47
    s_mul_i32 s18, s12, 7168
    v_and_b32 v8, 0x8000, v12
    v_lshl_add_u32 v8, v3, 4, v8
    v_lshl_add_u32 v8, v2, 2, v8
    v_add_u32 v8, s18, v8
    v_add_u32 v9, 1024, v8
    ds_read2_b32 v[180:181], v9 offset0:0 offset1:2
    ds_read2_b32 v[182:183], v9 offset0:128 offset1:130
    v_add_u32 v9, 2048, v8
    ds_read2_b32 v[184:185], v9 offset0:0 offset1:2
    ds_read2_b32 v[186:187], v9 offset0:128 offset1:130
    v_add_u32 v9, 3072, v8
    ds_read2_b32 v[188:189], v9 offset0:0 offset1:2
    ds_read2_b32 v[190:191], v9 offset0:128 offset1:130
    v_add_u32 v9, 4096, v8
    ds_read2_b32 v[192:193], v9 offset0:0 offset1:2
    ds_read2_b32 v[194:195], v9 offset0:128 offset1:130
    s_waitcnt lgkmcnt(0)
    v_add_u32 v9, 5120, v8
    ds_read2_b32 v[196:197], v9 offset0:0 offset1:2
    ds_read2_b32 v[198:199], v9 offset0:128 offset1:130
    v_add_u32 v9, 6144, v8
    ds_read2_b32 v[200:201], v9 offset0:0 offset1:2
    ds_read2_b32 v[202:203], v9 offset0:128 offset1:130
    v_add_u32 v9, 7168, v8
    ds_read2_b32 v[204:205], v9 offset0:0 offset1:2
    ds_read2_b32 v[206:207], v9 offset0:128 offset1:130
    s_lshl_b32 s19, s27, 3
    s_add_u32 s19, s19, s24
    s_mul_i32 s19, s19, 28672
    s_add_u32 s18, s18, s19
    s_add_u32 s18, s18, 75497472
    s_add_u32 s19, s18, 4096
    s_waitcnt lgkmcnt(0)
    buffer_store_dwordx4 v[180:183], v4, s[8:11], s18 offen offset:0 sc1
    buffer_store_dwordx4 v[184:187], v4, s[8:11], s18 offen offset:1024 sc1
    buffer_store_dwordx4 v[188:191], v4, s[8:11], s18 offen offset:2048 sc1
    buffer_store_dwordx4 v[192:195], v4, s[8:11], s18 offen offset:3072 sc1
    buffer_store_dwordx4 v[196:199], v4, s[8:11], s19 offen offset:0 sc1
    buffer_store_dwordx4 v[200:203], v4, s[8:11], s19 offen offset:1024 sc1
    buffer_store_dwordx4 v[204:207], v4, s[8:11], s19 offen offset:2048 sc1
Lw1x_47:
    s_nop 6
    v_xor_b32 v12, 0x8000, v12
    v_cvt_pk_bf16_f32 v160, v128, v129
    v_cvt_pk_bf16_f32 v161, v130, v131
    v_cvt_pk_bf16_f32 v162, v132, v133
    v_cvt_pk_bf16_f32 v163, v134, v135
    v_cvt_pk_bf16_f32 v164, v136, v137
    v_cvt_pk_bf16_f32 v165, v138, v139
    v_cvt_pk_bf16_f32 v166, v140, v141
    v_cvt_pk_bf16_f32 v167, v142, v143
    v_cvt_pk_bf16_f32 v168, v144, v145
    v_cvt_pk_bf16_f32 v169, v146, v147
    v_cvt_pk_bf16_f32 v170, v148, v149
    v_cvt_pk_bf16_f32 v171, v150, v151
    v_cvt_pk_bf16_f32 v172, v152, v153
    v_cvt_pk_bf16_f32 v173, v154, v155
    v_cvt_pk_bf16_f32 v174, v156, v157
    v_cvt_pk_bf16_f32 v175, v158, v159
    buffer_store_dwordx4 v[160:163], v7, s[8:11], s26 offen offset:0 sc1
    buffer_store_dwordx4 v[164:167], v7, s[8:11], s26 offen offset:1024 sc1
    buffer_store_dwordx4 v[168:171], v7, s[8:11], s26 offen offset:2048 sc1
    buffer_store_dwordx4 v[172:175], v7, s[8:11], s26 offen offset:3072 sc1
    s_add_u32 s26, s26, 3670016
    s_add_u32 s27, s27, 1
    s_cmp_lt_u32 s27, 8
    s_cbranch_scc1 Lw1_46
    s_waitcnt lgkmcnt(0)
    s_waitcnt vmcnt(0)
    s_barrier
    s_cmp_lg_u32 s12, 0
    s_cbranch_scc1 Lw1d_48
    s_and_b32 s18, s16, 7
    s_lshl_b32 s18, s18, 7
    s_add_u32 s18, s18, 108557312
    v_mov_b32 v8, 1
    v_mov_b32 v9, 0
    s_mov_b64 exec, 1
    buffer_atomic_add v8, v9, s[8:11], s18 offen sc1
    s_mov_b64 exec, -1
Lw1d_48:
    s_cmp_ge_u32 s37, 6
    s_cbranch_scc1 Lk_vm
    s_cmp_ge_u32 s13, 30
    s_cbranch_scc1 Lk_wb
    v_mbcnt_lo_u32_b32 v9, -1, 0
    v_and_b32 v9, 7, v9
    v_lshlrev_b32 v9, 7, v9
    s_mov_b32 s18, 108558336
Lwd_49:
    buffer_load_dword v10, v9, s[8:11], s18 offen sc1
    s_sub_u32 s15, s15, 1
    s_cbranch_scc1 Lm_exit
    s_waitcnt vmcnt(0)
    v_cmp_gt_u32 vcc, 28, v10
    s_sleep 2
    s_cbranch_vccnz Lwd_49
    s_mov_b32 s60, s37
    v_mov_b32 v252, -1
    v_mov_b32 v253, -1
    v_mov_b32 v254, -1
    v_mov_b32 v255, -1
    s_mov_b32 s30, 0xbdd2d3e8
    s_mov_b32 s31, s30
    s_cmp_ge_u32 s13, 16
    s_cbranch_scc1 Lk_beta
    s_mov_b32 s75, s13
    s_cmp_ge_u32 s13, 14
    s_cbranch_scc1 Lal0_50
    s_load_dwordx2 s[44:45], s[0:1], 72
    s_load_dwordx4 s[48:51], s[0:1], 88
    v_and_b32 v5, 0x13, v3
    v_and_b32 v6, 4, v3
    v_lshl_or_b32 v5, v6, 1, v5
    v_and_b32 v6, 8, v3
    v_lshrrev_b32 v6, 1, v6
    v_or_b32 v5, v5, v6
    v_mul_u32_u24 v6, 28672, v2
    v_lshl_add_u32 v6, v5, 4, v6
    s_mul_i32 s18, s12, 401408
    s_lshl_b32 s19, s75, 10
    s_add_u32 s18, s18, s19
    s_add_u32 s18, s18, 81788928
    buffer_load_dwordx4 a[112:115], v6, s[8:11], s18 offen offset:0 sc1
    buffer_load_dwordx4 a[140:143], v6, s[8:11], s18 offen offset:512 sc1
    s_add_u32 s18, s18, 57344
    buffer_load_dwordx4 a[116:119], v6, s[8:11], s18 offen offset:0 sc1
    buffer_load_dwordx4 a[144:147], v6, s[8:11], s18 offen offset:512 sc1
    s_add_u32 s18, s18, 57344
    buffer_load_dwordx4 a[120:123], v6, s[8:11], s18 offen offset:0 sc1
    buffer_load_dwordx4 a[148:151], v6, s[8:11], s18 offen offset:512 sc1
    s_add_u32 s18, s18, 57344
    buffer_load_dwordx4 a[124:127], v6, s[8:11], s18 offen offset:0 sc1
    buffer_load_dwordx4 a[152:155], v6, s[8:11], s18 offen offset:512 sc1
    s_add_u32 s18, s18, 57344
    buffer_load_dwordx4 a[128:131], v6, s[8:11], s18 offen offset:0 sc1
    buffer_load_dwordx4 a[156:159], v6, s[8:11], s18 offen offset:512 sc1
    s_add_u32 s18, s18, 57344
    buffer_load_dwordx4 a[132:135], v6, s[8:11], s18 offen offset:0 sc1
    buffer_load_dwordx4 a[160:163], v6, s[8:11], s18 offen offset:512 sc1
    s_add_u32 s18, s18, 57344
    buffer_load_dwordx4 a[136:139], v6, s[8:11], s18 offen offset:0 sc1
    buffer_load_dwordx4 a[164:167], v6, s[8:11], s18 offen offset:512 sc1
    s_add_u32 s18, s18, 57344
    s_cmp_ge_u32 s75, 14
    s_cselect_b32 s20, 1, 0
    s_mul_i32 s21, s20, 14
    s_sub_u32 s21, s75, s21
    v_lshrrev_b32 v7, 4, v1
    v_and_b32 v8, 15, v1
    v_mul_u32_u24 v6, 7168, v7
    v_lshl_add_u32 v6, v8, 4, v6
    s_mul_i32 s18, s12, 401408
    s_lshl_b32 s19, s21, 9
    s_add_u32 s18, s18, s19
    s_add_u32 s18, s18, 83886080
    buffer_load_dwordx4 a[0:3], v6, s[8:11], s18 offen offset:0 sc1
    buffer_load_dwordx4 a[4:7], v6, s[8:11], s18 offen offset:256 sc1
    s_add_u32 s18, s18, 28672
    buffer_load_dwordx4 a[8:11], v6, s[8:11], s18 offen offset:0 sc1
    buffer_load_dwordx4 a[12:15], v6, s[8:11], s18 offen offset:256 sc1
    s_add_u32 s18, s18, 28672
    buffer_load_dwordx4 a[16:19], v6, s[8:11], s18 offen offset:0 sc1
    buffer_load_dwordx4 a[20:23], v6, s[8:11], s18 offen offset:256 sc1
    s_add_u32 s18, s18, 28672
    buffer_load_dwordx4 a[24:27], v6, s[8:11], s18 offen offset:0 sc1
    buffer_load_dwordx4 a[28:31], v6, s[8:11], s18 offen offset:256 sc1
    s_add_u32 s18, s18, 28672
    buffer_load_dwordx4 a[32:35], v6, s[8:11], s18 offen offset:0 sc1
    buffer_load_dwordx4 a[36:39], v6, s[8:11], s18 offen offset:256 sc1
    s_add_u32 s18, s18, 28672
    buffer_load_dwordx4 a[40:43], v6, s[8:11], s18 offen offset:0 sc1
    buffer_load_dwordx4 a[44:47], v6, s[8:11], s18 offen offset:256 sc1
    s_add_u32 s18, s18, 28672
    buffer_load_dwordx4 a[48:51], v6, s[8:11], s18 offen offset:0 sc1
    buffer_load_dwordx4 a[52:55], v6, s[8:11], s18 offen offset:256 sc1
    s_add_u32 s18, s18, 28672
    buffer_load_dwordx4 a[56:59], v6, s[8:11], s18 offen offset:0 sc1
    buffer_load_dwordx4 a[60:63], v6, s[8:11], s18 offen offset:256 sc1
    s_add_u32 s18, s18, 28672
    buffer_load_dwordx4 a[64:67], v6, s[8:11], s18 offen offset:0 sc1
    buffer_load_dwordx4 a[68:71], v6, s[8:11], s18 offen offset:256 sc1
    s_add_u32 s18, s18, 28672
    buffer_load_dwordx4 a[72:75], v6, s[8:11], s18 offen offset:0 sc1
    buffer_load_dwordx4 a[76:79], v6, s[8:11], s18 offen offset:256 sc1
    s_add_u32 s18, s18, 28672
    buffer_load_dwordx4 a[80:83], v6, s[8:11], s18 offen offset:0 sc1
    buffer_load_dwordx4 a[84:87], v6, s[8:11], s18 offen offset:256 sc1
    s_add_u32 s18, s18, 28672
    buffer_load_dwordx4 a[88:91], v6, s[8:11], s18 offen offset:0 sc1
    buffer_load_dwordx4 a[92:95], v6, s[8:11], s18 offen offset:256 sc1
    s_add_u32 s18, s18, 28672
    buffer_load_dwordx4 a[96:99], v6, s[8:11], s18 offen offset:0 sc1
    buffer_load_dwordx4 a[100:103], v6, s[8:11], s18 offen offset:256 sc1
    s_add_u32 s18, s18, 28672
    buffer_load_dwordx4 a[104:107], v6, s[8:11], s18 offen offset:0 sc1
    buffer_load_dwordx4 a[108:111], v6, s[8:11], s18 offen offset:256 sc1
    s_add_u32 s18, s18, 28672
    s_waitcnt lgkmcnt(0)
    s_mov_b32 s56, s44
    s_and_b32 s57, s45, 0xffff
    s_mov_b32 s58, 3584
    s_mov_b32 s59, 0x20000
    v_lshlrev_b32 v6, 4, v2
    s_lshl_b32 s18, s75, 7
    s_lshl_b32 s19, s12, 5
    s_add_u32 s18, s18, s19
    buffer_load_dwordx4 v[16:19], v6, s[56:59], s18 offen
    s_mov_b32 s56, s48
    s_and_b32 s57, s49, 0xffff
    s_mov_b32 s58, 896
    s_mov_b32 s59, 0x20000
    s_mov_b32 s76, s50
    s_and_b32 s77, s51, 0xffff
    s_mov_b32 s78, 1835008
    s_mov_b32 s79, 0x20000
    v_lshlrev_b32 v6, 4, v7
    s_lshl_b32 s74, s21, 6
    buffer_load_dwordx4 v[20:23], v6, s[56:59], s74 offen
    s_lshl_b32 s18, s12, 13
    v_add_u32 v229, s18, v4
    s_lshl_b32 s18, s12, 11
    v_add_u32 v230, s18, v4
    v_lshlrev_b32 v231, 9, v7
    v_lshl_add_u32 v231, v8, 4, v231
    v_lshlrev_b32 v232, 10, v7
    v_lshl_add_u32 v232, v8, 4, v232
    v_mul_u32_u24 v233, 896, v8
    v_lshl_add_u32 v233, v7, 4, v233
    s_mul_i32 s70, s60, 28672
    s_mul_i32 s18, s12, 7168
    s_add_u32 s70, s70, s18
    s_add_u32 s70, s70, 103284736
    s_mul_i32 s72, s60, 114688
    s_add_u32 s72, s72, 93323264
    s_lshl_b32 s18, s75, 12
    s_add_u32 s71, s72, s18
    s_lshl_b32 s18, s12, 10
    s_add_u32 s71, s71, s18
    s_mul_i32 s18, s12, 28672
    s_add_u32 s72, s72, s18
    s_lshl_b32 s18, s20, 8
    s_add_u32 s72, s72, s18
    s_mul_i32 s73, s60, 57344
    s_add_u32 s73, s73, s18
    s_lshl_b32 s18, s21, 12
    s_add_u32 s73, s73, s18
    s_add_u32 s73, s73, 77594624
    s_lshl_b32 s18, s60, 1
    s_add_u32 s18, s18, s20
    s_mul_i32 s18, s18, 14336
    s_add_u32 s74, s74, s18
    s_waitcnt vmcnt(0)
    v_lshlrev_b32 v236, 16, v16
    v_and_b32 v237, 0xffff0000, v16
    v_lshlrev_b32 v244, 16, v20
    v_and_b32 v248, 0xffff0000, v20
    v_lshlrev_b32 v238, 16, v17
    v_and_b32 v239, 0xffff0000, v17
    v_lshlrev_b32 v245, 16, v21
    v_and_b32 v249, 0xffff0000, v21
    v_lshlrev_b32 v240, 16, v18
    v_and_b32 v241, 0xffff0000, v18
    v_lshlrev_b32 v246, 16, v22
    v_and_b32 v250, 0xffff0000, v22
    v_lshlrev_b32 v242, 16, v19
    v_and_b32 v243, 0xffff0000, v19
    v_lshlrev_b32 v247, 16, v23
    v_and_b32 v251, 0xffff0000, v23
Lal0_50:
    v_mbcnt_lo_u32_b32 v9, -1, 0
    v_and_b32 v9, 7, v9
    v_lshlrev_b32 v9, 7, v9
    s_mov_b32 s18, 108557312
Lwd_51:
    buffer_load_dword v10, v9, s[8:11], s18 offen sc1
    s_sub_u32 s15, s15, 1
    s_cbranch_scc1 Lm_exit
    s_waitcnt vmcnt(0)
    v_cmp_gt_u32 vcc, 28, v10
    s_sleep 2
    s_cbranch_vccnz Lwd_51
    s_mul_i32 s20, s12, 7168
    s_mul_i32 s61, s60, 458752
    s_mul_i32 s18, s13, 28672
    s_add_u32 s61, s61, s18
    s_add_u32 s61, s61, s20
    s_add_u32 s61, s61, 46137344
    s_mul_i32 s62, s60, 28672
    s_add_u32 s62, s62, s20
    s_add_u32 s62, s62, 75497472
    s_mul_i32 s63, s60, 7168
    s_mul_i32 s18, s12, 1792
    s_add_u32 s63, s63, s18
    s_add_u32 s63, s63, 108068864
    s_mul_i32 s64, s60, 40960
    s_mul_i32 s18, s13, 2560
    s_add_u32 s64, s64, s18
    s_add_u32 s64, s64, 100663296
    v_and_b32 v9, 6, v1
    v_lshlrev_b32 v5, 5, v9
    v_lshl_add_u32 v5, v2, 5, v5
    v_and_b32 v9, 1, v1
    v_lshl_add_u32 v5, v9, 4, v5
    s_lshl_b32 s18, s12, 12
    v_add_u32 v6, s18, v4
    v_lshlrev_b32 v7, 2, v2
    v_sub_u32 v7, v3, v7
    v_lshlrev_b32 v8, 4, v3
    v_lshl_add_u32 v8, v2, 3, v8
    s_lshl_b32 s18, s12, 10
    v_add_u32 v11, s18, v4
    v_mov_b32 v60, v11
    v_mov_b32 v9, 1073741824
    v_cmp_le_u32 vcc, 2560, v11
    s_nop 1
    v_cndmask_b32 v11, v11, v9, vcc
    s_mov_b32 s65, s60
    s_mov_b32 s66, 2
    s_branch Lalp_57
Lal_52:
    s_cmp_ge_u32 s13, 14
    s_cbranch_scc1 Lalna_59
    s_add_u32 s20, s71, 688128
    s_cmp_ge_u32 s60, 58
    s_cselect_b32 s20, 1073741824, s20
    buffer_store_dwordx4 v[252:255], v4, s[8:11], s20 offen
Lalna_59:
    s_mov_b32 s66, 0
    s_cmp_lg_u32 s65, s60
    s_cbranch_scc1 Lalnx_61
Lalpost_60:
    s_add_u32 s20, s64, 245760
    s_cmp_ge_u32 s65, 58
    s_cselect_b32 s20, 1073741824, s20
    buffer_store_dwordx4 v[252:255], v11, s[8:11], s20 offen
    buffer_load_dwordx4 v[64:67], v5, s[8:11], s63 offen offset:0 sc1
    buffer_load_dwordx4 v[68:71], v5, s[8:11], s63 offen offset:256 sc1
    buffer_load_dwordx4 v[72:75], v5, s[8:11], s63 offen offset:512 sc1
    buffer_load_dwordx4 v[76:79], v5, s[8:11], s63 offen offset:768 sc1
    buffer_load_dwordx4 v[80:83], v5, s[8:11], s63 offen offset:1024 sc1
    buffer_load_dwordx4 v[84:87], v5, s[8:11], s63 offen offset:1280 sc1
    buffer_load_dwordx4 v[88:91], v5, s[8:11], s63 offen offset:1536 sc1
    s_waitcnt vmcnt(0)
    s_branch Lpc_63
Lpr_62:
    s_cmp_ge_u32 s60, 58
    s_cbranch_scc1 Lps_64
    s_sleep 6
Lps_64:
    buffer_load_dwordx4 v[64:67], v5, s[8:11], s63 offen offset:0 sc1
    buffer_load_dwordx4 v[68:71], v5, s[8:11], s63 offen offset:256 sc1
    buffer_load_dwordx4 v[72:75], v5, s[8:11], s63 offen offset:512 sc1
    buffer_load_dwordx4 v[76:79], v5, s[8:11], s63 offen offset:768 sc1
    buffer_load_dwordx4 v[80:83], v5, s[8:11], s63 offen offset:1024 sc1
    buffer_load_dwordx4 v[84:87], v5, s[8:11], s63 offen offset:1280 sc1
    buffer_load_dwordx4 v[88:91], v5, s[8:11], s63 offen offset:1536 sc1
    s_sub_u32 s15, s15, 1
    s_cbranch_scc1 Lm_exit
    s_waitcnt vmcnt(0)
Lpc_63:
    v_max_u32 v10, v64, v65
    v_max3_u32 v10, v10, v66, v67
    v_max3_u32 v10, v10, v68, v69
    v_max3_u32 v10, v10, v70, v71
    v_max3_u32 v10, v10, v72, v73
    v_max3_u32 v10, v10, v74, v75
    v_max3_u32 v10, v10, v76, v77
    v_max3_u32 v10, v10, v78, v79
    v_max3_u32 v10, v10, v80, v81
    v_max3_u32 v10, v10, v82, v83
    v_max3_u32 v10, v10, v84, v85
    v_max3_u32 v10, v10, v86, v87
    v_max3_u32 v10, v10, v88, v89
    v_max3_u32 v10, v10, v90, v91
    v_cmp_eq_u32 vcc, -1, v10
    s_cbranch_vccnz Lpr_62
    v_mfma_f32_32x32x16_bf16 v[92:107], v[64:67], v[16:19], 0
    v_mfma_f32_32x32x16_bf16 v[92:107], v[68:71], v[20:23], v[92:107]
    v_mfma_f32_32x32x16_bf16 v[92:107], v[72:75], v[24:27], v[92:107]
    v_mfma_f32_32x32x16_bf16 v[92:107], v[76:79], v[28:31], v[92:107]
    v_mfma_f32_32x32x16_bf16 v[92:107], v[80:83], v[32:35], v[92:107]
    v_mfma_f32_32x32x16_bf16 v[92:107], v[84:87], v[36:39], v[92:107]
    v_mfma_f32_32x32x16_bf16 v[92:107], v[88:91], v[40:43], v[92:107]
    s_nop 11
    ds_write_b128 v60, v[92:95] offset:20480
    s_waitcnt lgkmcnt(0)
    s_barrier
    ds_read_b128 v[108:111], v4 offset:20480
    ds_read_b128 v[112:115], v4 offset:21504
    ds_read_b128 v[116:119], v4 offset:22528
    ds_read_b128 v[120:123], v4 offset:23552
    s_waitcnt lgkmcnt(0)
    v_pk_add_f32 v[108:109], v[108:109], v[112:113]
    v_pk_add_f32 v[116:117], v[116:117], v[120:121]
    v_pk_add_f32 v[110:111], v[110:111], v[114:115]
    v_pk_add_f32 v[118:119], v[118:119], v[122:123]
    v_pk_add_f32 v[108:109], v[108:109], v[116:117]
    v_pk_add_f32 v[110:111], v[110:111], v[118:119]
    v_max3_f32 v9, v12, v108, v109
    v_max3_f32 v9, v9, v110, v111
    v_mov_b32 v10, v9
    s_nop 1
    v_permlane32_swap_b32 v9, v10
    v_max_f32 v9, v9, v10
    v_sub_f32 v14, v12, v9
    v_sub_f32 v108, v108, v9
    v_sub_f32 v109, v109, v9
    v_sub_f32 v110, v110, v9
    v_sub_f32 v111, v111, v9
    v_exp_f32 v14, v14
    v_exp_f32 v108, v108
    v_exp_f32 v109, v109
    v_exp_f32 v110, v110
    v_exp_f32 v111, v111
    v_fma_f32 v9, v14, v13, v108
    v_add_f32 v9, v9, v109
    v_add_f32 v9, v9, v110
    v_add_f32 v9, v9, v111
    v_mov_b32 v10, v9
    s_nop 1
    v_permlane32_swap_b32 v9, v10
    v_add_f32 v9, v9, v10
    v_rcp_f32 v9, v9
    s_cmp_eq_u32 s12, 1
    s_cbranch_scc1 Lala_53
    s_cmp_ge_u32 s12, 2
    s_cbranch_scc1 Lalb_54
    v_mul_f32 v14, v14, v9
    v_mov_b32 v15, v14
    v_pk_mul_f32 v[44:45], v[44:45], v[14:15]
    v_pk_mul_f32 v[46:47], v[46:47], v[14:15]
    v_pk_mul_f32 v[48:49], v[48:49], v[14:15]
    v_pk_mul_f32 v[50:51], v[50:51], v[14:15]
    v_cvt_pk_bf16_f32 v116, v44, v45
    v_cvt_pk_bf16_f32 v117, v46, v47
    v_cvt_pk_bf16_f32 v118, v48, v49
    v_cvt_pk_bf16_f32 v119, v50, v51
    v_min_u32 v116, -2, v116
    v_min_u32 v117, -2, v117
    v_min_u32 v118, -2, v118
    v_min_u32 v119, -2, v119
    buffer_store_dwordx4 v[116:119], v4, s[8:11], s64 offen offset:0
    s_branch Lale_55
Lala_53:
    v_mul_f32 v14, v14, v9
    v_mov_b32 v15, v14
    v_pk_mul_f32 v[52:53], v[52:53], v[14:15]
    v_pk_mul_f32 v[54:55], v[54:55], v[14:15]
    v_pk_mul_f32 v[56:57], v[56:57], v[14:15]
    v_pk_mul_f32 v[58:59], v[58:59], v[14:15]
    v_cvt_pk_bf16_f32 v116, v52, v53
    v_cvt_pk_bf16_f32 v117, v54, v55
    v_cvt_pk_bf16_f32 v118, v56, v57
    v_cvt_pk_bf16_f32 v119, v58, v59
    v_min_u32 v116, -2, v116
    v_min_u32 v117, -2, v117
    v_min_u32 v118, -2, v118
    v_min_u32 v119, -2, v119
    buffer_store_dwordx4 v[116:119], v4, s[8:11], s64 offen offset:1024
    s_branch Lale_55
Lalb_54:
    s_cmp_eq_u32 s12, 3
    s_cbranch_scc1 Lale_55
    v_mul_f32 v108, v108, v9
    v_mul_f32 v109, v109, v9
    v_mul_f32 v110, v110, v9
    v_mul_f32 v111, v111, v9
    v_cvt_pk_bf16_f32 v116, v108, v109
    v_cvt_pk_bf16_f32 v117, v110, v111
    v_min_u32 v116, -2, v116
    v_min_u32 v117, -2, v117
    buffer_store_dwordx2 v[116:117], v8, s[8:11], s64 offen offset:2048
Lale_55:
    s_barrier
    s_add_u32 s63, s63, 43008
    s_add_u32 s64, s64, 245760
    s_add_u32 s65, s65, 6
    s_cmp_eq_u32 s66, 1
    s_cbranch_scc1 Lalm_58
Lalnx_61:
    s_cmp_ge_u32 s65, 64
    s_cbranch_scc1 Lalm_58
Lalp_57:
    s_add_u32 s18, s61, 4096
    s_add_u32 s19, s62, 4096
    buffer_load_dwordx4 v[16:19], v4, s[8:11], s61 offen offset:0 sc1
    buffer_load_dwordx4 v[64:67], v4, s[8:11], s62 offen offset:0 sc1
    buffer_load_dwordx4 v[20:23], v4, s[8:11], s61 offen offset:1024 sc1
    buffer_load_dwordx4 v[68:71], v4, s[8:11], s62 offen offset:1024 sc1
    buffer_load_dwordx4 v[24:27], v4, s[8:11], s61 offen offset:2048 sc1
    buffer_load_dwordx4 v[72:75], v4, s[8:11], s62 offen offset:2048 sc1
    buffer_load_dwordx4 v[28:31], v4, s[8:11], s61 offen offset:3072 sc1
    buffer_load_dwordx4 v[76:79], v4, s[8:11], s62 offen offset:3072 sc1
    buffer_load_dwordx4 v[32:35], v4, s[8:11], s18 offen offset:0 sc1
    buffer_load_dwordx4 v[80:83], v4, s[8:11], s19 offen offset:0 sc1
    buffer_load_dwordx4 v[36:39], v4, s[8:11], s18 offen offset:1024 sc1
    buffer_load_dwordx4 v[84:87], v4, s[8:11], s19 offen offset:1024 sc1
    buffer_load_dwordx4 v[40:43], v4, s[8:11], s18 offen offset:2048 sc1
    buffer_load_dwordx4 v[88:91], v4, s[8:11], s19 offen offset:2048 sc1
    s_add_u32 s61, s61, 2752512
    s_add_u32 s62, s62, 172032
    buffer_load_dword v61, v5, s[8:11], s63 offen sc1
    s_waitcnt vmcnt(13)
    v_mfma_f32_32x32x16_bf16 v[92:107], v[64:67], v[16:19], 0
    s_waitcnt vmcnt(11)
    v_mfma_f32_32x32x16_bf16 v[92:107], v[68:71], v[20:23], v[92:107]
    s_waitcnt vmcnt(9)
    v_mfma_f32_32x32x16_bf16 v[92:107], v[72:75], v[24:27], v[92:107]
    s_waitcnt vmcnt(7)
    v_mfma_f32_32x32x16_bf16 v[92:107], v[76:79], v[28:31], v[92:107]
    s_waitcnt vmcnt(5)
    v_mfma_f32_32x32x16_bf16 v[92:107], v[80:83], v[32:35], v[92:107]
    s_waitcnt vmcnt(3)
    v_mfma_f32_32x32x16_bf16 v[92:107], v[84:87], v[36:39], v[92:107]
    s_waitcnt vmcnt(1)
    v_mfma_f32_32x32x16_bf16 v[92:107], v[88:91], v[40:43], v[92:107]
    s_nop 11
    ds_write_b128 v6, v[92:95] offset:1024
    ds_write_b128 v6, v[96:99] offset:2048
    ds_write_b128 v6, v[100:103] offset:3072
    ds_write_b128 v6, v[104:107] offset:4096
    s_waitcnt vmcnt(0)
    ds_write_b32 v60, v61 offset:61440
    s_waitcnt lgkmcnt(0)
    s_barrier
    ds_read_b32 v61, v4 offset:61440
    ds_read_b128 v[108:111], v4 offset:1024
    ds_read_b128 v[112:115], v4 offset:2048
    ds_read_b128 v[116:119], v4 offset:3072
    ds_read_b128 v[120:123], v4 offset:4096
    ds_read_b128 v[124:127], v4 offset:5120
    ds_read_b128 v[128:131], v4 offset:6144
    ds_read_b128 v[132:135], v4 offset:7168
    ds_read_b128 v[136:139], v4 offset:8192
    s_waitcnt lgkmcnt(0)
    ds_read_b128 v[140:143], v4 offset:9216
    ds_read_b128 v[144:147], v4 offset:10240
    ds_read_b128 v[148:151], v4 offset:11264
    ds_read_b128 v[152:155], v4 offset:12288
    ds_read_b128 v[156:159], v4 offset:13312
    ds_read_b128 v[160:163], v4 offset:14336
    ds_read_b128 v[164:167], v4 offset:15360
    ds_read_b128 v[168:171], v4 offset:16384
    s_waitcnt lgkmcnt(0)
    v_pk_add_f32 v[108:109], v[108:109], v[124:125]
    v_pk_add_f32 v[140:141], v[140:141], v[156:157]
    v_pk_add_f32 v[44:45], v[108:109], v[140:141]
    v_pk_add_f32 v[110:111], v[110:111], v[126:127]
    v_pk_add_f32 v[142:143], v[142:143], v[158:159]
    v_pk_add_f32 v[46:47], v[110:111], v[142:143]
    v_pk_add_f32 v[112:113], v[112:113], v[128:129]
    v_pk_add_f32 v[144:145], v[144:145], v[160:161]
    v_pk_add_f32 v[48:49], v[112:113], v[144:145]
    v_pk_add_f32 v[114:115], v[114:115], v[130:131]
    v_pk_add_f32 v[146:147], v[146:147], v[162:163]
    v_pk_add_f32 v[50:51], v[114:115], v[146:147]
    v_pk_add_f32 v[116:117], v[116:117], v[132:133]
    v_pk_add_f32 v[148:149], v[148:149], v[164:165]
    v_pk_add_f32 v[52:53], v[116:117], v[148:149]
    v_pk_add_f32 v[118:119], v[118:119], v[134:135]
    v_pk_add_f32 v[150:151], v[150:151], v[166:167]
    v_pk_add_f32 v[54:55], v[118:119], v[150:151]
    v_pk_add_f32 v[120:121], v[120:121], v[136:137]
    v_pk_add_f32 v[152:153], v[152:153], v[168:169]
    v_pk_add_f32 v[56:57], v[120:121], v[152:153]
    v_pk_add_f32 v[122:123], v[122:123], v[138:139]
    v_pk_add_f32 v[154:155], v[154:155], v[170:171]
    v_pk_add_f32 v[58:59], v[122:123], v[154:155]
    v_mov_b32 v10, 0xceabfb8f
    v_cmp_le_i32 vcc, 0, v7
    s_nop 1
    v_cndmask_b32 v44, v10, v44, vcc
    v_cmp_le_i32 vcc, 1, v7
    s_nop 1
    v_cndmask_b32 v45, v10, v45, vcc
    v_cmp_le_i32 vcc, 2, v7
    s_nop 1
    v_cndmask_b32 v46, v10, v46, vcc
    v_cmp_le_i32 vcc, 3, v7
    s_nop 1
    v_cndmask_b32 v47, v10, v47, vcc
    v_cmp_le_i32 vcc, 8, v7
    s_nop 1
    v_cndmask_b32 v48, v10, v48, vcc
    v_cmp_le_i32 vcc, 9, v7
    s_nop 1
    v_cndmask_b32 v49, v10, v49, vcc
    v_cmp_le_i32 vcc, 10, v7
    s_nop 1
    v_cndmask_b32 v50, v10, v50, vcc
    v_cmp_le_i32 vcc, 11, v7
    s_nop 1
    v_cndmask_b32 v51, v10, v51, vcc
    v_cmp_le_i32 vcc, 16, v7
    s_nop 1
    v_cndmask_b32 v52, v10, v52, vcc
    v_cmp_le_i32 vcc, 17, v7
    s_nop 1
    v_cndmask_b32 v53, v10, v53, vcc
    v_cmp_le_i32 vcc, 18, v7
    s_nop 1
    v_cndmask_b32 v54, v10, v54, vcc
    v_cmp_le_i32 vcc, 19, v7
    s_nop 1
    v_cndmask_b32 v55, v10, v55, vcc
    v_cmp_le_i32 vcc, 24, v7
    s_nop 1
    v_cndmask_b32 v56, v10, v56, vcc
    v_cmp_le_i32 vcc, 25, v7
    s_nop 1
    v_cndmask_b32 v57, v10, v57, vcc
    v_cmp_le_i32 vcc, 26, v7
    s_nop 1
    v_cndmask_b32 v58, v10, v58, vcc
    v_cmp_le_i32 vcc, 27, v7
    s_nop 1
    v_cndmask_b32 v59, v10, v59, vcc
    v_max_f32 v12, v44, v45
    v_max3_f32 v12, v12, v46, v47
    v_max3_f32 v12, v12, v48, v49
    v_max3_f32 v12, v12, v50, v51
    v_max3_f32 v12, v12, v52, v53
    v_max3_f32 v12, v12, v54, v55
    v_max3_f32 v12, v12, v56, v57
    v_max3_f32 v12, v12, v58, v59
    v_mov_b32 v10, v12
    s_nop 1
    v_permlane32_swap_b32 v12, v10
    v_max_f32 v12, v12, v10
    v_sub_f32 v44, v44, v12
    v_sub_f32 v45, v45, v12
    v_sub_f32 v46, v46, v12
    v_sub_f32 v47, v47, v12
    v_sub_f32 v48, v48, v12
    v_sub_f32 v49, v49, v12
    v_sub_f32 v50, v50, v12
    v_sub_f32 v51, v51, v12
    v_sub_f32 v52, v52, v12
    v_sub_f32 v53, v53, v12
    v_sub_f32 v54, v54, v12
    v_sub_f32 v55, v55, v12
    v_sub_f32 v56, v56, v12
    v_sub_f32 v57, v57, v12
    v_sub_f32 v58, v58, v12
    v_sub_f32 v59, v59, v12
    v_exp_f32 v44, v44
    v_exp_f32 v45, v45
    v_exp_f32 v46, v46
    v_exp_f32 v47, v47
    v_exp_f32 v48, v48
    v_exp_f32 v49, v49
    v_exp_f32 v50, v50
    v_exp_f32 v51, v51
    v_exp_f32 v52, v52
    v_exp_f32 v53, v53
    v_exp_f32 v54, v54
    v_exp_f32 v55, v55
    v_exp_f32 v56, v56
    v_exp_f32 v57, v57
    v_exp_f32 v58, v58
    v_exp_f32 v59, v59
    v_add_f32 v13, v44, v45
    v_add_f32 v13, v13, v46
    v_add_f32 v13, v13, v47
    v_add_f32 v13, v13, v48
    v_add_f32 v13, v13, v49
    v_add_f32 v13, v13, v50
    v_add_f32 v13, v13, v51
    v_add_f32 v13, v13, v52
    v_add_f32 v13, v13, v53
    v_add_f32 v13, v13, v54
    v_add_f32 v13, v13, v55
    v_add_f32 v13, v13, v56
    v_add_f32 v13, v13, v57
    v_add_f32 v13, v13, v58
    v_add_f32 v13, v13, v59
    s_cmp_eq_u32 s66, 2
    s_cbranch_scc1 Lal_52
    v_readfirstlane_b32 s67, v61
    s_mov_b32 s66, 1
    s_cmp_lg_u32 s67, -1
    s_cbranch_scc1 Lalpost_60
Lalm_58:
    s_cmp_ge_u32 s13, 14
    s_cbranch_scc1 Lalq_56
    s_add_u32 s19, s70, 4096
    buffer_load_dwordx4 v[64:67], v4, s[8:11], s70 offen offset:0 sc1
    buffer_load_dwordx4 v[68:71], v4, s[8:11], s70 offen offset:1024 sc1
    buffer_load_dwordx4 v[72:75], v4, s[8:11], s70 offen offset:2048 sc1
    buffer_load_dwordx4 v[76:79], v4, s[8:11], s70 offen offset:3072 sc1
    buffer_load_dwordx4 v[80:83], v4, s[8:11], s19 offen offset:0 sc1
    buffer_load_dwordx4 v[84:87], v4, s[8:11], s19 offen offset:1024 sc1
    buffer_load_dwordx4 v[88:91], v4, s[8:11], s19 offen offset:2048 sc1
    s_waitcnt vmcnt(0)
    s_branch Lpc_66
Lpr_65:
    s_cmp_ge_u32 s60, 58
    s_cbranch_scc1 Lps_67
    s_sleep 1
Lps_67:
    buffer_load_dwordx4 v[64:67], v4, s[8:11], s70 offen offset:0 sc1
    buffer_load_dwordx4 v[68:71], v4, s[8:11], s70 offen offset:1024 sc1
    buffer_load_dwordx4 v[72:75], v4, s[8:11], s70 offen offset:2048 sc1
    buffer_load_dwordx4 v[76:79], v4, s[8:11], s70 offen offset:3072 sc1
    buffer_load_dwordx4 v[80:83], v4, s[8:11], s19 offen offset:0 sc1
    buffer_load_dwordx4 v[84:87], v4, s[8:11], s19 offen offset:1024 sc1
    buffer_load_dwordx4 v[88:91], v4, s[8:11], s19 offen offset:2048 sc1
    s_sub_u32 s15, s15, 1
    s_cbranch_scc1 Lm_exit
    s_waitcnt vmcnt(0)
Lpc_66:
    v_max_u32 v10, v64, v65
    v_max3_u32 v10, v10, v66, v67
    v_max3_u32 v10, v10, v68, v69
    v_max3_u32 v10, v10, v70, v71
    v_max3_u32 v10, v10, v72, v73
    v_max3_u32 v10, v10, v74, v75
    v_max3_u32 v10, v10, v76, v77
    v_max3_u32 v10, v10, v78, v79
    v_max3_u32 v10, v10, v80, v81
    v_max3_u32 v10, v10, v82, v83
    v_max3_u32 v10, v10, v84, v85
    v_max3_u32 v10, v10, v86, v87
    v_max3_u32 v10, v10, v88, v89
    v_max3_u32 v10, v10, v90, v91
    v_cmp_eq_u32 vcc, -1, v10
    s_cbranch_vccnz Lpr_65
    v_mfma_f32_32x32x16_bf16 v[92:107], a[112:115], v[64:67], 0
    v_mfma_f32_32x32x16_bf16 v[108:123], a[140:143], v[64:67], 0
    v_mfma_f32_32x32x16_bf16 v[92:107], a[116:119], v[68:71], v[92:107]
    v_mfma_f32_32x32x16_bf16 v[108:123], a[144:147], v[68:71], v[108:123]
    v_mfma_f32_32x32x16_bf16 v[92:107], a[120:123], v[72:75], v[92:107]
    v_mfma_f32_32x32x16_bf16 v[108:123], a[148:151], v[72:75], v[108:123]
    v_mfma_f32_32x32x16_bf16 v[92:107], a[124:127], v[76:79], v[92:107]
    v_mfma_f32_32x32x16_bf16 v[108:123], a[152:155], v[76:79], v[108:123]
    v_mfma_f32_32x32x16_bf16 v[92:107], a[128:131], v[80:83], v[92:107]
    v_mfma_f32_32x32x16_bf16 v[108:123], a[156:159], v[80:83], v[108:123]
    v_mfma_f32_32x32x16_bf16 v[92:107], a[132:135], v[84:87], v[92:107]
    v_mfma_f32_32x32x16_bf16 v[108:123], a[160:163], v[84:87], v[108:123]
    v_mfma_f32_32x32x16_bf16 v[92:107], a[136:139], v[88:91], v[92:107]
    v_mfma_f32_32x32x16_bf16 v[108:123], a[164:167], v[88:91], v[108:123]
    v_mov_b32 v64, 0xc0135761
    v_mov_b32 v65, v64
    v_mov_b32 v66, 1.0
    v_mov_b32 v67, 1.0
    s_nop 6
    ds_write_b128 v229, v[92:95] offset:32768
    ds_write_b128 v229, v[96:99] offset:33792
    ds_write_b128 v229, v[100:103] offset:34816
    ds_write_b128 v229, v[104:107] offset:35840
    ds_write_b128 v229, v[108:111] offset:36864
    ds_write_b128 v229, v[112:115] offset:37888
    ds_write_b128 v229, v[116:119] offset:38912
    ds_write_b128 v229, v[120:123] offset:39936
    s_waitcnt lgkmcnt(0)
    s_barrier
    ds_read_b128 v[124:127], v230 offset:32768
    ds_read_b128 v[128:131], v230 offset:33792
    ds_read_b128 v[132:135], v230 offset:40960
    ds_read_b128 v[136:139], v230 offset:41984
    ds_read_b128 v[140:143], v230 offset:49152
    ds_read_b128 v[144:147], v230 offset:50176
    ds_read_b128 v[148:151], v230 offset:57344
    ds_read_b128 v[152:155], v230 offset:58368
    buffer_load_dwordx4 v[156:159], v232, s[8:11], s73 offen sc1
    buffer_load_dwordx4 v[160:163], v232, s[8:11], s73 offen offset:512 sc1
    s_waitcnt lgkmcnt(0)
    v_pk_add_f32 v[124:125], v[124:125], v[132:133]
    v_pk_add_f32 v[140:141], v[140:141], v[148:149]
    v_pk_add_f32 v[124:125], v[124:125], v[236:237]
    v_pk_add_f32 v[124:125], v[124:125], v[140:141]
    v_pk_add_f32 v[126:127], v[126:127], v[134:135]
    v_pk_add_f32 v[142:143], v[142:143], v[150:151]
    v_pk_add_f32 v[126:127], v[126:127], v[238:239]
    v_pk_add_f32 v[126:127], v[126:127], v[142:143]
    v_pk_add_f32 v[128:129], v[128:129], v[136:137]
    v_pk_add_f32 v[144:145], v[144:145], v[152:153]
    v_pk_add_f32 v[128:129], v[128:129], v[240:241]
    v_pk_add_f32 v[128:129], v[128:129], v[144:145]
    v_pk_add_f32 v[130:131], v[130:131], v[138:139]
    v_pk_add_f32 v[146:147], v[146:147], v[154:155]
    v_pk_add_f32 v[130:131], v[130:131], v[242:243]
    v_pk_add_f32 v[130:131], v[130:131], v[146:147]
    v_pk_mul_f32 v[132:133], v[124:125], v[124:125]
    v_pk_mul_f32 v[134:135], v[126:127], v[126:127]
    v_pk_mul_f32 v[136:137], v[128:129], v[128:129]
    v_pk_mul_f32 v[138:139], v[130:131], v[130:131]
    v_pk_fma_f32 v[132:133], v[132:133], s[30:31], v[64:65]
    v_pk_fma_f32 v[134:135], v[134:135], s[30:31], v[64:65]
    v_pk_fma_f32 v[136:137], v[136:137], s[30:31], v[64:65]
    v_pk_fma_f32 v[138:139], v[138:139], s[30:31], v[64:65]
    v_pk_mul_f32 v[132:133], v[132:133], v[124:125]
    v_pk_mul_f32 v[134:135], v[134:135], v[126:127]
    v_pk_mul_f32 v[136:137], v[136:137], v[128:129]
    v_pk_mul_f32 v[138:139], v[138:139], v[130:131]
    v_exp_f32 v132, v132
    v_exp_f32 v133, v133
    v_exp_f32 v134, v134
    v_exp_f32 v135, v135
    v_exp_f32 v136, v136
    v_exp_f32 v137, v137
    v_exp_f32 v138, v138
    v_exp_f32 v139, v139
    v_pk_add_f32 v[132:133], v[132:133], v[66:67]
    v_pk_add_f32 v[134:135], v[134:135], v[66:67]
    v_pk_add_f32 v[136:137], v[136:137], v[66:67]
    v_pk_add_f32 v[138:139], v[138:139], v[66:67]
    v_rcp_f32 v132, v132
    v_rcp_f32 v133, v133
    v_rcp_f32 v134, v134
    v_rcp_f32 v135, v135
    v_rcp_f32 v136, v136
    v_rcp_f32 v137, v137
    v_rcp_f32 v138, v138
    v_rcp_f32 v139, v139
    v_pk_mul_f32 v[124:125], v[124:125], v[132:133]
    v_pk_mul_f32 v[126:127], v[126:127], v[134:135]
    v_pk_mul_f32 v[128:129], v[128:129], v[136:137]
    v_pk_mul_f32 v[130:131], v[130:131], v[138:139]
    v_cvt_pk_bf16_f32 v140, v124, v125
    v_cvt_pk_bf16_f32 v141, v126, v127
    v_cvt_pk_bf16_f32 v142, v128, v129
    v_cvt_pk_bf16_f32 v143, v130, v131
    v_min_u32 v140, -2, v140
    v_min_u32 v141, -2, v141
    v_min_u32 v142, -2, v142
    v_min_u32 v143, -2, v143
    buffer_store_dwordx4 v[140:143], v4, s[8:11], s71 offen
    s_sleep 3
Lg2f_68:
    s_mov_b32 s18, s72
    buffer_load_dwordx4 v[64:67], v231, s[8:11], s18 offen offset:0 sc1
    buffer_load_dwordx4 v[68:71], v231, s[8:11], s18 offen offset:2048 sc1
    s_add_u32 s18, s18, 4096
    buffer_load_dwordx4 v[72:75], v231, s[8:11], s18 offen offset:0 sc1
    buffer_load_dwordx4 v[76:79], v231, s[8:11], s18 offen offset:2048 sc1
    s_add_u32 s18, s18, 4096
    buffer_load_dwordx4 v[80:83], v231, s[8:11], s18 offen offset:0 sc1
    buffer_load_dwordx4 v[84:87], v231, s[8:11], s18 offen offset:2048 sc1
    s_add_u32 s18, s18, 4096
    buffer_load_dwordx4 v[88:91], v231, s[8:11], s18 offen offset:0 sc1
    buffer_load_dwordx4 v[92:95], v231, s[8:11], s18 offen offset:2048 sc1
    s_add_u32 s18, s18, 4096
    buffer_load_dwordx4 v[96:99], v231, s[8:11], s18 offen offset:0 sc1
    buffer_load_dwordx4 v[100:103], v231, s[8:11], s18 offen offset:2048 sc1
    s_add_u32 s18, s18, 4096
    buffer_load_dwordx4 v[104:107], v231, s[8:11], s18 offen offset:0 sc1
    buffer_load_dwordx4 v[108:111], v231, s[8:11], s18 offen offset:2048 sc1
    s_add_u32 s18, s18, 4096
    buffer_load_dwordx4 v[112:115], v231, s[8:11], s18 offen offset:0 sc1
    buffer_load_dwordx4 v[116:119], v231, s[8:11], s18 offen offset:2048 sc1
    s_add_u32 s18, s18, 4096
    s_sub_u32 s15, s15, 1
    s_cbranch_scc1 Lm_exit
    v_mov_b32 v10, 0
    s_waitcnt vmcnt(13)
    v_mfma_f32_16x16x32_bf16 v[120:123], a[0:3], v[64:67], 0
    v_max3_u32 v10, v10, v64, v65
    v_mfma_f32_16x16x32_bf16 v[124:127], a[4:7], v[64:67], 0
    v_max3_u32 v10, v10, v66, v67
    s_waitcnt vmcnt(12)
    v_mfma_f32_16x16x32_bf16 v[120:123], a[8:11], v[68:71], v[120:123]
    v_max3_u32 v10, v10, v68, v69
    v_mfma_f32_16x16x32_bf16 v[124:127], a[12:15], v[68:71], v[124:127]
    v_max3_u32 v10, v10, v70, v71
    s_waitcnt vmcnt(11)
    v_mfma_f32_16x16x32_bf16 v[120:123], a[16:19], v[72:75], v[120:123]
    v_max3_u32 v10, v10, v72, v73
    v_mfma_f32_16x16x32_bf16 v[124:127], a[20:23], v[72:75], v[124:127]
    v_max3_u32 v10, v10, v74, v75
    s_waitcnt vmcnt(10)
    v_mfma_f32_16x16x32_bf16 v[120:123], a[24:27], v[76:79], v[120:123]
    v_max3_u32 v10, v10, v76, v77
    v_mfma_f32_16x16x32_bf16 v[124:127], a[28:31], v[76:79], v[124:127]
    v_max3_u32 v10, v10, v78, v79
    s_waitcnt vmcnt(9)
    v_mfma_f32_16x16x32_bf16 v[120:123], a[32:35], v[80:83], v[120:123]
    v_max3_u32 v10, v10, v80, v81
    v_mfma_f32_16x16x32_bf16 v[124:127], a[36:39], v[80:83], v[124:127]
    v_max3_u32 v10, v10, v82, v83
    s_waitcnt vmcnt(8)
    v_mfma_f32_16x16x32_bf16 v[120:123], a[40:43], v[84:87], v[120:123]
    v_max3_u32 v10, v10, v84, v85
    v_mfma_f32_16x16x32_bf16 v[124:127], a[44:47], v[84:87], v[124:127]
    v_max3_u32 v10, v10, v86, v87
    s_waitcnt vmcnt(7)
    v_mfma_f32_16x16x32_bf16 v[120:123], a[48:51], v[88:91], v[120:123]
    v_max3_u32 v10, v10, v88, v89
    v_mfma_f32_16x16x32_bf16 v[124:127], a[52:55], v[88:91], v[124:127]
    v_max3_u32 v10, v10, v90, v91
    s_waitcnt vmcnt(6)
    v_mfma_f32_16x16x32_bf16 v[120:123], a[56:59], v[92:95], v[120:123]
    v_max3_u32 v10, v10, v92, v93
    v_mfma_f32_16x16x32_bf16 v[124:127], a[60:63], v[92:95], v[124:127]
    v_max3_u32 v10, v10, v94, v95
    s_waitcnt vmcnt(5)
    v_mfma_f32_16x16x32_bf16 v[120:123], a[64:67], v[96:99], v[120:123]
    v_max3_u32 v10, v10, v96, v97
    v_mfma_f32_16x16x32_bf16 v[124:127], a[68:71], v[96:99], v[124:127]
    v_max3_u32 v10, v10, v98, v99
    s_waitcnt vmcnt(4)
    v_mfma_f32_16x16x32_bf16 v[120:123], a[72:75], v[100:103], v[120:123]
    v_max3_u32 v10, v10, v100, v101
    v_mfma_f32_16x16x32_bf16 v[124:127], a[76:79], v[100:103], v[124:127]
    v_max3_u32 v10, v10, v102, v103
    s_waitcnt vmcnt(3)
    v_mfma_f32_16x16x32_bf16 v[120:123], a[80:83], v[104:107], v[120:123]
    v_max3_u32 v10, v10, v104, v105
    v_mfma_f32_16x16x32_bf16 v[124:127], a[84:87], v[104:107], v[124:127]
    v_max3_u32 v10, v10, v106, v107
    s_waitcnt vmcnt(2)
    v_mfma_f32_16x16x32_bf16 v[120:123], a[88:91], v[108:111], v[120:123]
    v_max3_u32 v10, v10, v108, v109
    v_mfma_f32_16x16x32_bf16 v[124:127], a[92:95], v[108:111], v[124:127]
    v_max3_u32 v10, v10, v110, v111
    s_waitcnt vmcnt(1)
    v_mfma_f32_16x16x32_bf16 v[120:123], a[96:99], v[112:115], v[120:123]
    v_max3_u32 v10, v10, v112, v113
    v_mfma_f32_16x16x32_bf16 v[124:127], a[100:103], v[112:115], v[124:127]
    v_max3_u32 v10, v10, v114, v115
    s_waitcnt vmcnt(0)
    v_mfma_f32_16x16x32_bf16 v[120:123], a[104:107], v[116:119], v[120:123]
    v_max3_u32 v10, v10, v116, v117
    v_mfma_f32_16x16x32_bf16 v[124:127], a[108:111], v[116:119], v[124:127]
    v_max3_u32 v10, v10, v118, v119
    v_cmp_eq_u32 vcc, -1, v10
    s_cbranch_vccnz Lg2f_68
    s_nop 2
    ds_write_b128 v230, v[120:123] offset:24576
    s_nop 0
    ds_write_b128 v230, v[124:127] offset:25600
    s_waitcnt lgkmcnt(0)
    s_barrier
    s_cmp_lg_u32 s12, 0
    s_cbranch_scc1 Lg2s_69
    ds_read_b128 v[72:75], v4 offset:26624
    ds_read_b128 v[76:79], v4 offset:27648
    ds_read_b128 v[80:83], v4 offset:28672
    ds_read_b128 v[84:87], v4 offset:29696
    ds_read_b128 v[88:91], v4 offset:30720
    ds_read_b128 v[92:95], v4 offset:31744
    v_pk_add_f32 v[156:157], v[156:157], v[244:245]
    v_pk_add_f32 v[158:159], v[158:159], v[246:247]
    v_pk_add_f32 v[160:161], v[160:161], v[248:249]
    v_pk_add_f32 v[162:163], v[162:163], v[250:251]
    s_waitcnt lgkmcnt(0)
    v_pk_add_f32 v[120:121], v[120:121], v[72:73]
    v_pk_add_f32 v[80:81], v[80:81], v[88:89]
    v_pk_add_f32 v[120:121], v[120:121], v[80:81]
    v_pk_add_f32 v[120:121], v[120:121], v[156:157]
    v_pk_add_f32 v[122:123], v[122:123], v[74:75]
    v_pk_add_f32 v[82:83], v[82:83], v[90:91]
    v_pk_add_f32 v[122:123], v[122:123], v[82:83]
    v_pk_add_f32 v[122:123], v[122:123], v[158:159]
    v_pk_add_f32 v[124:125], v[124:125], v[76:77]
    v_pk_add_f32 v[84:85], v[84:85], v[92:93]
    v_pk_add_f32 v[124:125], v[124:125], v[84:85]
    v_pk_add_f32 v[124:125], v[124:125], v[160:161]
    v_pk_add_f32 v[126:127], v[126:127], v[78:79]
    v_pk_add_f32 v[86:87], v[86:87], v[94:95]
    v_pk_add_f32 v[126:127], v[126:127], v[86:87]
    v_pk_add_f32 v[126:127], v[126:127], v[162:163]
    v_cvt_pk_bf16_f32 v64, v120, v124
    v_cvt_pk_bf16_f32 v65, v121, v125
    v_cvt_pk_bf16_f32 v66, v122, v126
    v_cvt_pk_bf16_f32 v67, v123, v127
    buffer_store_dwordx4 v[64:67], v233, s[76:79], s74 offen
Lg2s_69:
    s_add_u32 s70, s70, 172032
    s_add_u32 s71, s71, 688128
    s_add_u32 s72, s72, 688128
    s_add_u32 s73, s73, 344064
    s_add_u32 s74, s74, 172032
Lalq_56:
    s_add_u32 s60, s60, 6
    s_cmp_lt_u32 s60, 64
    s_cbranch_scc1 Lal_52
    s_endpgm
Lk_beta:
    s_sub_u32 s61, s13, 16
    s_sub_u32 s75, s13, 2
    s_load_dwordx2 s[44:45], s[0:1], 72
    s_load_dwordx4 s[48:51], s[0:1], 88
    v_and_b32 v5, 0x13, v3
    v_and_b32 v6, 4, v3
    v_lshl_or_b32 v5, v6, 1, v5
    v_and_b32 v6, 8, v3
    v_lshrrev_b32 v6, 1, v6
    v_or_b32 v5, v5, v6
    v_mul_u32_u24 v6, 28672, v2
    v_lshl_add_u32 v6, v5, 4, v6
    s_mul_i32 s18, s12, 401408
    s_lshl_b32 s19, s75, 10
    s_add_u32 s18, s18, s19
    s_add_u32 s18, s18, 81788928
    buffer_load_dwordx4 a[112:115], v6, s[8:11], s18 offen offset:0 sc1
    buffer_load_dwordx4 a[140:143], v6, s[8:11], s18 offen offset:512 sc1
    s_add_u32 s18, s18, 57344
    buffer_load_dwordx4 a[116:119], v6, s[8:11], s18 offen offset:0 sc1
    buffer_load_dwordx4 a[144:147], v6, s[8:11], s18 offen offset:512 sc1
    s_add_u32 s18, s18, 57344
    buffer_load_dwordx4 a[120:123], v6, s[8:11], s18 offen offset:0 sc1
    buffer_load_dwordx4 a[148:151], v6, s[8:11], s18 offen offset:512 sc1
    s_add_u32 s18, s18, 57344
    buffer_load_dwordx4 a[124:127], v6, s[8:11], s18 offen offset:0 sc1
    buffer_load_dwordx4 a[152:155], v6, s[8:11], s18 offen offset:512 sc1
    s_add_u32 s18, s18, 57344
    buffer_load_dwordx4 a[128:131], v6, s[8:11], s18 offen offset:0 sc1
    buffer_load_dwordx4 a[156:159], v6, s[8:11], s18 offen offset:512 sc1
    s_add_u32 s18, s18, 57344
    buffer_load_dwordx4 a[132:135], v6, s[8:11], s18 offen offset:0 sc1
    buffer_load_dwordx4 a[160:163], v6, s[8:11], s18 offen offset:512 sc1
    s_add_u32 s18, s18, 57344
    buffer_load_dwordx4 a[136:139], v6, s[8:11], s18 offen offset:0 sc1
    buffer_load_dwordx4 a[164:167], v6, s[8:11], s18 offen offset:512 sc1
    s_add_u32 s18, s18, 57344
    s_cmp_ge_u32 s75, 14
    s_cselect_b32 s20, 1, 0
    s_mul_i32 s21, s20, 14
    s_sub_u32 s21, s75, s21
    v_lshrrev_b32 v7, 4, v1
    v_and_b32 v8, 15, v1
    v_mul_u32_u24 v6, 7168, v7
    v_lshl_add_u32 v6, v8, 4, v6
    s_mul_i32 s18, s12, 401408
    s_lshl_b32 s19, s21, 9
    s_add_u32 s18, s18, s19
    s_add_u32 s18, s18, 83886080
    buffer_load_dwordx4 a[0:3], v6, s[8:11], s18 offen offset:0 sc1
    buffer_load_dwordx4 a[4:7], v6, s[8:11], s18 offen offset:256 sc1
    s_add_u32 s18, s18, 28672
    buffer_load_dwordx4 a[8:11], v6, s[8:11], s18 offen offset:0 sc1
    buffer_load_dwordx4 a[12:15], v6, s[8:11], s18 offen offset:256 sc1
    s_add_u32 s18, s18, 28672
    buffer_load_dwordx4 a[16:19], v6, s[8:11], s18 offen offset:0 sc1
    buffer_load_dwordx4 a[20:23], v6, s[8:11], s18 offen offset:256 sc1
    s_add_u32 s18, s18, 28672
    buffer_load_dwordx4 a[24:27], v6, s[8:11], s18 offen offset:0 sc1
    buffer_load_dwordx4 a[28:31], v6, s[8:11], s18 offen offset:256 sc1
    s_add_u32 s18, s18, 28672
    buffer_load_dwordx4 a[32:35], v6, s[8:11], s18 offen offset:0 sc1
    buffer_load_dwordx4 a[36:39], v6, s[8:11], s18 offen offset:256 sc1
    s_add_u32 s18, s18, 28672
    buffer_load_dwordx4 a[40:43], v6, s[8:11], s18 offen offset:0 sc1
    buffer_load_dwordx4 a[44:47], v6, s[8:11], s18 offen offset:256 sc1
    s_add_u32 s18, s18, 28672
    buffer_load_dwordx4 a[48:51], v6, s[8:11], s18 offen offset:0 sc1
    buffer_load_dwordx4 a[52:55], v6, s[8:11], s18 offen offset:256 sc1
    s_add_u32 s18, s18, 28672
    buffer_load_dwordx4 a[56:59], v6, s[8:11], s18 offen offset:0 sc1
    buffer_load_dwordx4 a[60:63], v6, s[8:11], s18 offen offset:256 sc1
    s_add_u32 s18, s18, 28672
    buffer_load_dwordx4 a[64:67], v6, s[8:11], s18 offen offset:0 sc1
    buffer_load_dwordx4 a[68:71], v6, s[8:11], s18 offen offset:256 sc1
    s_add_u32 s18, s18, 28672
    buffer_load_dwordx4 a[72:75], v6, s[8:11], s18 offen offset:0 sc1
    buffer_load_dwordx4 a[76:79], v6, s[8:11], s18 offen offset:256 sc1
    s_add_u32 s18, s18, 28672
    buffer_load_dwordx4 a[80:83], v6, s[8:11], s18 offen offset:0 sc1
    buffer_load_dwordx4 a[84:87], v6, s[8:11], s18 offen offset:256 sc1
    s_add_u32 s18, s18, 28672
    buffer_load_dwordx4 a[88:91], v6, s[8:11], s18 offen offset:0 sc1
    buffer_load_dwordx4 a[92:95], v6, s[8:11], s18 offen offset:256 sc1
    s_add_u32 s18, s18, 28672
    buffer_load_dwordx4 a[96:99], v6, s[8:11], s18 offen offset:0 sc1
    buffer_load_dwordx4 a[100:103], v6, s[8:11], s18 offen offset:256 sc1
    s_add_u32 s18, s18, 28672
    buffer_load_dwordx4 a[104:107], v6, s[8:11], s18 offen offset:0 sc1
    buffer_load_dwordx4 a[108:111], v6, s[8:11], s18 offen offset:256 sc1
    s_add_u32 s18, s18, 28672
    s_waitcnt lgkmcnt(0)
    s_mov_b32 s56, s44
    s_and_b32 s57, s45, 0xffff
    s_mov_b32 s58, 3584
    s_mov_b32 s59, 0x20000
    v_lshlrev_b32 v6, 4, v2
    s_lshl_b32 s18, s75, 7
    s_lshl_b32 s19, s12, 5
    s_add_u32 s18, s18, s19
    buffer_load_dwordx4 v[16:19], v6, s[56:59], s18 offen
    s_mov_b32 s56, s48
    s_and_b32 s57, s49, 0xffff
    s_mov_b32 s58, 896
    s_mov_b32 s59, 0x20000
    s_mov_b32 s76, s50
    s_and_b32 s77, s51, 0xffff
    s_mov_b32 s78, 1835008
    s_mov_b32 s79, 0x20000
    v_lshlrev_b32 v6, 4, v7
    s_lshl_b32 s74, s21, 6
    buffer_load_dwordx4 v[20:23], v6, s[56:59], s74 offen
    s_lshl_b32 s18, s12, 13
    v_add_u32 v229, s18, v4
    s_lshl_b32 s18, s12, 11
    v_add_u32 v230, s18, v4
    v_lshlrev_b32 v231, 9, v7
    v_lshl_add_u32 v231, v8, 4, v231
    v_lshlrev_b32 v232, 10, v7
    v_lshl_add_u32 v232, v8, 4, v232
    v_mul_u32_u24 v233, 896, v8
    v_lshl_add_u32 v233, v7, 4, v233
    s_mul_i32 s70, s60, 28672
    s_mul_i32 s18, s12, 7168
    s_add_u32 s70, s70, s18
    s_add_u32 s70, s70, 103284736
    s_mul_i32 s72, s60, 114688
    s_add_u32 s72, s72, 93323264
    s_lshl_b32 s18, s75, 12
    s_add_u32 s71, s72, s18
    s_lshl_b32 s18, s12, 10
    s_add_u32 s71, s71, s18
    s_mul_i32 s18, s12, 28672
    s_add_u32 s72, s72, s18
    s_lshl_b32 s18, s20, 8
    s_add_u32 s72, s72, s18
    s_mul_i32 s73, s60, 57344
    s_add_u32 s73, s73, s18
    s_lshl_b32 s18, s21, 12
    s_add_u32 s73, s73, s18
    s_add_u32 s73, s73, 77594624
    s_lshl_b32 s18, s60, 1
    s_add_u32 s18, s18, s20
    s_mul_i32 s18, s18, 14336
    s_add_u32 s74, s74, s18
    s_waitcnt vmcnt(0)
    v_lshlrev_b32 v236, 16, v16
    v_and_b32 v237, 0xffff0000, v16
    v_lshlrev_b32 v244, 16, v20
    v_and_b32 v248, 0xffff0000, v20
    v_lshlrev_b32 v238, 16, v17
    v_and_b32 v239, 0xffff0000, v17
    v_lshlrev_b32 v245, 16, v21
    v_and_b32 v249, 0xffff0000, v21
    v_lshlrev_b32 v240, 16, v18
    v_and_b32 v241, 0xffff0000, v18
    v_lshlrev_b32 v246, 16, v22
    v_and_b32 v250, 0xffff0000, v22
    v_lshlrev_b32 v242, 16, v19
    v_and_b32 v243, 0xffff0000, v19
    v_lshlrev_b32 v247, 16, v23
    v_and_b32 v251, 0xffff0000, v23
    v_mbcnt_lo_u32_b32 v9, -1, 0
    v_and_b32 v9, 7, v9
    v_lshlrev_b32 v9, 7, v9
    s_mov_b32 s18, 108557312
Lwd_70:
    buffer_load_dword v10, v9, s[8:11], s18 offen sc1
    s_sub_u32 s15, s15, 1
    s_cbranch_scc1 Lm_exit
    s_waitcnt vmcnt(0)
    v_cmp_gt_u32 vcc, 28, v10
    s_sleep 2
    s_cbranch_vccnz Lwd_70
    s_load_dwordx2 s[44:45], s[0:1], 0
    v_and_b32 v9, 7, v3
    v_lshlrev_b32 v9, 1, v9
    v_and_b32 v10, 16, v3
    v_or_b32 v9, v9, v10
    v_bfe_u32 v10, v3, 3, 1
    v_or_b32 v9, v9, v10
    s_lshl_b32 s18, s61, 5
    v_add_u32 v9, s18, v9
    v_mul_u32_u24 v10, 2341, v9
    v_lshrrev_b32 v10, 16, v10
    v_mul_u32_u24 v11, 28, v10
    v_sub_u32 v9, v9, v11
    v_mul_u32_u24 v6, 7168, v10
    v_lshl_add_u32 v6, v9, 4, v6
    v_mul_u32_u24 v10, 448, v2
    v_add_u32 v6, v6, v10
    v_and_b32 v10, 1, v9
    v_mul_u32_u24 v10, 14, v10
    v_lshrrev_b32 v9, 1, v9
    v_add3_u32 v9, v9, v10, v11
    v_mul_u32_u24 v10, 14336, v2
    v_lshl_add_u32 v5, v9, 4, v10
    v_mul_u32_u24 v7, 2560, v2
    v_lshl_add_u32 v7, v3, 4, v7
    v_mul_u32_u24 v8, 896, v3
    v_lshl_add_u32 v8, v2, 4, v8
    s_lshl_b32 s18, s12, 12
    v_add_u32 v11, s18, v4
    s_and_b32 s20, s12, 1
    s_lshl_b32 s18, s20, 11
    v_add_u32 v12, s18, v4
    v_lshlrev_b32 v13, 10, v2
    v_lshl_add_u32 v13, v3, 4, v13
    v_lshlrev_b32 v14, 3, v3
    v_mul_u32_u24 v15, 3584, v2
    v_add_u32 v15, v15, v14
    s_mul_i32 s62, s60, 458752
    s_mul_i32 s18, s12, 114688
    s_add_u32 s62, s62, s18
    s_add_u32 s62, s62, 16777216
    s_mul_i32 s63, s60, 28672
    s_lshl_b32 s18, s61, 6
    s_add_u32 s63, s63, s18
    s_lshl_b32 s18, s20, 5
    s_add_u32 s63, s63, s18
    s_mul_i32 s64, s60, 40960
    s_mul_i32 s18, s12, 10240
    s_add_u32 s64, s64, s18
    s_add_u32 s64, s64, 100663296
    s_mul_i32 s65, s60, 114688
    s_mul_i32 s18, s12, 1792
    s_add_u32 s65, s65, s18
    s_add_u32 s65, s65, 85983232
    s_mul_i32 s18, s60, 28
    s_lshl_b32 s19, s61, 1
    s_add_u32 s19, s19, s20
    s_add_u32 s18, s18, s19
    s_lshl_b32 s66, s18, 11
    s_add_u32 s66, s66, 77594624
    s_lshl_b32 s67, s18, 10
    s_add_u32 s67, s67, 103284736
    s_mul_i32 s68, s60, 7168
    s_add_u32 s68, s68, 105119744
    s_lshl_b32 s69, s19, 8
    s_waitcnt lgkmcnt(0)
    s_mov_b32 s56, s44
    s_and_b32 s57, s45, 0xffff
    s_mov_b32 s58, 1835008
    s_mov_b32 s59, 0x20000
    s_add_u32 s18, s62, 0
    buffer_load_dwordx4 v[16:19], v5, s[8:11], s18 offen sc1
    s_add_u32 s18, s62, 7168
    buffer_load_dwordx4 v[20:23], v5, s[8:11], s18 offen sc1
    s_add_u32 s18, s62, 28672
    buffer_load_dwordx4 v[24:27], v5, s[8:11], s18 offen sc1
    s_add_u32 s18, s62, 35840
    buffer_load_dwordx4 v[28:31], v5, s[8:11], s18 offen sc1
    s_add_u32 s18, s62, 57344
    buffer_load_dwordx4 v[32:35], v5, s[8:11], s18 offen sc1
    s_add_u32 s18, s62, 64512
    buffer_load_dwordx4 v[36:39], v5, s[8:11], s18 offen sc1
    s_add_u32 s18, s62, 86016
    buffer_load_dwordx4 v[40:43], v5, s[8:11], s18 offen sc1
    s_add_u32 s18, s62, 93184
    buffer_load_dwordx4 v[44:47], v5, s[8:11], s18 offen sc1
    buffer_load_dwordx4 v[48:51], v8, s[56:59], s63 offen
    s_add_u32 s62, s62, 2752512
    s_add_u32 s63, s63, 172032
    s_add_u32 s48, s64, 0
    s_add_u32 s49, s64, 2560
    s_add_u32 s50, s64, 5120
    s_add_u32 s51, s64, 7680
    s_mov_b32 s52, s65
    buffer_load_dwordx4 v[172:175], v4, s[8:11], s48 offen offset:0 sc1
    buffer_load_dwordx4 v[176:179], v4, s[8:11], s48 offen offset:1024 sc1
    buffer_load_dwordx4 v[180:183], v4, s[8:11], s49 offen offset:0 sc1
    buffer_load_dwordx4 v[184:187], v4, s[8:11], s49 offen offset:1024 sc1
    buffer_load_dwordx4 v[188:191], v4, s[8:11], s50 offen offset:0 sc1
    buffer_load_dwordx4 v[192:195], v4, s[8:11], s50 offen offset:1024 sc1
    buffer_load_dwordx4 v[196:199], v4, s[8:11], s51 offen offset:0 sc1
    buffer_load_dwordx4 v[200:203], v4, s[8:11], s51 offen offset:1024 sc1
    buffer_load_dwordx4 v[204:207], v7, s[8:11], s48 offen offset:2048 sc1
    buffer_load_dwordx4 v[208:211], v7, s[8:11], s50 offen offset:2048 sc1
    buffer_load_dwordx4 v[212:215], v6, s[8:11], s52 offen offset:0 sc1
    buffer_load_dwordx4 v[216:219], v6, s[8:11], s52 offen offset:896 sc1
    s_add_u32 s64, s64, 245760
    s_add_u32 s65, s65, 688128
Lbe_71:
    s_add_u32 s19, s67, 172032
    s_cmp_ge_u32 s60, 58
    s_cselect_b32 s19, 1073741824, s19
    s_add_u32 s18, s68, s69
    s_add_u32 s20, s18, 43008
    s_cmp_ge_u32 s60, 58
    s_cselect_b32 s20, 1073741824, s20
    buffer_store_dwordx4 v[252:255], v4, s[8:11], s19 offen
    buffer_store_dwordx2 v[252:253], v14, s[8:11], s20 offen
    s_add_u32 s20, s71, 688128
    s_cmp_ge_u32 s60, 58
    s_cselect_b32 s20, 1073741824, s20
    buffer_store_dwordx4 v[252:255], v4, s[8:11], s20 offen
    s_waitcnt vmcnt(3)
    s_branch Lpc_74
Lpr_73:
    s_cmp_ge_u32 s60, 58
    s_cbranch_scc1 Lps_75
    s_sleep 2
Lps_75:
    buffer_load_dwordx4 v[204:207], v7, s[8:11], s48 offen offset:2048 sc1
    buffer_load_dwordx4 v[208:211], v7, s[8:11], s50 offen offset:2048 sc1
    s_sub_u32 s15, s15, 1
    s_cbranch_scc1 Lm_exit
    s_waitcnt vmcnt(0)
Lpc_74:
    v_max_u32 v10, v204, v205
    v_max3_u32 v10, v10, v206, v207
    v_max3_u32 v10, v10, v208, v209
    v_max3_u32 v10, v10, v210, v211
    v_cmp_eq_u32 vcc, -1, v10
    s_cbranch_vccnz Lpr_73
    s_waitcnt vmcnt(3)
    s_branch Lpc_77
Lpr_76:
    buffer_load_dwordx4 v[172:175], v4, s[8:11], s48 offen offset:0 sc1
    buffer_load_dwordx4 v[176:179], v4, s[8:11], s48 offen offset:1024 sc1
    buffer_load_dwordx4 v[180:183], v4, s[8:11], s49 offen offset:0 sc1
    buffer_load_dwordx4 v[184:187], v4, s[8:11], s49 offen offset:1024 sc1
    buffer_load_dwordx4 v[188:191], v4, s[8:11], s50 offen offset:0 sc1
    buffer_load_dwordx4 v[192:195], v4, s[8:11], s50 offen offset:1024 sc1
    buffer_load_dwordx4 v[196:199], v4, s[8:11], s51 offen offset:0 sc1
    buffer_load_dwordx4 v[200:203], v4, s[8:11], s51 offen offset:1024 sc1
    buffer_load_dwordx4 v[212:215], v6, s[8:11], s52 offen offset:0 sc1
    buffer_load_dwordx4 v[216:219], v6, s[8:11], s52 offen offset:896 sc1
    s_sub_u32 s15, s15, 1
    s_cbranch_scc1 Lm_exit
    s_waitcnt vmcnt(2)
Lpc_77:
    v_max_u32 v10, v172, v173
    v_max3_u32 v10, v10, v174, v175
    v_max3_u32 v10, v10, v176, v177
    v_max3_u32 v10, v10, v178, v179
    v_max3_u32 v10, v10, v180, v181
    v_max3_u32 v10, v10, v182, v183
    v_max3_u32 v10, v10, v184, v185
    v_max3_u32 v10, v10, v186, v187
    v_max3_u32 v10, v10, v188, v189
    v_max3_u32 v10, v10, v190, v191
    v_max3_u32 v10, v10, v192, v193
    v_max3_u32 v10, v10, v194, v195
    v_max3_u32 v10, v10, v196, v197
    v_max3_u32 v10, v10, v198, v199
    v_max3_u32 v10, v10, v200, v201
    v_max3_u32 v10, v10, v202, v203
    v_cmp_eq_u32 vcc, -1, v10
    s_cbranch_vccnz Lpr_76
    v_mfma_f32_32x32x16_bf16 v[112:127], v[16:19], v[172:175], 0
    v_mfma_f32_32x32x16_bf16 v[112:127], v[20:23], v[176:179], v[112:127]
    v_mfma_f32_32x32x16_bf16 v[112:127], v[24:27], v[180:183], v[112:127]
    v_mfma_f32_32x32x16_bf16 v[112:127], v[28:31], v[184:187], v[112:127]
    v_mfma_f32_32x32x16_bf16 v[112:127], v[32:35], v[188:191], v[112:127]
    v_mfma_f32_32x32x16_bf16 v[112:127], v[36:39], v[192:195], v[112:127]
    v_mfma_f32_32x32x16_bf16 v[112:127], v[40:43], v[196:199], v[112:127]
    v_mfma_f32_32x32x16_bf16 v[112:127], v[44:47], v[200:203], v[112:127]
    v_lshlrev_b32 v52, 16, v48
    v_and_b32 v56, 0xffff0000, v48
    v_lshlrev_b32 v53, 16, v49
    v_and_b32 v57, 0xffff0000, v49
    v_lshlrev_b32 v54, 16, v50
    v_and_b32 v58, 0xffff0000, v50
    v_lshlrev_b32 v55, 16, v51
    v_and_b32 v59, 0xffff0000, v51
    s_waitcnt vmcnt(0)
    s_branch Lpc_79
Lpr_78:
    buffer_load_dwordx4 v[212:215], v6, s[8:11], s52 offen offset:0 sc1
    buffer_load_dwordx4 v[216:219], v6, s[8:11], s52 offen offset:896 sc1
    s_sub_u32 s15, s15, 1
    s_cbranch_scc1 Lm_exit
    s_waitcnt vmcnt(0)
Lpc_79:
    v_max_u32 v10, v212, v213
    v_max3_u32 v10, v10, v214, v215
    v_max3_u32 v10, v10, v216, v217
    v_max3_u32 v10, v10, v218, v219
    v_cmp_eq_u32 vcc, -1, v10
    s_cbranch_vccnz Lpr_78
    v_mfma_f32_32x32x16_bf16 v[112:127], v[212:215], v[204:207], v[112:127]
    v_mfma_f32_32x32x16_bf16 v[112:127], v[216:219], v[208:211], v[112:127]
    s_nop 11
    ds_write_b128 v11, v[112:115] offset:1024
    ds_write_b128 v11, v[116:119] offset:2048
    ds_write_b128 v11, v[120:123] offset:3072
    ds_write_b128 v11, v[124:127] offset:4096
    s_waitcnt lgkmcnt(0)
    s_barrier
    s_cmp_ge_u32 s12, 2
    s_cbranch_scc1 Lbee_72
    ds_read_b128 v[128:131], v12 offset:1024
    ds_read_b128 v[132:135], v12 offset:2048
    ds_read_b128 v[136:139], v12 offset:5120
    ds_read_b128 v[140:143], v12 offset:6144
    ds_read_b128 v[144:147], v12 offset:9216
    ds_read_b128 v[148:151], v12 offset:10240
    ds_read_b128 v[152:155], v12 offset:13312
    ds_read_b128 v[156:159], v12 offset:14336
    s_waitcnt lgkmcnt(0)
    v_pk_add_f32 v[128:129], v[128:129], v[136:137]
    v_pk_add_f32 v[144:145], v[144:145], v[152:153]
    v_pk_add_f32 v[52:53], v[52:53], v[128:129]
    v_pk_add_f32 v[52:53], v[52:53], v[144:145]
    v_pk_add_f32 v[130:131], v[130:131], v[138:139]
    v_pk_add_f32 v[146:147], v[146:147], v[154:155]
    v_pk_add_f32 v[54:55], v[54:55], v[130:131]
    v_pk_add_f32 v[54:55], v[54:55], v[146:147]
    v_pk_add_f32 v[132:133], v[132:133], v[140:141]
    v_pk_add_f32 v[148:149], v[148:149], v[156:157]
    v_pk_add_f32 v[56:57], v[56:57], v[132:133]
    v_pk_add_f32 v[56:57], v[56:57], v[148:149]
    v_pk_add_f32 v[134:135], v[134:135], v[142:143]
    v_pk_add_f32 v[150:151], v[150:151], v[158:159]
    v_pk_add_f32 v[58:59], v[58:59], v[134:135]
    v_pk_add_f32 v[58:59], v[58:59], v[150:151]
    v_pk_add_f32 v[60:61], v[52:53], v[54:55]
    v_pk_add_f32 v[62:63], v[56:57], v[58:59]
    v_pk_add_f32 v[60:61], v[60:61], v[62:63]
    v_add_f32 v60, v60, v61
    v_mov_b32 v10, v60
    s_nop 1
    v_permlane32_swap_b32 v60, v10
    v_add_f32 v60, v60, v10
    v_mul_f32 v62, 0xbd800000, v60
    v_mov_b32 v63, v62
    v_pk_add_f32 v[128:129], v[52:53], v[62:63]
    v_pk_add_f32 v[130:131], v[54:55], v[62:63]
    v_pk_add_f32 v[132:133], v[56:57], v[62:63]
    v_pk_add_f32 v[134:135], v[58:59], v[62:63]
    v_pk_mul_f32 v[62:63], v[128:129], v[128:129]
    v_pk_fma_f32 v[62:63], v[130:131], v[130:131], v[62:63]
    v_pk_fma_f32 v[62:63], v[132:133], v[132:133], v[62:63]
    v_pk_fma_f32 v[62:63], v[134:135], v[134:135], v[62:63]
    v_add_f32 v61, v62, v63
    v_mov_b32 v10, v61
    s_nop 1
    v_permlane32_swap_b32 v61, v10
    v_add_f32 v61, v61, v10
    v_min_u32 v60, -2, v60
    v_min_u32 v61, -2, v61
    s_add_u32 s18, s68, s69
    s_mov_b32 exec_hi, 0
    buffer_store_dwordx2 v[60:61], v14, s[8:11], s18 offen
    s_mov_b32 exec_hi, -1
    buffer_store_dwordx4 v[52:55], v13, s[8:11], s66 offen offset:0
    buffer_store_dwordx4 v[56:59], v13, s[8:11], s66 offen offset:512
Lpr_80:
    buffer_load_dwordx2 v[128:129], v15, s[8:11], s68 offen offset:0 sc1
    buffer_load_dwordx2 v[130:131], v15, s[8:11], s68 offen offset:256 sc1
    buffer_load_dwordx2 v[132:133], v15, s[8:11], s68 offen offset:512 sc1
    buffer_load_dwordx2 v[134:135], v15, s[8:11], s68 offen offset:768 sc1
    buffer_load_dwordx2 v[136:137], v15, s[8:11], s68 offen offset:1024 sc1
    buffer_load_dwordx2 v[138:139], v15, s[8:11], s68 offen offset:1280 sc1
    buffer_load_dwordx2 v[140:141], v15, s[8:11], s68 offen offset:1536 sc1
    buffer_load_dwordx2 v[142:143], v15, s[8:11], s68 offen offset:1792 sc1
    buffer_load_dwordx2 v[144:145], v15, s[8:11], s68 offen offset:2048 sc1
    buffer_load_dwordx2 v[146:147], v15, s[8:11], s68 offen offset:2304 sc1
    buffer_load_dwordx2 v[148:149], v15, s[8:11], s68 offen offset:2560 sc1
    buffer_load_dwordx2 v[150:151], v15, s[8:11], s68 offen offset:2816 sc1
    buffer_load_dwordx2 v[152:153], v15, s[8:11], s68 offen offset:3072 sc1
    buffer_load_dwordx2 v[154:155], v15, s[8:11], s68 offen offset:3328 sc1
    s_sub_u32 s15, s15, 1
    s_cbranch_scc1 Lm_exit
    s_waitcnt vmcnt(0)
Lpc_81:
    v_max_u32 v10, v128, v129
    v_max3_u32 v10, v10, v130, v131
    v_max3_u32 v10, v10, v132, v133
    v_max3_u32 v10, v10, v134, v135
    v_max3_u32 v10, v10, v136, v137
    v_max3_u32 v10, v10, v138, v139
    v_max3_u32 v10, v10, v140, v141
    v_max3_u32 v10, v10, v142, v143
    v_max3_u32 v10, v10, v144, v145
    v_max3_u32 v10, v10, v146, v147
    v_max3_u32 v10, v10, v148, v149
    v_max3_u32 v10, v10, v150, v151
    v_max3_u32 v10, v10, v152, v153
    v_max3_u32 v10, v10, v154, v155
    v_cmp_eq_u32 vcc, -1, v10
    s_cbranch_vccnz Lpr_80
    v_pk_add_f32 v[60:61], v[128:129], v[130:131]
    v_pk_add_f32 v[60:61], v[60:61], v[132:133]
    v_pk_add_f32 v[60:61], v[60:61], v[134:135]
    v_pk_add_f32 v[60:61], v[60:61], v[136:137]
    v_pk_add_f32 v[60:61], v[60:61], v[138:139]
    v_pk_add_f32 v[60:61], v[60:61], v[140:141]
    v_pk_add_f32 v[60:61], v[60:61], v[142:143]
    v_pk_add_f32 v[60:61], v[60:61], v[144:145]
    v_pk_add_f32 v[60:61], v[60:61], v[146:147]
    v_pk_add_f32 v[60:61], v[60:61], v[148:149]
    v_pk_add_f32 v[60:61], v[60:61], v[150:151]
    v_pk_add_f32 v[60:61], v[60:61], v[152:153]
    v_pk_add_f32 v[60:61], v[60:61], v[154:155]
    v_mov_b32 v10, v60
    s_nop 1
    v_permlane32_swap_b32 v60, v10
    v_add_f32 v60, v60, v10
    v_mul_f32 v62, 0x3d124925, v60
    v_sub_f32 v128, v128, v62
    v_sub_f32 v130, v130, v62
    v_sub_f32 v132, v132, v62
    v_sub_f32 v134, v134, v62
    v_sub_f32 v136, v136, v62
    v_sub_f32 v138, v138, v62
    v_sub_f32 v140, v140, v62
    v_sub_f32 v142, v142, v62
    v_sub_f32 v144, v144, v62
    v_sub_f32 v146, v146, v62
    v_sub_f32 v148, v148, v62
    v_sub_f32 v150, v150, v62
    v_sub_f32 v152, v152, v62
    v_sub_f32 v154, v154, v62
    v_mul_f32 v63, v128, v128
    v_fmac_f32 v63, v130, v130
    v_fmac_f32 v63, v132, v132
    v_fmac_f32 v63, v134, v134
    v_fmac_f32 v63, v136, v136
    v_fmac_f32 v63, v138, v138
    v_fmac_f32 v63, v140, v140
    v_fmac_f32 v63, v142, v142
    v_fmac_f32 v63, v144, v144
    v_fmac_f32 v63, v146, v146
    v_fmac_f32 v63, v148, v148
    v_fmac_f32 v63, v150, v150
    v_fmac_f32 v63, v152, v152
    v_fmac_f32 v63, v154, v154
    v_fmac_f32 v61, 0x3d800000, v63
    v_mov_b32 v10, v61
    s_nop 1
    v_permlane32_swap_b32 v61, v10
    v_add_f32 v61, v61, v10
    v_mul_f32 v61, 0x3b124925, v61
    v_add_f32 v9, 0x3727c5ac, v61
    v_rsq_f32 v9, v9
    v_mul_f32 v62, 0xbb124925, v60
    v_mov_b32 v63, v62
    v_mul_f32 v61, v61, v9
    v_mov_b32 v10, 0x3727c5ac
    v_fmac_f32 v10, v61, v9
    v_rsq_f32 v10, v10
    v_pk_add_f32 v[128:129], v[52:53], v[62:63]
    v_pk_add_f32 v[130:131], v[54:55], v[62:63]
    v_pk_add_f32 v[132:133], v[56:57], v[62:63]
    v_pk_add_f32 v[134:135], v[58:59], v[62:63]
    v_mul_f32 v60, v9, v10
    v_mov_b32 v61, v60
    v_pk_mul_f32 v[128:129], v[128:129], v[60:61]
    v_pk_mul_f32 v[130:131], v[130:131], v[60:61]
    v_pk_mul_f32 v[132:133], v[132:133], v[60:61]
    v_pk_mul_f32 v[134:135], v[134:135], v[60:61]
    v_cvt_pk_bf16_f32 v136, v128, v132
    v_cvt_pk_bf16_f32 v137, v129, v133
    v_cvt_pk_bf16_f32 v138, v130, v134
    v_cvt_pk_bf16_f32 v139, v131, v135
    v_min_u32 v136, -2, v136
    v_min_u32 v137, -2, v137
    v_min_u32 v138, -2, v138
    v_min_u32 v139, -2, v139
    buffer_store_dwordx4 v[136:139], v4, s[8:11], s67 offen
Lbee_72:
    s_barrier
    s_add_u32 s19, s70, 4096
    buffer_load_dwordx4 v[64:67], v4, s[8:11], s70 offen offset:0 sc1
    buffer_load_dwordx4 v[68:71], v4, s[8:11], s70 offen offset:1024 sc1
    buffer_load_dwordx4 v[72:75], v4, s[8:11], s70 offen offset:2048 sc1
    buffer_load_dwordx4 v[76:79], v4, s[8:11], s70 offen offset:3072 sc1
    buffer_load_dwordx4 v[80:83], v4, s[8:11], s19 offen offset:0 sc1
    buffer_load_dwordx4 v[84:87], v4, s[8:11], s19 offen offset:1024 sc1
    buffer_load_dwordx4 v[88:91], v4, s[8:11], s19 offen offset:2048 sc1
    s_waitcnt vmcnt(0)
    s_branch Lpc_83
Lpr_82:
    s_cmp_ge_u32 s60, 58
    s_cbranch_scc1 Lps_84
    s_sleep 1
Lps_84:
    buffer_load_dwordx4 v[64:67], v4, s[8:11], s70 offen offset:0 sc1
    buffer_load_dwordx4 v[68:71], v4, s[8:11], s70 offen offset:1024 sc1
    buffer_load_dwordx4 v[72:75], v4, s[8:11], s70 offen offset:2048 sc1
    buffer_load_dwordx4 v[76:79], v4, s[8:11], s70 offen offset:3072 sc1
    buffer_load_dwordx4 v[80:83], v4, s[8:11], s19 offen offset:0 sc1
    buffer_load_dwordx4 v[84:87], v4, s[8:11], s19 offen offset:1024 sc1
    buffer_load_dwordx4 v[88:91], v4, s[8:11], s19 offen offset:2048 sc1
    s_sub_u32 s15, s15, 1
    s_cbranch_scc1 Lm_exit
    s_waitcnt vmcnt(0)
Lpc_83:
    v_max_u32 v10, v64, v65
    v_max3_u32 v10, v10, v66, v67
    v_max3_u32 v10, v10, v68, v69
    v_max3_u32 v10, v10, v70, v71
    v_max3_u32 v10, v10, v72, v73
    v_max3_u32 v10, v10, v74, v75
    v_max3_u32 v10, v10, v76, v77
    v_max3_u32 v10, v10, v78, v79
    v_max3_u32 v10, v10, v80, v81
    v_max3_u32 v10, v10, v82, v83
    v_max3_u32 v10, v10, v84, v85
    v_max3_u32 v10, v10, v86, v87
    v_max3_u32 v10, v10, v88, v89
    v_max3_u32 v10, v10, v90, v91
    v_cmp_eq_u32 vcc, -1, v10
    s_cbranch_vccnz Lpr_82
    v_mfma_f32_32x32x16_bf16 v[92:107], a[112:115], v[64:67], 0
    v_mfma_f32_32x32x16_bf16 v[108:123], a[140:143], v[64:67], 0
    v_mfma_f32_32x32x16_bf16 v[92:107], a[116:119], v[68:71], v[92:107]
    v_mfma_f32_32x32x16_bf16 v[108:123], a[144:147], v[68:71], v[108:123]
    v_mfma_f32_32x32x16_bf16 v[92:107], a[120:123], v[72:75], v[92:107]
    v_mfma_f32_32x32x16_bf16 v[108:123], a[148:151], v[72:75], v[108:123]
    v_mfma_f32_32x32x16_bf16 v[92:107], a[124:127], v[76:79], v[92:107]
    v_mfma_f32_32x32x16_bf16 v[108:123], a[152:155], v[76:79], v[108:123]
    v_mfma_f32_32x32x16_bf16 v[92:107], a[128:131], v[80:83], v[92:107]
    v_mfma_f32_32x32x16_bf16 v[108:123], a[156:159], v[80:83], v[108:123]
    v_mfma_f32_32x32x16_bf16 v[92:107], a[132:135], v[84:87], v[92:107]
    v_mfma_f32_32x32x16_bf16 v[108:123], a[160:163], v[84:87], v[108:123]
    v_mfma_f32_32x32x16_bf16 v[92:107], a[136:139], v[88:91], v[92:107]
    v_mfma_f32_32x32x16_bf16 v[108:123], a[164:167], v[88:91], v[108:123]
    s_cmp_ge_u32 s60, 58
    s_cbranch_scc1 Lbeh_85
    s_add_u32 s18, s62, 0
    buffer_load_dwordx4 v[16:19], v5, s[8:11], s18 offen sc1
    s_add_u32 s18, s62, 7168
    buffer_load_dwordx4 v[20:23], v5, s[8:11], s18 offen sc1
    s_add_u32 s18, s62, 28672
    buffer_load_dwordx4 v[24:27], v5, s[8:11], s18 offen sc1
    s_add_u32 s18, s62, 35840
    buffer_load_dwordx4 v[28:31], v5, s[8:11], s18 offen sc1
    s_add_u32 s18, s62, 57344
    buffer_load_dwordx4 v[32:35], v5, s[8:11], s18 offen sc1
    s_add_u32 s18, s62, 64512
    buffer_load_dwordx4 v[36:39], v5, s[8:11], s18 offen sc1
    s_add_u32 s18, s62, 86016
    buffer_load_dwordx4 v[40:43], v5, s[8:11], s18 offen sc1
    s_add_u32 s18, s62, 93184
    buffer_load_dwordx4 v[44:47], v5, s[8:11], s18 offen sc1
    buffer_load_dwordx4 v[48:51], v8, s[56:59], s63 offen
    s_add_u32 s62, s62, 2752512
    s_add_u32 s63, s63, 172032
    s_add_u32 s48, s64, 0
    s_add_u32 s49, s64, 2560
    s_add_u32 s50, s64, 5120
    s_add_u32 s51, s64, 7680
    s_mov_b32 s52, s65
    buffer_load_dwordx4 v[172:175], v4, s[8:11], s48 offen offset:0 sc1
    buffer_load_dwordx4 v[176:179], v4, s[8:11], s48 offen offset:1024 sc1
    buffer_load_dwordx4 v[180:183], v4, s[8:11], s49 offen offset:0 sc1
    buffer_load_dwordx4 v[184:187], v4, s[8:11], s49 offen offset:1024 sc1
    buffer_load_dwordx4 v[188:191], v4, s[8:11], s50 offen offset:0 sc1
    buffer_load_dwordx4 v[192:195], v4, s[8:11], s50 offen offset:1024 sc1
    buffer_load_dwordx4 v[196:199], v4, s[8:11], s51 offen offset:0 sc1
    buffer_load_dwordx4 v[200:203], v4, s[8:11], s51 offen offset:1024 sc1
    buffer_load_dwordx4 v[204:207], v7, s[8:11], s48 offen offset:2048 sc1
    buffer_load_dwordx4 v[208:211], v7, s[8:11], s50 offen offset:2048 sc1
    buffer_load_dwordx4 v[212:215], v6, s[8:11], s52 offen offset:0 sc1
    buffer_load_dwordx4 v[216:219], v6, s[8:11], s52 offen offset:896 sc1
    s_add_u32 s64, s64, 245760
    s_add_u32 s65, s65, 688128
Lbeh_85:
    s_nop 4
    v_mov_b32 v64, 0xc0135761
    v_mov_b32 v65, v64
    v_mov_b32 v66, 1.0
    v_mov_b32 v67, 1.0
    ds_write_b128 v229, v[92:95] offset:32768
    ds_write_b128 v229, v[96:99] offset:33792
    ds_write_b128 v229, v[100:103] offset:34816
    ds_write_b128 v229, v[104:107] offset:35840
    ds_write_b128 v229, v[108:111] offset:36864
    ds_write_b128 v229, v[112:115] offset:37888
    ds_write_b128 v229, v[116:119] offset:38912
    ds_write_b128 v229, v[120:123] offset:39936
    s_waitcnt lgkmcnt(0)
    s_barrier
    ds_read_b128 v[124:127], v230 offset:32768
    ds_read_b128 v[128:131], v230 offset:33792
    ds_read_b128 v[132:135], v230 offset:40960
    ds_read_b128 v[136:139], v230 offset:41984
    ds_read_b128 v[140:143], v230 offset:49152
    ds_read_b128 v[144:147], v230 offset:50176
    ds_read_b128 v[148:151], v230 offset:57344
    ds_read_b128 v[152:155], v230 offset:58368
    buffer_load_dwordx4 v[156:159], v232, s[8:11], s73 offen sc1
    buffer_load_dwordx4 v[160:163], v232, s[8:11], s73 offen offset:512 sc1
    s_waitcnt lgkmcnt(0)
    v_pk_add_f32 v[124:125], v[124:125], v[132:133]
    v_pk_add_f32 v[140:141], v[140:141], v[148:149]
    v_pk_add_f32 v[124:125], v[124:125], v[236:237]
    v_pk_add_f32 v[124:125], v[124:125], v[140:141]
    v_pk_add_f32 v[126:127], v[126:127], v[134:135]
    v_pk_add_f32 v[142:143], v[142:143], v[150:151]
    v_pk_add_f32 v[126:127], v[126:127], v[238:239]
    v_pk_add_f32 v[126:127], v[126:127], v[142:143]
    v_pk_add_f32 v[128:129], v[128:129], v[136:137]
    v_pk_add_f32 v[144:145], v[144:145], v[152:153]
    v_pk_add_f32 v[128:129], v[128:129], v[240:241]
    v_pk_add_f32 v[128:129], v[128:129], v[144:145]
    v_pk_add_f32 v[130:131], v[130:131], v[138:139]
    v_pk_add_f32 v[146:147], v[146:147], v[154:155]
    v_pk_add_f32 v[130:131], v[130:131], v[242:243]
    v_pk_add_f32 v[130:131], v[130:131], v[146:147]
    v_pk_mul_f32 v[132:133], v[124:125], v[124:125]
    v_pk_mul_f32 v[134:135], v[126:127], v[126:127]
    v_pk_mul_f32 v[136:137], v[128:129], v[128:129]
    v_pk_mul_f32 v[138:139], v[130:131], v[130:131]
    v_pk_fma_f32 v[132:133], v[132:133], s[30:31], v[64:65]
    v_pk_fma_f32 v[134:135], v[134:135], s[30:31], v[64:65]
    v_pk_fma_f32 v[136:137], v[136:137], s[30:31], v[64:65]
    v_pk_fma_f32 v[138:139], v[138:139], s[30:31], v[64:65]
    v_pk_mul_f32 v[132:133], v[132:133], v[124:125]
    v_pk_mul_f32 v[134:135], v[134:135], v[126:127]
    v_pk_mul_f32 v[136:137], v[136:137], v[128:129]
    v_pk_mul_f32 v[138:139], v[138:139], v[130:131]
    v_exp_f32 v132, v132
    v_exp_f32 v133, v133
    v_exp_f32 v134, v134
    v_exp_f32 v135, v135
    v_exp_f32 v136, v136
    v_exp_f32 v137, v137
    v_exp_f32 v138, v138
    v_exp_f32 v139, v139
    v_pk_add_f32 v[132:133], v[132:133], v[66:67]
    v_pk_add_f32 v[134:135], v[134:135], v[66:67]
    v_pk_add_f32 v[136:137], v[136:137], v[66:67]
    v_pk_add_f32 v[138:139], v[138:139], v[66:67]
    v_rcp_f32 v132, v132
    v_rcp_f32 v133, v133
    v_rcp_f32 v134, v134
    v_rcp_f32 v135, v135
    v_rcp_f32 v136, v136
    v_rcp_f32 v137, v137
    v_rcp_f32 v138, v138
    v_rcp_f32 v139, v139
    v_pk_mul_f32 v[124:125], v[124:125], v[132:133]
    v_pk_mul_f32 v[126:127], v[126:127], v[134:135]
    v_pk_mul_f32 v[128:129], v[128:129], v[136:137]
    v_pk_mul_f32 v[130:131], v[130:131], v[138:139]
    v_cvt_pk_bf16_f32 v140, v124, v125
    v_cvt_pk_bf16_f32 v141, v126, v127
    v_cvt_pk_bf16_f32 v142, v128, v129
    v_cvt_pk_bf16_f32 v143, v130, v131
    v_min_u32 v140, -2, v140
    v_min_u32 v141, -2, v141
    v_min_u32 v142, -2, v142
    v_min_u32 v143, -2, v143
    buffer_store_dwordx4 v[140:143], v4, s[8:11], s71 offen
    s_sleep 3
Lg2f_86:
    s_mov_b32 s18, s72
    buffer_load_dwordx4 v[64:67], v231, s[8:11], s18 offen offset:0 sc1
    buffer_load_dwordx4 v[68:71], v231, s[8:11], s18 offen offset:2048 sc1
    s_add_u32 s18, s18, 4096
    buffer_load_dwordx4 v[72:75], v231, s[8:11], s18 offen offset:0 sc1
    buffer_load_dwordx4 v[76:79], v231, s[8:11], s18 offen offset:2048 sc1
    s_add_u32 s18, s18, 4096
    buffer_load_dwordx4 v[80:83], v231, s[8:11], s18 offen offset:0 sc1
    buffer_load_dwordx4 v[84:87], v231, s[8:11], s18 offen offset:2048 sc1
    s_add_u32 s18, s18, 4096
    buffer_load_dwordx4 v[88:91], v231, s[8:11], s18 offen offset:0 sc1
    buffer_load_dwordx4 v[92:95], v231, s[8:11], s18 offen offset:2048 sc1
    s_add_u32 s18, s18, 4096
    buffer_load_dwordx4 v[96:99], v231, s[8:11], s18 offen offset:0 sc1
    buffer_load_dwordx4 v[100:103], v231, s[8:11], s18 offen offset:2048 sc1
    s_add_u32 s18, s18, 4096
    buffer_load_dwordx4 v[104:107], v231, s[8:11], s18 offen offset:0 sc1
    buffer_load_dwordx4 v[108:111], v231, s[8:11], s18 offen offset:2048 sc1
    s_add_u32 s18, s18, 4096
    buffer_load_dwordx4 v[112:115], v231, s[8:11], s18 offen offset:0 sc1
    buffer_load_dwordx4 v[116:119], v231, s[8:11], s18 offen offset:2048 sc1
    s_add_u32 s18, s18, 4096
    s_sub_u32 s15, s15, 1
    s_cbranch_scc1 Lm_exit
    v_mov_b32 v10, 0
    s_waitcnt vmcnt(13)
    v_mfma_f32_16x16x32_bf16 v[120:123], a[0:3], v[64:67], 0
    v_max3_u32 v10, v10, v64, v65
    v_mfma_f32_16x16x32_bf16 v[124:127], a[4:7], v[64:67], 0
    v_max3_u32 v10, v10, v66, v67
    s_waitcnt vmcnt(12)
    v_mfma_f32_16x16x32_bf16 v[120:123], a[8:11], v[68:71], v[120:123]
    v_max3_u32 v10, v10, v68, v69
    v_mfma_f32_16x16x32_bf16 v[124:127], a[12:15], v[68:71], v[124:127]
    v_max3_u32 v10, v10, v70, v71
    s_waitcnt vmcnt(11)
    v_mfma_f32_16x16x32_bf16 v[120:123], a[16:19], v[72:75], v[120:123]
    v_max3_u32 v10, v10, v72, v73
    v_mfma_f32_16x16x32_bf16 v[124:127], a[20:23], v[72:75], v[124:127]
    v_max3_u32 v10, v10, v74, v75
    s_waitcnt vmcnt(10)
    v_mfma_f32_16x16x32_bf16 v[120:123], a[24:27], v[76:79], v[120:123]
    v_max3_u32 v10, v10, v76, v77
    v_mfma_f32_16x16x32_bf16 v[124:127], a[28:31], v[76:79], v[124:127]
    v_max3_u32 v10, v10, v78, v79
    s_waitcnt vmcnt(9)
    v_mfma_f32_16x16x32_bf16 v[120:123], a[32:35], v[80:83], v[120:123]
    v_max3_u32 v10, v10, v80, v81
    v_mfma_f32_16x16x32_bf16 v[124:127], a[36:39], v[80:83], v[124:127]
    v_max3_u32 v10, v10, v82, v83
    s_waitcnt vmcnt(8)
    v_mfma_f32_16x16x32_bf16 v[120:123], a[40:43], v[84:87], v[120:123]
    v_max3_u32 v10, v10, v84, v85
    v_mfma_f32_16x16x32_bf16 v[124:127], a[44:47], v[84:87], v[124:127]
    v_max3_u32 v10, v10, v86, v87
    s_waitcnt vmcnt(7)
    v_mfma_f32_16x16x32_bf16 v[120:123], a[48:51], v[88:91], v[120:123]
    v_max3_u32 v10, v10, v88, v89
    v_mfma_f32_16x16x32_bf16 v[124:127], a[52:55], v[88:91], v[124:127]
    v_max3_u32 v10, v10, v90, v91
    s_waitcnt vmcnt(6)
    v_mfma_f32_16x16x32_bf16 v[120:123], a[56:59], v[92:95], v[120:123]
    v_max3_u32 v10, v10, v92, v93
    v_mfma_f32_16x16x32_bf16 v[124:127], a[60:63], v[92:95], v[124:127]
    v_max3_u32 v10, v10, v94, v95
    s_waitcnt vmcnt(5)
    v_mfma_f32_16x16x32_bf16 v[120:123], a[64:67], v[96:99], v[120:123]
    v_max3_u32 v10, v10, v96, v97
    v_mfma_f32_16x16x32_bf16 v[124:127], a[68:71], v[96:99], v[124:127]
    v_max3_u32 v10, v10, v98, v99
    s_waitcnt vmcnt(4)
    v_mfma_f32_16x16x32_bf16 v[120:123], a[72:75], v[100:103], v[120:123]
    v_max3_u32 v10, v10, v100, v101
    v_mfma_f32_16x16x32_bf16 v[124:127], a[76:79], v[100:103], v[124:127]
    v_max3_u32 v10, v10, v102, v103
    s_waitcnt vmcnt(3)
    v_mfma_f32_16x16x32_bf16 v[120:123], a[80:83], v[104:107], v[120:123]
    v_max3_u32 v10, v10, v104, v105
    v_mfma_f32_16x16x32_bf16 v[124:127], a[84:87], v[104:107], v[124:127]
    v_max3_u32 v10, v10, v106, v107
    s_waitcnt vmcnt(2)
    v_mfma_f32_16x16x32_bf16 v[120:123], a[88:91], v[108:111], v[120:123]
    v_max3_u32 v10, v10, v108, v109
    v_mfma_f32_16x16x32_bf16 v[124:127], a[92:95], v[108:111], v[124:127]
    v_max3_u32 v10, v10, v110, v111
    s_waitcnt vmcnt(1)
    v_mfma_f32_16x16x32_bf16 v[120:123], a[96:99], v[112:115], v[120:123]
    v_max3_u32 v10, v10, v112, v113
    v_mfma_f32_16x16x32_bf16 v[124:127], a[100:103], v[112:115], v[124:127]
    v_max3_u32 v10, v10, v114, v115
    s_waitcnt vmcnt(0)
    v_mfma_f32_16x16x32_bf16 v[120:123], a[104:107], v[116:119], v[120:123]
    v_max3_u32 v10, v10, v116, v117
    v_mfma_f32_16x16x32_bf16 v[124:127], a[108:111], v[116:119], v[124:127]
    v_max3_u32 v10, v10, v118, v119
    v_cmp_eq_u32 vcc, -1, v10
    s_cbranch_vccnz Lg2f_86
    s_nop 2
    ds_write_b128 v230, v[120:123] offset:24576
    s_nop 0
    ds_write_b128 v230, v[124:127] offset:25600
    s_waitcnt lgkmcnt(0)
    s_barrier
    s_cmp_lg_u32 s12, 0
    s_cbranch_scc1 Lg2s_87
    ds_read_b128 v[72:75], v4 offset:26624
    ds_read_b128 v[76:79], v4 offset:27648
    ds_read_b128 v[80:83], v4 offset:28672
    ds_read_b128 v[84:87], v4 offset:29696
    ds_read_b128 v[88:91], v4 offset:30720
    ds_read_b128 v[92:95], v4 offset:31744
    v_pk_add_f32 v[156:157], v[156:157], v[244:245]
    v_pk_add_f32 v[158:159], v[158:159], v[246:247]
    v_pk_add_f32 v[160:161], v[160:161], v[248:249]
    v_pk_add_f32 v[162:163], v[162:163], v[250:251]
    s_waitcnt lgkmcnt(0)
    v_pk_add_f32 v[120:121], v[120:121], v[72:73]
    v_pk_add_f32 v[80:81], v[80:81], v[88:89]
    v_pk_add_f32 v[120:121], v[120:121], v[80:81]
    v_pk_add_f32 v[120:121], v[120:121], v[156:157]
    v_pk_add_f32 v[122:123], v[122:123], v[74:75]
    v_pk_add_f32 v[82:83], v[82:83], v[90:91]
    v_pk_add_f32 v[122:123], v[122:123], v[82:83]
    v_pk_add_f32 v[122:123], v[122:123], v[158:159]
    v_pk_add_f32 v[124:125], v[124:125], v[76:77]
    v_pk_add_f32 v[84:85], v[84:85], v[92:93]
    v_pk_add_f32 v[124:125], v[124:125], v[84:85]
    v_pk_add_f32 v[124:125], v[124:125], v[160:161]
    v_pk_add_f32 v[126:127], v[126:127], v[78:79]
    v_pk_add_f32 v[86:87], v[86:87], v[94:95]
    v_pk_add_f32 v[126:127], v[126:127], v[86:87]
    v_pk_add_f32 v[126:127], v[126:127], v[162:163]
    v_cvt_pk_bf16_f32 v64, v120, v124
    v_cvt_pk_bf16_f32 v65, v121, v125
    v_cvt_pk_bf16_f32 v66, v122, v126
    v_cvt_pk_bf16_f32 v67, v123, v127
    buffer_store_dwordx4 v[64:67], v233, s[76:79], s74 offen
Lg2s_87:
    s_add_u32 s70, s70, 172032
    s_add_u32 s71, s71, 688128
    s_add_u32 s72, s72, 688128
    s_add_u32 s73, s73, 344064
    s_add_u32 s74, s74, 172032
    s_add_u32 s66, s66, 344064
    s_add_u32 s67, s67, 172032
    s_add_u32 s68, s68, 43008
    s_add_u32 s60, s60, 6
    s_cmp_lt_u32 s60, 64
    s_cbranch_scc1 Lbe_71
    s_endpgm
Lk_vm:
    s_lshr_b32 s60, s13, 4
    s_or_b32 s13, s13, 16
    s_lshl_b32 s19, s12, 9
    s_add_u32 s19, s19, 108554240
    v_mbcnt_lo_u32_b32 v8, -1, 0
    v_min_u32 v8, 3, v8
    v_lshlrev_b32 v8, 7, v8
    s_branch Lwc_89
Lww_88:
    s_sleep 2
Lwc_89:
    buffer_load_dword v9, v8, s[8:11], s19 offen sc1
    s_sub_u32 s15, s15, 1
    s_cbranch_scc1 Lm_exit
    s_waitcnt vmcnt(0)
    v_cmp_gt_u32 vcc, 7, v9
    s_cbranch_vccnz Lww_88
    v_and_b32 v44, 63, v0
    v_lshrrev_b32 v45, 4, v44
    v_and_b32 v46, 15, v44
    s_sub_u32 s34, s13, 16
    s_mul_i32 s18, s12, 1792
    s_mul_i32 s19, s34, 7168
    s_add_u32 s18, s18, s19
    s_add_u32 s18, s18, 6422528
    v_mul_u32_u24 v49, 114688, v45
    v_lshl_add_u32 v52, v46, 4, v49
    s_lshl_b32 s20, s12, 1
    s_mul_i32 s21, s20, 917504
    s_add_u32 s16, s21, s18
    buffer_load_dwordx4 a[0:3], v52, s[8:11], s16 offen offset:0 sc1
    buffer_load_dwordx4 a[56:59], v52, s[8:11], s16 offen offset:256 sc1
    buffer_load_dwordx4 a[112:115], v52, s[8:11], s16 offen offset:512 sc1
    buffer_load_dwordx4 a[168:171], v52, s[8:11], s16 offen offset:768 sc1
    buffer_load_dwordx4 a[224:227], v52, s[8:11], s16 offen offset:1024 sc1
    buffer_load_dwordx4 v[144:147], v52, s[8:11], s16 offen offset:1280 sc1
    buffer_load_dwordx4 v[200:203], v52, s[8:11], s16 offen offset:1536 sc1
    s_mul_i32 s21, s20, 917504
    s_add_u32 s21, s21, 458752
    s_add_u32 s16, s21, s18
    buffer_load_dwordx4 a[4:7], v52, s[8:11], s16 offen offset:0 sc1
    buffer_load_dwordx4 a[60:63], v52, s[8:11], s16 offen offset:256 sc1
    buffer_load_dwordx4 a[116:119], v52, s[8:11], s16 offen offset:512 sc1
    buffer_load_dwordx4 a[172:175], v52, s[8:11], s16 offen offset:768 sc1
    buffer_load_dwordx4 a[228:231], v52, s[8:11], s16 offen offset:1024 sc1
    buffer_load_dwordx4 v[148:151], v52, s[8:11], s16 offen offset:1280 sc1
    buffer_load_dwordx4 v[204:207], v52, s[8:11], s16 offen offset:1536 sc1
    s_add_u32 s20, s20, 1
    s_cmp_eq_u32 s20, 7
    s_cselect_b32 s20, 0, s20
    s_mul_i32 s21, s20, 917504
    s_add_u32 s16, s21, s18
    buffer_load_dwordx4 a[8:11], v52, s[8:11], s16 offen offset:0 sc1
    buffer_load_dwordx4 a[64:67], v52, s[8:11], s16 offen offset:256 sc1
    buffer_load_dwordx4 a[120:123], v52, s[8:11], s16 offen offset:512 sc1
    buffer_load_dwordx4 a[176:179], v52, s[8:11], s16 offen offset:768 sc1
    buffer_load_dwordx4 a[232:235], v52, s[8:11], s16 offen offset:1024 sc1
    buffer_load_dwordx4 v[152:155], v52, s[8:11], s16 offen offset:1280 sc1
    buffer_load_dwordx4 v[208:211], v52, s[8:11], s16 offen offset:1536 sc1
    s_mul_i32 s21, s20, 917504
    s_add_u32 s21, s21, 458752
    s_add_u32 s16, s21, s18
    buffer_load_dwordx4 a[12:15], v52, s[8:11], s16 offen offset:0 sc1
    buffer_load_dwordx4 a[68:71], v52, s[8:11], s16 offen offset:256 sc1
    buffer_load_dwordx4 a[124:127], v52, s[8:11], s16 offen offset:512 sc1
    buffer_load_dwordx4 a[180:183], v52, s[8:11], s16 offen offset:768 sc1
    buffer_load_dwordx4 a[236:239], v52, s[8:11], s16 offen offset:1024 sc1
    buffer_load_dwordx4 v[156:159], v52, s[8:11], s16 offen offset:1280 sc1
    buffer_load_dwordx4 v[212:215], v52, s[8:11], s16 offen offset:1536 sc1
    s_add_u32 s20, s20, 1
    s_cmp_eq_u32 s20, 7
    s_cselect_b32 s20, 0, s20
    s_mul_i32 s21, s20, 917504
    s_add_u32 s16, s21, s18
    buffer_load_dwordx4 a[16:19], v52, s[8:11], s16 offen offset:0 sc1
    buffer_load_dwordx4 a[72:75], v52, s[8:11], s16 offen offset:256 sc1
    buffer_load_dwordx4 a[128:131], v52, s[8:11], s16 offen offset:512 sc1
    buffer_load_dwordx4 a[184:187], v52, s[8:11], s16 offen offset:768 sc1
    buffer_load_dwordx4 a[240:243], v52, s[8:11], s16 offen offset:1024 sc1
    buffer_load_dwordx4 v[160:163], v52, s[8:11], s16 offen offset:1280 sc1
    buffer_load_dwordx4 v[216:219], v52, s[8:11], s16 offen offset:1536 sc1
    s_mul_i32 s21, s20, 917504
    s_add_u32 s21, s21, 458752
    s_add_u32 s16, s21, s18
    buffer_load_dwordx4 a[20:23], v52, s[8:11], s16 offen offset:0 sc1
    buffer_load_dwordx4 a[76:79], v52, s[8:11], s16 offen offset:256 sc1
    buffer_load_dwordx4 a[132:135], v52, s[8:11], s16 offen offset:512 sc1
    buffer_load_dwordx4 a[188:191], v52, s[8:11], s16 offen offset:768 sc1
    buffer_load_dwordx4 a[244:247], v52, s[8:11], s16 offen offset:1024 sc1
    buffer_load_dwordx4 v[164:167], v52, s[8:11], s16 offen offset:1280 sc1
    buffer_load_dwordx4 v[220:223], v52, s[8:11], s16 offen offset:1536 sc1
    s_add_u32 s20, s20, 1
    s_cmp_eq_u32 s20, 7
    s_cselect_b32 s20, 0, s20
    s_mul_i32 s21, s20, 917504
    s_add_u32 s16, s21, s18
    buffer_load_dwordx4 a[24:27], v52, s[8:11], s16 offen offset:0 sc1
    buffer_load_dwordx4 a[80:83], v52, s[8:11], s16 offen offset:256 sc1
    buffer_load_dwordx4 a[136:139], v52, s[8:11], s16 offen offset:512 sc1
    buffer_load_dwordx4 a[192:195], v52, s[8:11], s16 offen offset:768 sc1
    buffer_load_dwordx4 a[248:251], v52, s[8:11], s16 offen offset:1024 sc1
    buffer_load_dwordx4 v[168:171], v52, s[8:11], s16 offen offset:1280 sc1
    buffer_load_dwordx4 v[224:227], v52, s[8:11], s16 offen offset:1536 sc1
    s_mul_i32 s21, s20, 917504
    s_add_u32 s21, s21, 458752
    s_add_u32 s16, s21, s18
    buffer_load_dwordx4 a[28:31], v52, s[8:11], s16 offen offset:0 sc1
    buffer_load_dwordx4 a[84:87], v52, s[8:11], s16 offen offset:256 sc1
    buffer_load_dwordx4 a[140:143], v52, s[8:11], s16 offen offset:512 sc1
    buffer_load_dwordx4 a[196:199], v52, s[8:11], s16 offen offset:768 sc1
    buffer_load_dwordx4 a[252:255], v52, s[8:11], s16 offen offset:1024 sc1
    buffer_load_dwordx4 v[172:175], v52, s[8:11], s16 offen offset:1280 sc1
    buffer_load_dwordx4 v[228:231], v52, s[8:11], s16 offen offset:1536 sc1
    s_add_u32 s20, s20, 1
    s_cmp_eq_u32 s20, 7
    s_cselect_b32 s20, 0, s20
    s_waitcnt vmcnt(42)
    s_mul_i32 s21, s20, 917504
    s_add_u32 s16, s21, s18
    buffer_load_dwordx4 a[32:35], v52, s[8:11], s16 offen offset:0 sc1
    buffer_load_dwordx4 a[88:91], v52, s[8:11], s16 offen offset:256 sc1
    buffer_load_dwordx4 a[144:147], v52, s[8:11], s16 offen offset:512 sc1
    buffer_load_dwordx4 a[200:203], v52, s[8:11], s16 offen offset:768 sc1
    buffer_load_dwordx4 v[120:123], v52, s[8:11], s16 offen offset:1024 sc1
    buffer_load_dwordx4 v[176:179], v52, s[8:11], s16 offen offset:1280 sc1
    buffer_load_dwordx4 v[232:235], v52, s[8:11], s16 offen offset:1536 sc1
    s_mul_i32 s21, s20, 917504
    s_add_u32 s21, s21, 458752
    s_add_u32 s16, s21, s18
    buffer_load_dwordx4 a[36:39], v52, s[8:11], s16 offen offset:0 sc1
    buffer_load_dwordx4 a[92:95], v52, s[8:11], s16 offen offset:256 sc1
    buffer_load_dwordx4 a[148:151], v52, s[8:11], s16 offen offset:512 sc1
    buffer_load_dwordx4 a[204:207], v52, s[8:11], s16 offen offset:768 sc1
    buffer_load_dwordx4 v[124:127], v52, s[8:11], s16 offen offset:1024 sc1
    buffer_load_dwordx4 v[180:183], v52, s[8:11], s16 offen offset:1280 sc1
    buffer_load_dwordx4 v[236:239], v52, s[8:11], s16 offen offset:1536 sc1
    s_add_u32 s20, s20, 1
    s_cmp_eq_u32 s20, 7
    s_cselect_b32 s20, 0, s20
    s_waitcnt vmcnt(42)
    s_mul_i32 s21, s20, 917504
    s_add_u32 s16, s21, s18
    buffer_load_dwordx4 a[40:43], v52, s[8:11], s16 offen offset:0 sc1
    buffer_load_dwordx4 a[96:99], v52, s[8:11], s16 offen offset:256 sc1
    buffer_load_dwordx4 a[152:155], v52, s[8:11], s16 offen offset:512 sc1
    buffer_load_dwordx4 a[208:211], v52, s[8:11], s16 offen offset:768 sc1
    buffer_load_dwordx4 v[128:131], v52, s[8:11], s16 offen offset:1024 sc1
    buffer_load_dwordx4 v[184:187], v52, s[8:11], s16 offen offset:1280 sc1
    buffer_load_dwordx4 v[240:243], v52, s[8:11], s16 offen offset:1536 sc1
    s_mul_i32 s21, s20, 917504
    s_add_u32 s21, s21, 458752
    s_add_u32 s16, s21, s18
    buffer_load_dwordx4 a[44:47], v52, s[8:11], s16 offen offset:0 sc1
    buffer_load_dwordx4 a[100:103], v52, s[8:11], s16 offen offset:256 sc1
    buffer_load_dwordx4 a[156:159], v52, s[8:11], s16 offen offset:512 sc1
    buffer_load_dwordx4 a[212:215], v52, s[8:11], s16 offen offset:768 sc1
    buffer_load_dwordx4 v[132:135], v52, s[8:11], s16 offen offset:1024 sc1
    buffer_load_dwordx4 v[188:191], v52, s[8:11], s16 offen offset:1280 sc1
    buffer_load_dwordx4 v[244:247], v52, s[8:11], s16 offen offset:1536 sc1
    s_add_u32 s20, s20, 1
    s_cmp_eq_u32 s20, 7
    s_cselect_b32 s20, 0, s20
    s_waitcnt vmcnt(42)
    s_mul_i32 s21, s20, 917504
    s_add_u32 s16, s21, s18
    buffer_load_dwordx4 a[48:51], v52, s[8:11], s16 offen offset:0 sc1
    buffer_load_dwordx4 a[104:107], v52, s[8:11], s16 offen offset:256 sc1
    buffer_load_dwordx4 a[160:163], v52, s[8:11], s16 offen offset:512 sc1
    buffer_load_dwordx4 a[216:219], v52, s[8:11], s16 offen offset:768 sc1
    buffer_load_dwordx4 v[136:139], v52, s[8:11], s16 offen offset:1024 sc1
    buffer_load_dwordx4 v[192:195], v52, s[8:11], s16 offen offset:1280 sc1
    buffer_load_dwordx4 v[248:251], v52, s[8:11], s16 offen offset:1536 sc1
    s_mul_i32 s21, s20, 917504
    s_add_u32 s21, s21, 458752
    s_add_u32 s16, s21, s18
    buffer_load_dwordx4 a[52:55], v52, s[8:11], s16 offen offset:0 sc1
    buffer_load_dwordx4 a[108:111], v52, s[8:11], s16 offen offset:256 sc1
    buffer_load_dwordx4 a[164:167], v52, s[8:11], s16 offen offset:512 sc1
    buffer_load_dwordx4 a[220:223], v52, s[8:11], s16 offen offset:768 sc1
    buffer_load_dwordx4 v[140:143], v52, s[8:11], s16 offen offset:1024 sc1
    buffer_load_dwordx4 v[196:199], v52, s[8:11], s16 offen offset:1280 sc1
    buffer_load_dwordx4 v[252:255], v52, s[8:11], s16 offen offset:1536 sc1
    s_add_u32 s20, s20, 1
    s_cmp_eq_u32 s20, 7
    s_cselect_b32 s20, 0, s20
    s_waitcnt vmcnt(42)
    v_mbcnt_lo_u32_b32 v60, -1, 0
    v_and_b32 v60, 7, v60
    v_lshlrev_b32 v60, 7, v60
    s_mov_b32 s18, 108557312
Lwd_90:
    buffer_load_dword v61, v60, s[8:11], s18 offen sc1
    s_sub_u32 s15, s15, 1
    s_cbranch_scc1 Lm_exit
    s_waitcnt vmcnt(0)
    v_cmp_gt_u32 vcc, 28, v61
    s_sleep 2
    s_cbranch_vccnz Lwd_90
    v_mov_b32 v0, 0x4444
    v_and_b32 v47, 2, v44
    v_cmp_ne_u32 vcc, 0, v47
    v_mov_b32 v47, 0xeeee
    s_nop 0
    v_cndmask_b32 v0, v0, v47, vcc
    v_lshlrev_b32 v47, 4, v44
    s_lshl_b32 s20, s12, 1
    s_lshl_b32 s21, s20, 10
    v_add_u32 v1, s21, v47
    s_add_u32 s20, s20, 1
    s_cmp_eq_u32 s20, 7
    s_cselect_b32 s20, 0, s20
    s_lshl_b32 s21, s20, 10
    v_add_u32 v49, s21, v47
    s_add_u32 s20, s20, 1
    s_cmp_eq_u32 s20, 7
    s_cselect_b32 s20, 0, s20
    s_lshl_b32 s21, s20, 10
    v_add_u32 v11, s21, v47
    s_add_u32 s20, s20, 1
    s_cmp_eq_u32 s20, 7
    s_cselect_b32 s20, 0, s20
    s_lshl_b32 s21, s20, 10
    v_add_u32 v12, s21, v47
    s_add_u32 s20, s20, 1
    s_cmp_eq_u32 s20, 7
    s_cselect_b32 s20, 0, s20
    s_lshl_b32 s21, s20, 10
    v_add_u32 v13, s21, v47
    s_add_u32 s20, s20, 1
    s_cmp_eq_u32 s20, 7
    s_cselect_b32 s20, 0, s20
    s_lshl_b32 s21, s20, 10
    v_add_u32 v14, s21, v47
    s_add_u32 s20, s20, 1
    s_cmp_eq_u32 s20, 7
    s_cselect_b32 s20, 0, s20
    s_lshl_b32 s21, s20, 10
    v_add_u32 v15, s21, v47
    s_add_u32 s20, s20, 1
    s_cmp_eq_u32 s20, 7
    s_cselect_b32 s20, 0, s20
    s_lshl_b32 s21, s12, 11
    s_add_u32 s21, s21, 40960
    v_lshlrev_b32 v50, 4, v46
    v_lshl_add_u32 v2, v45, 2, v50
    v_add_u32 v2, s21, v2
    v_add_u32 v3, 256, v1
    v_and_b32 v3, 1024, v3
    v_lshl_add_u32 v3, v3, 20, v1
    s_mul_i32 s16, s60, 7168
    s_add_u32 s16, s16, 108068864
    s_cmp_eq_u32 s12, 3
    s_cselect_b32 s18, 7168, 0
    s_add_u32 s17, s16, 1024
    s_sub_u32 s17, s17, s18
    s_mul_i32 s61, s34, 7168
    s_lshl_b32 s18, s12, 8
    s_sub_u32 s61, s61, s18
    s_mul_i32 s18, s60, 114688
    s_add_u32 s61, s61, s18
    s_add_u32 s61, s61, 85983232
    v_mov_b32 v72, -1
    v_mov_b32 v73, -1
    v_mov_b32 v74, -1
    v_mov_b32 v75, -1
Lvs_91:
    s_add_u32 s62, s61, 1376256
    s_cmp_ge_u32 s60, 52
    s_cselect_b32 s62, 1073741824, s62
    buffer_store_dwordx4 v[72:75], v1, s[8:11], s62 offen sc1
    buffer_store_dwordx4 v[72:75], v3, s[8:11], s62 offen offset:1024 sc1
    v_mov_b64 v[44:45], 0
    v_mov_b64 v[46:47], 0
    v_mov_b64 v[48:49], 0
    v_mov_b64 v[50:51], 0
    v_mov_b64 v[52:53], 0
    v_mov_b64 v[54:55], 0
    v_mov_b64 v[56:57], 0
    v_mov_b64 v[58:59], 0
    v_mov_b64 v[60:61], 0
    v_mov_b64 v[62:63], 0
    v_mov_b64 v[64:65], 0
    v_mov_b64 v[66:67], 0
    v_mov_b64 v[68:69], 0
    v_mov_b64 v[70:71], 0
    buffer_load_dwordx4 v[16:19], v1, s[8:11], s16 offen sc1
    buffer_load_dwordx4 v[20:23], v1, s[8:11], s17 offen sc1
    s_waitcnt vmcnt(0)
    s_branch Lpc_93
Lpr_92:
    s_cmp_ge_u32 s60, 58
    s_cbranch_scc1 Lps_94
    s_sleep 6
Lps_94:
    buffer_load_dwordx4 v[16:19], v1, s[8:11], s16 offen sc1
    buffer_load_dwordx4 v[20:23], v1, s[8:11], s17 offen sc1
    s_sub_u32 s15, s15, 1
    s_cbranch_scc1 Lm_exit
    s_waitcnt vmcnt(0)
Lpc_93:
    v_max_u32 v104, v16, v17
    v_max3_u32 v104, v104, v18, v19
    v_max3_u32 v104, v104, v20, v21
    v_max3_u32 v104, v104, v22, v23
    v_cmp_eq_u32 vcc, -1, v104
    s_cbranch_vccnz Lpr_92
    v_smfmac_f32_16x16x64_bf16 v[44:47], v[16:19], a[0:7], v0
    ds_write_b128 v1, v[16:19]
    ds_write_b128 v1, v[20:23] offset:1024
    v_smfmac_f32_16x16x64_bf16 v[48:51], v[16:19], a[56:63], v0
    v_smfmac_f32_16x16x64_bf16 v[52:55], v[16:19], a[112:119], v0
    v_smfmac_f32_16x16x64_bf16 v[56:59], v[16:19], a[168:175], v0
    v_smfmac_f32_16x16x64_bf16 v[60:63], v[16:19], a[224:231], v0
    v_smfmac_f32_16x16x64_bf16 v[64:67], v[16:19], v[144:151], v0
    v_smfmac_f32_16x16x64_bf16 v[68:71], v[16:19], v[200:207], v0
    v_smfmac_f32_16x16x64_bf16 v[44:47], v[20:23], a[8:15], v0
    v_smfmac_f32_16x16x64_bf16 v[48:51], v[20:23], a[64:71], v0
    s_waitcnt lgkmcnt(0)
    s_barrier
    ds_read_b128 v[24:27], v11
    v_smfmac_f32_16x16x64_bf16 v[52:55], v[20:23], a[120:127], v0
    ds_read_b128 v[28:31], v12
    v_smfmac_f32_16x16x64_bf16 v[56:59], v[20:23], a[176:183], v0
    ds_read_b128 v[32:35], v13
    v_smfmac_f32_16x16x64_bf16 v[60:63], v[20:23], a[232:239], v0
    ds_read_b128 v[36:39], v14
    v_smfmac_f32_16x16x64_bf16 v[64:67], v[20:23], v[152:159], v0
    ds_read_b128 v[40:43], v15
    v_smfmac_f32_16x16x64_bf16 v[68:71], v[20:23], v[208:215], v0
    s_waitcnt lgkmcnt(4)
    v_smfmac_f32_16x16x64_bf16 v[44:47], v[24:27], a[16:23], v0
    s_waitcnt lgkmcnt(3)
    v_smfmac_f32_16x16x64_bf16 v[44:47], v[28:31], a[24:31], v0
    s_waitcnt lgkmcnt(2)
    v_smfmac_f32_16x16x64_bf16 v[44:47], v[32:35], a[32:39], v0
    s_waitcnt lgkmcnt(1)
    v_smfmac_f32_16x16x64_bf16 v[44:47], v[36:39], a[40:47], v0
    s_waitcnt lgkmcnt(0)
    v_smfmac_f32_16x16x64_bf16 v[44:47], v[40:43], a[48:55], v0
    s_barrier
    v_smfmac_f32_16x16x64_bf16 v[48:51], v[24:27], a[72:79], v0
    v_smfmac_f32_16x16x64_bf16 v[48:51], v[28:31], a[80:87], v0
    v_smfmac_f32_16x16x64_bf16 v[48:51], v[32:35], a[88:95], v0
    v_smfmac_f32_16x16x64_bf16 v[48:51], v[36:39], a[96:103], v0
    v_smfmac_f32_16x16x64_bf16 v[48:51], v[40:43], a[104:111], v0
    v_smfmac_f32_16x16x64_bf16 v[52:55], v[24:27], a[128:135], v0
    s_nop 0
    v_add_f32 v44, v44, v46
    v_smfmac_f32_16x16x64_bf16 v[52:55], v[28:31], a[136:143], v0
    v_add_f32 v45, v45, v47
    v_smfmac_f32_16x16x64_bf16 v[52:55], v[32:35], a[144:151], v0
    v_cvt_pk_bf16_f32 v46, v44, v45
    v_smfmac_f32_16x16x64_bf16 v[52:55], v[36:39], a[152:159], v0
    v_min_u32 v46, -2, v46
    v_smfmac_f32_16x16x64_bf16 v[52:55], v[40:43], a[160:167], v0
    v_smfmac_f32_16x16x64_bf16 v[56:59], v[24:27], a[184:191], v0
    v_add_f32 v48, v48, v50
    v_smfmac_f32_16x16x64_bf16 v[56:59], v[28:31], a[192:199], v0
    v_add_f32 v49, v49, v51
    v_smfmac_f32_16x16x64_bf16 v[56:59], v[32:35], a[200:207], v0
    v_cvt_pk_bf16_f32 v50, v48, v49
    v_smfmac_f32_16x16x64_bf16 v[56:59], v[36:39], a[208:215], v0
    v_min_u32 v50, -2, v50
    v_smfmac_f32_16x16x64_bf16 v[56:59], v[40:43], a[216:223], v0
    ds_write2st64_b32 v2, v46, v50 offset0:0 offset1:1
    v_smfmac_f32_16x16x64_bf16 v[60:63], v[24:27], a[240:247], v0
    v_add_f32 v52, v52, v54
    v_smfmac_f32_16x16x64_bf16 v[60:63], v[28:31], a[248:255], v0
    v_add_f32 v53, v53, v55
    v_smfmac_f32_16x16x64_bf16 v[60:63], v[32:35], v[120:127], v0
    v_cvt_pk_bf16_f32 v54, v52, v53
    v_smfmac_f32_16x16x64_bf16 v[60:63], v[36:39], v[128:135], v0
    v_min_u32 v54, -2, v54
    v_smfmac_f32_16x16x64_bf16 v[60:63], v[40:43], v[136:143], v0
    v_smfmac_f32_16x16x64_bf16 v[64:67], v[24:27], v[160:167], v0
    v_add_f32 v56, v56, v58
    v_smfmac_f32_16x16x64_bf16 v[64:67], v[28:31], v[168:175], v0
    v_add_f32 v57, v57, v59
    v_smfmac_f32_16x16x64_bf16 v[64:67], v[32:35], v[176:183], v0
    v_cvt_pk_bf16_f32 v58, v56, v57
    v_smfmac_f32_16x16x64_bf16 v[64:67], v[36:39], v[184:191], v0
    v_min_u32 v58, -2, v58
    v_smfmac_f32_16x16x64_bf16 v[64:67], v[40:43], v[192:199], v0
    ds_write2st64_b32 v2, v54, v58 offset0:2 offset1:3
    v_smfmac_f32_16x16x64_bf16 v[68:71], v[24:27], v[216:223], v0
    v_add_f32 v60, v60, v62
    v_smfmac_f32_16x16x64_bf16 v[68:71], v[28:31], v[224:231], v0
    v_add_f32 v61, v61, v63
    v_smfmac_f32_16x16x64_bf16 v[68:71], v[32:35], v[232:239], v0
    v_cvt_pk_bf16_f32 v62, v60, v61
    v_smfmac_f32_16x16x64_bf16 v[68:71], v[36:39], v[240:247], v0
    v_min_u32 v62, -2, v62
    v_smfmac_f32_16x16x64_bf16 v[68:71], v[40:43], v[248:255], v0
    v_add_f32 v64, v64, v66
    v_add_f32 v65, v65, v67
    v_cvt_pk_bf16_f32 v66, v64, v65
    v_min_u32 v66, -2, v66
    ds_write2st64_b32 v2, v62, v66 offset0:4 offset1:5
    s_nop 2
    v_add_f32 v68, v68, v70
    v_add_f32 v69, v69, v71
    v_cvt_pk_bf16_f32 v70, v68, v69
    v_min_u32 v70, -2, v70
    ds_write_b32 v2, v70 offset:1536
    ds_read_b128 v[112:115], v1 offset:40960
    ds_read_b128 v[116:119], v1 offset:41984
    s_waitcnt lgkmcnt(0)
    buffer_store_dwordx4 v[112:115], v1, s[8:11], s61 offen sc1
    buffer_store_dwordx4 v[116:119], v3, s[8:11], s61 offen offset:1024 sc1
    s_add_u32 s16, s16, 14336
    s_add_u32 s17, s17, 14336
    s_add_u32 s61, s61, 229376
    s_add_u32 s60, s60, 2
    s_cmp_lt_u32 s60, 64
    s_cbranch_scc1 Lvs_91
    s_endpgm
Lk_wb:
    s_cmp_lg_u32 s13, 30
    s_cbranch_scc1 Lm_exit
    s_cmp_lg_u32 s12, 0
    s_cbranch_scc1 Lm_exit
    v_mbcnt_lo_u32_b32 v9, -1, 0
    v_and_b32 v9, 7, v9
    v_lshlrev_b32 v9, 7, v9
    s_mov_b32 s18, 108557312
Lwd_95:
    buffer_load_dword v10, v9, s[8:11], s18 offen sc1
    s_sub_u32 s15, s15, 1
    s_cbranch_scc1 Lm_exit
    s_waitcnt vmcnt(0)
    v_cmp_gt_u32 vcc, 28, v10
    s_sleep 2
    s_cbranch_vccnz Lwd_95
    v_mov_b32 v9, 0
    s_mov_b32 s18, 108491776
    s_mov_b32 s18, 108427264
Lk_wbl0:
    s_sleep 16
    buffer_load_dword v10, v9, s[8:11], s18 offen sc1
    s_sub_u32 s15, s15, 1
    s_cbranch_scc1 Lm_exit
    s_waitcnt vmcnt(0)
    v_cmp_eq_u32 vcc, -1, v10
    s_cbranch_vccnz Lk_wbl0
    buffer_wbl2 sc1
    s_waitcnt vmcnt(0)
    s_mov_b32 s18, 108491776
Lk_wbl1:
    s_sleep 16
    buffer_load_dword v10, v9, s[8:11], s18 offen sc1
    s_sub_u32 s15, s15, 1
    s_cbranch_scc1 Lm_exit
    s_waitcnt vmcnt(0)
    v_cmp_eq_u32 vcc, -1, v10
    s_cbranch_vccnz Lk_wbl1
    buffer_wbl2 sc1
    s_waitcnt vmcnt(0)
    s_endpgm
Lm_exit:
    s_endpgm
.section .rodata,"a"
.p2align 6
.amdhsa_kernel sequential_preLN__memory_aug_recurrent_mem_tr__mixer_channel_mlp__prompt_kernel
  .amdhsa_next_free_vgpr 512
  .amdhsa_next_free_sgpr 102
  .amdhsa_accum_offset 256
  .amdhsa_group_segment_fixed_size 0
  .amdhsa_kernarg_size 120
  .amdhsa_user_sgpr_count 2
  .amdhsa_user_sgpr_kernarg_segment_ptr 1
  .amdhsa_system_sgpr_workgroup_id_x 1
.end_amdhsa_kernel
.text
```
